```python
import torch

def _softmax(x, axis=-1):
    return torch.softmax(x, dim=axis)
def _gelu(x):
    return torch.nn.functional.gelu(x, approximate="tanh")
def _silu(x):
    return torch.nn.functional.silu(x)
def _sigmoid(x):
    return torch.sigmoid(x)
def _layernorm(x, axis=-1, eps=1e-5):
    m = x.mean(dim=axis, keepdim=True)
    v = x.var(dim=axis, keepdim=True, unbiased=False)
    return (x - m) / torch.sqrt(v + eps)
def _scatter_add(tgt, idx, src, axis=0):
    return tgt.clone().index_add_(axis, idx, src)
def _segment_sum(src, seg, n):
    out = torch.zeros((n,) + src.shape[1:], dtype=src.dtype)
    return out.index_add_(0, seg, src)
def _pad(x, pw):
    flat = tuple(v for pair in reversed(pw) for v in pair)
    return torch.nn.functional.pad(x, flat)

kernel_name = 'standalone__hybrid_graph_tf_nagphormer__graph'

def setup_inputs():

    _w = (lambda a: (lambda t: t.to(torch.bfloat16) if t.is_floating_point() else t)(torch.as_tensor(a)))
    N, deg, D = 25000, 16, 128
    E = N * deg
    src = (lambda lo, hi, *s: torch.randint(lo, hi, s))(0, N, E).to(torch.int64)
    dst = (lambda lo, hi, *s: torch.randint(lo, hi, s))(0, N, E).to(torch.int64)
    deg_cnt = torch.bincount(dst, minlength=N).to(float) + 1.0
    sc = 1.0 / D ** 0.5
    return {
        "x": _w((lambda *s: torch.randn(*s, dtype=torch.bfloat16) * 0.1)(N, D)),
        "src": _w(src),
        "dst": _w(dst),
        "deg_inv_sqrt": _w(1.0 / (lambda _x: torch.sqrt(torch.as_tensor(_x)))(deg_cnt)),
        "wq": _w((lambda *s: torch.randn(*s, dtype=torch.bfloat16) * 1.6)(D, D) * sc),
        "wk": _w((lambda *s: torch.randn(*s, dtype=torch.bfloat16) * 1.6)(D, D) * sc),
        "wv": _w((lambda *s: torch.randn(*s, dtype=torch.bfloat16) * 0.1)(D, D) * sc),
        "wo": _w((lambda *s: torch.randn(*s, dtype=torch.bfloat16) * 0.1)(D, D) * sc),
        "w_r": _w((lambda *s: torch.randn(*s, dtype=torch.bfloat16) * 0.1)(D)),
    }

def reference(x, src, dst, deg_inv_sqrt, wq, wk, wv, wo, w_r):
    N, D = x.shape[0], x.shape[1]
    K = 7
    h = x
    toks = [x]
    for _ in range(K):
        msg = h[src] * deg_inv_sqrt[src, None] * deg_inv_sqrt[dst, None]
        h = _segment_sum(msg, dst, N)
        toks.append(h)
    tok = torch.stack(toks, axis=1)
    t = _layernorm(tok, axis=-1)
    q   = torch.einsum('nkd,de->nke', t, wq)
    key = torch.einsum('nkd,de->nke', t, wk)
    v   = torch.einsum('nkd,de->nke', t, wv)
    scale = 1.0 / (D ** 0.5)
    attn = _softmax(torch.einsum('nkd,nld->nkl', q, key) * scale, axis=-1)
    o = torch.einsum('nkl,nld->nkd', attn, v)
    o = tok + torch.einsum('nkd,de->nke', o, wo)
    r = _layernorm(o, axis=-1)
    alpha = _softmax(torch.einsum('nkd,d->nk', r, w_r), axis=-1)
    return torch.einsum('nk,nkd->nd', alpha, o)
```

```asm
; @launch kernel=prep_kernel grid=(253,1,1) block=(1024,1,1) lds=65536
; @launch kernel=build_kernel grid=(249,1,1) block=(1024,1,1) lds=116224
; @launch kernel=hops_kernel grid=(256,1,1) block=(1024,1,1) lds=159104
; @launch kernel=attn_kernel grid=(256,1,1) block=(512,1,1) lds=135232
.amdgcn_target "amdgcn-amd-amdhsa--gfx950"
.text
.globl prep_kernel
.p2align 8
.type prep_kernel,@function
prep_kernel:

    s_cmp_ge_u32 s2, 253
    s_cbranch_scc1 K1_END
    s_load_dwordx2 s[8:9], s[0:1], 88
    v_lshrrev_b32 v1, 6, v0
    v_and_b32 v2, 63, v0
    s_cmp_ge_u32 s2, 100
    v_readfirstlane_b32 s3, v1
    s_cbranch_scc1 K1_NOTPART
    s_load_dwordx4 s[4:7], s[0:1], 8
    v_lshlrev_b32 v3, 2, v0
    v_mov_b32 v4, 0
    ds_write_b32 v3, v4
    v_lshlrev_b32 v3, 4, v0
    s_mul_i32 s10, s2, 16000
    s_waitcnt lgkmcnt(0)
    s_mov_b32 s12, s4
    s_mov_b32 s13, s5
    s_mov_b32 s14, 0x186a00
    s_mov_b32 s15, 0x20000
    s_mov_b32 s16, s6
    s_mov_b32 s17, s7
    s_mov_b32 s18, 0x186a00
    s_mov_b32 s19, 0x20000
    v_cmp_gt_u32 vcc, 1000, v0
    s_and_saveexec_b64 s[20:21], vcc
    buffer_load_dwordx4 v[8:11], v3, s[16:19], s10 offen nt
    buffer_load_dwordx4 v[4:7], v3, s[12:15], s10 offen nt
    s_movk_i32 s22, 896
    s_movk_i32 s23, 2048
    s_movk_i32 s24, -448
    s_movk_i32 s25, -3136
    s_movk_i32 s42, 1152
    v_mov_b32 v28, 1
    v_mov_b32 v29, 896
    v_mov_b32 v30, 2048
    s_barrier
    s_waitcnt vmcnt(1)
    v_lshrrev_b32 v12, 6, v8
    v_lshrrev_b32 v13, 6, v9
    v_lshrrev_b32 v14, 6, v10
    v_lshrrev_b32 v15, 6, v11
    v_mul_u32_u24 v32, 1338, v12
    v_mul_u32_u24 v33, 1338, v13
    v_mul_u32_u24 v34, 1338, v14
    v_mul_u32_u24 v35, 1338, v15
    v_mul_u32_u24 v12, 9363, v12
    v_mul_u32_u24 v13, 9363, v13
    v_mul_u32_u24 v14, 9363, v14
    v_mul_u32_u24 v15, 9363, v15
    v_lshrrev_b32 v32, 16, v32
    v_lshrrev_b32 v33, 16, v33
    v_lshrrev_b32 v34, 16, v34
    v_lshrrev_b32 v35, 16, v35
    v_lshrrev_b32 v12, 16, v12
    v_lshrrev_b32 v13, 16, v13
    v_lshrrev_b32 v14, 16, v14
    v_lshrrev_b32 v15, 16, v15
    v_mad_i32_i24 v8, v12, s24, v8
    v_mad_i32_i24 v9, v13, s24, v9
    v_mad_i32_i24 v10, v14, s24, v10
    v_mad_i32_i24 v11, v15, s24, v11
    v_lshl_add_u32 v12, v12, 1, v12
    v_lshl_add_u32 v13, v13, 1, v13
    v_lshl_add_u32 v14, v14, 1, v14
    v_lshl_add_u32 v15, v15, 1, v15
    s_waitcnt vmcnt(0)
    v_lshrrev_b32 v36, 6, v4
    v_lshrrev_b32 v37, 6, v5
    v_lshrrev_b32 v38, 6, v6
    v_lshrrev_b32 v39, 6, v7
    v_mul_u32_u24 v36, 1338, v36
    v_mul_u32_u24 v37, 1338, v37
    v_mul_u32_u24 v38, 1338, v38
    v_mul_u32_u24 v39, 1338, v39
    v_lshrrev_b32 v36, 16, v36
    v_lshrrev_b32 v37, 16, v37
    v_lshrrev_b32 v38, 16, v38
    v_lshrrev_b32 v39, 16, v39
    v_mad_i32_i24 v4, v36, s25, v4
    v_mad_i32_i24 v5, v37, s25, v5
    v_mad_i32_i24 v6, v38, s25, v6
    v_mad_i32_i24 v7, v39, s25, v7
    v_cmp_le_u32 s[26:27], s22, v4
    v_cmp_le_u32 s[28:29], s22, v5
    v_cmp_le_u32 s[30:31], s22, v6
    v_cmp_le_u32 s[32:33], s22, v7
    v_cmp_le_u32 s[34:35], s23, v4
    v_cmp_le_u32 s[36:37], s23, v5
    v_cmp_le_u32 s[38:39], s23, v6
    v_cmp_le_u32 s[40:41], s23, v7
    v_cndmask_b32 v16, 0, v29, s[26:27]
    v_cndmask_b32 v17, 0, v29, s[28:29]
    v_cndmask_b32 v18, 0, v29, s[30:31]
    v_cndmask_b32 v19, 0, v29, s[32:33]
    v_cndmask_b32 v40, 0, 1, s[26:27]
    v_cndmask_b32 v41, 0, 1, s[28:29]
    v_cndmask_b32 v42, 0, 1, s[30:31]
    v_cndmask_b32 v43, 0, 1, s[32:33]
    v_cndmask_b32 v16, v16, v30, s[34:35]
    v_cndmask_b32 v17, v17, v30, s[36:37]
    v_cndmask_b32 v18, v18, v30, s[38:39]
    v_cndmask_b32 v19, v19, v30, s[40:41]
    v_cndmask_b32 v40, v40, 2, s[34:35]
    v_cndmask_b32 v41, v41, 2, s[36:37]
    v_cndmask_b32 v42, v42, 2, s[38:39]
    v_cndmask_b32 v43, v43, 2, s[40:41]
    v_cmp_gt_u32 s[26:27], v36, v32
    v_cmp_gt_u32 s[28:29], v37, v33
    v_cmp_gt_u32 s[30:31], v38, v34
    v_cmp_gt_u32 s[32:33], v39, v35
    v_cmp_eq_u32 s[34:35], v36, v32
    v_cmp_eq_u32 s[36:37], v37, v33
    v_cmp_eq_u32 s[38:39], v38, v34
    v_cmp_eq_u32 s[40:41], v39, v35
    v_sub_u32 v16, v4, v16
    v_sub_u32 v17, v5, v17
    v_sub_u32 v18, v6, v18
    v_sub_u32 v19, v7, v19
    v_subb_co_u32 v36, vcc, v36, 0, s[26:27]
    v_subb_co_u32 v37, vcc, v37, 0, s[28:29]
    v_subb_co_u32 v38, vcc, v38, 0, s[30:31]
    v_subb_co_u32 v39, vcc, v39, 0, s[32:33]
    v_or_b32 v44, 0x200, v8
    v_or_b32 v45, 0x200, v9
    v_or_b32 v46, 0x200, v10
    v_or_b32 v47, 0x200, v11
    v_mad_u32_u24 v16, v36, s42, v16
    v_mad_u32_u24 v17, v37, s42, v17
    v_mad_u32_u24 v18, v38, s42, v18
    v_mad_u32_u24 v19, v39, s42, v19
    v_cndmask_b32 v40, v40, 0, s[34:35]
    v_cndmask_b32 v41, v41, 0, s[36:37]
    v_cndmask_b32 v42, v42, 0, s[38:39]
    v_cndmask_b32 v43, v43, 0, s[40:41]
    v_cndmask_b32 v8, v8, v44, s[34:35]
    v_cndmask_b32 v9, v9, v45, s[36:37]
    v_cndmask_b32 v10, v10, v46, s[38:39]
    v_cndmask_b32 v11, v11, v47, s[40:41]
    v_cndmask_b32 v4, v16, v4, s[34:35]
    v_cndmask_b32 v5, v17, v5, s[36:37]
    v_cndmask_b32 v6, v18, v6, s[38:39]
    v_cndmask_b32 v7, v19, v7, s[40:41]
    v_add_lshl_u32 v12, v12, v40, 2
    v_add_lshl_u32 v13, v13, v41, 2
    v_add_lshl_u32 v14, v14, v42, 2
    v_add_lshl_u32 v15, v15, v43, 2
    ds_add_rtn_u32 v16, v12, v28
    ds_add_rtn_u32 v17, v13, v28
    ds_add_rtn_u32 v18, v14, v28
    ds_add_rtn_u32 v19, v15, v28
    v_lshl_or_b32 v4, v8, 16, v4
    v_lshl_or_b32 v5, v9, 16, v5
    v_lshl_or_b32 v6, v10, 16, v6
    v_lshl_or_b32 v7, v11, 16, v7
    s_waitcnt lgkmcnt(0)
    s_barrier
    s_cmp_lg_u32 s3, 0
    s_cbranch_scc1 K1_P_SKIPSCAN
    v_lshlrev_b32 v20, 4, v2
    ds_read_b128 v[24:27], v20
    s_lshl_b32 s11, s2, 2
    s_add_u32 s44, s8, 0x3290000
    s_addc_u32 s45, s9, 0
    s_mov_b32 s46, 86016
    s_mov_b32 s47, 0x20000
    v_lshlrev_b32 v23, 11, v2
    s_waitcnt lgkmcnt(0)
    v_add_u32 v21, v24, v25
    v_add3_u32 v21, v21, v26, v27
    v_mov_b32 v22, v21
    s_nop 1
    v_add_u32_dpp v22, v22, v22 row_shr:1 row_mask:0xf bank_mask:0xf bound_ctrl:0
    s_nop 1
    v_add_u32_dpp v22, v22, v22 row_shr:2 row_mask:0xf bank_mask:0xf bound_ctrl:0
    s_nop 1
    v_add_u32_dpp v22, v22, v22 row_shr:4 row_mask:0xf bank_mask:0xf bound_ctrl:0
    s_nop 1
    v_add_u32_dpp v22, v22, v22 row_shr:8 row_mask:0xf bank_mask:0xf bound_ctrl:0
    s_nop 1
    v_add_u32_dpp v22, v22, v22 row_bcast:15 row_mask:0xa bank_mask:0xf
    s_nop 1
    v_add_u32_dpp v22, v22, v22 row_bcast:31 row_mask:0xc bank_mask:0xf
    v_sub_u32 v32, v22, v21
    v_add_u32 v33, v32, v24
    v_add_u32 v34, v33, v25
    v_add_u32 v35, v34, v26
    ds_write_b128 v20, v[32:35] offset:1024
    v_max_u32 v40, v24, v25
    v_max3_u32 v40, v40, v26, v27
    ds_max_u32 v28, v40 offset:1019
    v_lshl_or_b32 v36, v24, 16, v32
    v_lshl_or_b32 v37, v25, 16, v33
    v_lshl_or_b32 v38, v26, 16, v34
    v_lshl_or_b32 v39, v27, 16, v35
    buffer_store_dword v36, v23, s[44:47], s11 offen sc1
    buffer_store_dword v37, v23, s[44:47], s11 offen offset:512 sc1
    buffer_store_dword v38, v23, s[44:47], s11 offen offset:1024 sc1
    buffer_store_dword v39, v23, s[44:47], s11 offen offset:1536 sc1
    s_waitcnt lgkmcnt(0)
K1_P_SKIPSCAN:
    s_barrier
    ds_read_b32 v20, v12 offset:1024
    ds_read_b32 v21, v13 offset:1024
    ds_read_b32 v22, v14 offset:1024
    ds_read_b32 v23, v15 offset:1024
    s_add_u32 s12, s8, 0x3100000
    s_addc_u32 s13, s9, 0
    s_mov_b32 s14, 0x186a00
    s_mov_b32 s15, 0x20000
    s_waitcnt lgkmcnt(3)
    v_add_lshl_u32 v20, v20, v16, 2
    s_waitcnt lgkmcnt(2)
    v_add_lshl_u32 v21, v21, v17, 2
    s_waitcnt lgkmcnt(1)
    v_add_lshl_u32 v22, v22, v18, 2
    s_waitcnt lgkmcnt(0)
    v_add_lshl_u32 v23, v23, v19, 2
    ds_write_b32 v20, v4 offset:2048
    ds_write_b32 v21, v5 offset:2048
    ds_write_b32 v22, v6 offset:2048
    ds_write_b32 v23, v7 offset:2048
    s_waitcnt lgkmcnt(0)
    s_barrier
    ds_read_b128 v[4:7], v3 offset:2048
    s_waitcnt lgkmcnt(0)
    buffer_store_dwordx4 v[4:7], v3, s[12:15], s10 offen
    s_endpgm
K1_NOTPART:
K1_WEIGHTS:
    s_cmp_lg_u32 s2, 100
    s_cbranch_scc1 K1_W1
    v_mov_b32 v12, 0
    v_mov_b32 v13, 0
    v_mov_b32 v14, 0
    v_mov_b32 v15, 0
    v_lshlrev_b32 v16, 6, v0
    s_waitcnt lgkmcnt(0)
    s_add_u32 s28, s8, 0x34e0000
    s_addc_u32 s29, s9, 0
    s_mov_b32 s30, 0x10000
    s_mov_b32 s31, 0x20000
    buffer_store_dwordx4 v[12:15], v16, s[28:31], 0 offen offset:0
    buffer_store_dwordx4 v[12:15], v16, s[28:31], 0 offen offset:16
    buffer_store_dwordx4 v[12:15], v16, s[28:31], 0 offen offset:32
    buffer_store_dwordx4 v[12:15], v16, s[28:31], 0 offen offset:48
K1_W1:
    s_cmp_ge_u32 s2, 132
    s_cbranch_scc1 TR_START
    s_cmp_lg_u32 s3, 0
    s_cbranch_scc1 K1_CP
    s_load_dwordx8 s[36:43], s[0:1], 32
    s_load_dwordx2 s[6:7], s[0:1], 64
    s_sub_u32 s4, s2, 100
    s_bfe_u32 s10, s4, 0x30001
    s_and_b32 s11, s4, 1
    v_and_b32 v4, 15, v2
    v_lshrrev_b32 v5, 4, v2
    v_lshrrev_b32 v6, 2, v4
    v_and_b32 v7, 3, v4
    v_lshl_add_u32 v6, v6, 3, v7
    v_lshlrev_b32 v3, 8, v6
    v_lshl_add_u32 v3, v5, 4, v3
    s_lshr_b32 s12, s10, 1
    s_and_b32 s13, s10, 1
    s_lshl_b32 s12, s12, 5
    s_lshl_b32 s13, s13, 2
    s_add_u32 s12, s12, s13
    v_add_lshl_u32 v8, v6, s12, 2
    v_lshlrev_b32 v9, 5, v5
    s_lshl_b32 s14, s11, 8
    v_add_u32 v9, s14, v9
    v_lshlrev_b32 v11, 4, v2
    s_lshl_b32 s15, s11, 14
    s_add_u32 s16, s15, 8192
    s_lshl_b32 s17, s12, 8
    s_waitcnt lgkmcnt(0)
    s_add_u32 s20, s8, 0x3510000
    s_addc_u32 s21, s9, 0
    s_mov_b32 s22, 0x26000
    s_mov_b32 s23, 0x20000
    s_cmp_ge_u32 s4, 16
    s_cbranch_scc1 K1_WV
    s_mov_b32 s24, s36
    s_mov_b32 s25, s37
    s_mov_b32 s26, 0x8000
    s_mov_b32 s27, 0x20000
    s_mov_b32 s28, s38
    s_mov_b32 s29, s39
    s_mov_b32 s30, 0x8000
    s_mov_b32 s31, 0x20000
    buffer_load_dwordx4 v[16:19], v3, s[28:31], s17 offen offset:0
    buffer_load_dwordx4 v[20:23], v3, s[28:31], s17 offen offset:64
    buffer_load_dwordx4 v[24:27], v3, s[28:31], s17 offen offset:128
    buffer_load_dwordx4 v[28:31], v3, s[28:31], s17 offen offset:192
    s_branch K1_WA
K1_WV:
    s_mov_b32 s24, s40
    s_mov_b32 s25, s41
    s_mov_b32 s26, 0x8000
    s_mov_b32 s27, 0x20000
    s_mov_b32 s28, s42
    s_mov_b32 s29, s43
    s_mov_b32 s30, 0x8000
    s_mov_b32 s31, 0x20000
    s_mov_b32 s32, s6
    s_mov_b32 s33, s7
    s_mov_b32 s34, 0x100
    s_mov_b32 s35, 0x20000
    v_lshrrev_b32 v15, 1, v8
    buffer_load_ushort v10, v15, s[32:35], 0 offen
    v_lshl_add_u32 v15, v5, 11, v15
    s_mov_b32 s18, 0
    buffer_load_ushort v96, v15, s[28:31], s18 offen offset:0
    buffer_load_ushort v97, v15, s[28:31], s18 offen offset:256
    buffer_load_ushort v98, v15, s[28:31], s18 offen offset:512
    buffer_load_ushort v99, v15, s[28:31], s18 offen offset:768
    buffer_load_ushort v100, v15, s[28:31], s18 offen offset:1024
    buffer_load_ushort v101, v15, s[28:31], s18 offen offset:1280
    buffer_load_ushort v102, v15, s[28:31], s18 offen offset:1536
    buffer_load_ushort v103, v15, s[28:31], s18 offen offset:1792
    s_mov_b32 s18, 8192
    buffer_load_ushort v104, v15, s[28:31], s18 offen offset:0
    buffer_load_ushort v105, v15, s[28:31], s18 offen offset:256
    buffer_load_ushort v106, v15, s[28:31], s18 offen offset:512
    buffer_load_ushort v107, v15, s[28:31], s18 offen offset:768
    buffer_load_ushort v108, v15, s[28:31], s18 offen offset:1024
    buffer_load_ushort v109, v15, s[28:31], s18 offen offset:1280
    buffer_load_ushort v110, v15, s[28:31], s18 offen offset:1536
    buffer_load_ushort v111, v15, s[28:31], s18 offen offset:1792
    s_mov_b32 s18, 16384
    buffer_load_ushort v112, v15, s[28:31], s18 offen offset:0
    buffer_load_ushort v113, v15, s[28:31], s18 offen offset:256
    buffer_load_ushort v114, v15, s[28:31], s18 offen offset:512
    buffer_load_ushort v115, v15, s[28:31], s18 offen offset:768
    buffer_load_ushort v116, v15, s[28:31], s18 offen offset:1024
    buffer_load_ushort v117, v15, s[28:31], s18 offen offset:1280
    buffer_load_ushort v118, v15, s[28:31], s18 offen offset:1536
    buffer_load_ushort v119, v15, s[28:31], s18 offen offset:1792
    s_mov_b32 s18, 24576
    buffer_load_ushort v120, v15, s[28:31], s18 offen offset:0
    buffer_load_ushort v121, v15, s[28:31], s18 offen offset:256
    buffer_load_ushort v122, v15, s[28:31], s18 offen offset:512
    buffer_load_ushort v123, v15, s[28:31], s18 offen offset:768
    buffer_load_ushort v124, v15, s[28:31], s18 offen offset:1024
    buffer_load_ushort v125, v15, s[28:31], s18 offen offset:1280
    buffer_load_ushort v126, v15, s[28:31], s18 offen offset:1536
    buffer_load_ushort v127, v15, s[28:31], s18 offen offset:1792
K1_WA:
    buffer_load_dwordx4 v[32:35], v3, s[24:27], s15 offen offset:0
    buffer_load_dwordx4 v[36:39], v3, s[24:27], s15 offen offset:64
    buffer_load_dwordx4 v[40:43], v3, s[24:27], s15 offen offset:128
    buffer_load_dwordx4 v[44:47], v3, s[24:27], s15 offen offset:192
    buffer_load_dwordx4 v[48:51], v3, s[24:27], s15 offen offset:1024
    buffer_load_dwordx4 v[52:55], v3, s[24:27], s15 offen offset:1088
    buffer_load_dwordx4 v[56:59], v3, s[24:27], s15 offen offset:1152
    buffer_load_dwordx4 v[60:63], v3, s[24:27], s15 offen offset:1216
    buffer_load_dwordx4 v[64:67], v3, s[24:27], s16 offen offset:0
    buffer_load_dwordx4 v[68:71], v3, s[24:27], s16 offen offset:64
    buffer_load_dwordx4 v[72:75], v3, s[24:27], s16 offen offset:128
    buffer_load_dwordx4 v[76:79], v3, s[24:27], s16 offen offset:192
    buffer_load_dwordx4 v[80:83], v3, s[24:27], s16 offen offset:1024
    buffer_load_dwordx4 v[84:87], v3, s[24:27], s16 offen offset:1088
    buffer_load_dwordx4 v[88:91], v3, s[24:27], s16 offen offset:1152
    buffer_load_dwordx4 v[92:95], v3, s[24:27], s16 offen offset:1216
    s_lshl_b32 s18, s4, 12
    s_lshl_b32 s19, s4, 8
    s_add_u32 s19, s19, 131072
    v_lshlrev_b32 v13, 2, v2
    v_lshlrev_b32 v14, 6, v5
    s_waitcnt vmcnt(0)
    s_cmp_lt_u32 s4, 16
    s_cbranch_scc1 K1_WB
    v_lshl_or_b32 v16, v97, 16, v96
    v_lshl_or_b32 v17, v99, 16, v98
    v_lshl_or_b32 v18, v101, 16, v100
    v_lshl_or_b32 v19, v103, 16, v102
    v_lshl_or_b32 v20, v105, 16, v104
    v_lshl_or_b32 v21, v107, 16, v106
    v_lshl_or_b32 v22, v109, 16, v108
    v_lshl_or_b32 v23, v111, 16, v110
    v_lshl_or_b32 v24, v113, 16, v112
    v_lshl_or_b32 v25, v115, 16, v114
    v_lshl_or_b32 v26, v117, 16, v116
    v_lshl_or_b32 v27, v119, 16, v118
    v_lshl_or_b32 v28, v121, 16, v120
    v_lshl_or_b32 v29, v123, 16, v122
    v_lshl_or_b32 v30, v125, 16, v124
    v_lshl_or_b32 v31, v127, 16, v126
    s_nop 1
K1_WB:
    v_mfma_f32_16x16x32_bf16 v[96:99], v[32:35], v[16:19], 0
    v_mfma_f32_16x16x32_bf16 v[100:103], v[48:51], v[16:19], 0
    v_mfma_f32_16x16x32_bf16 v[104:107], v[64:67], v[16:19], 0
    v_mfma_f32_16x16x32_bf16 v[108:111], v[80:83], v[16:19], 0
    v_mfma_f32_16x16x32_bf16 v[96:99], v[36:39], v[20:23], v[96:99]
    v_mfma_f32_16x16x32_bf16 v[100:103], v[52:55], v[20:23], v[100:103]
    v_mfma_f32_16x16x32_bf16 v[104:107], v[68:71], v[20:23], v[104:107]
    v_mfma_f32_16x16x32_bf16 v[108:111], v[84:87], v[20:23], v[108:111]
    v_mfma_f32_16x16x32_bf16 v[96:99], v[40:43], v[24:27], v[96:99]
    v_mfma_f32_16x16x32_bf16 v[100:103], v[56:59], v[24:27], v[100:103]
    v_mfma_f32_16x16x32_bf16 v[104:107], v[72:75], v[24:27], v[104:107]
    v_mfma_f32_16x16x32_bf16 v[108:111], v[88:91], v[24:27], v[108:111]
    v_mfma_f32_16x16x32_bf16 v[96:99], v[44:47], v[28:31], v[96:99]
    v_mfma_f32_16x16x32_bf16 v[100:103], v[60:63], v[28:31], v[100:103]
    v_mfma_f32_16x16x32_bf16 v[104:107], v[76:79], v[28:31], v[104:107]
    v_mfma_f32_16x16x32_bf16 v[108:111], v[92:95], v[28:31], v[108:111]
    s_nop 7
    buffer_store_dwordx4 v[96:99], v11, s[20:23], s18 offen offset:0
    buffer_store_dwordx4 v[100:103], v11, s[20:23], s18 offen offset:1024
    buffer_store_dwordx4 v[104:107], v11, s[20:23], s18 offen offset:2048
    buffer_store_dwordx4 v[108:111], v11, s[20:23], s18 offen offset:3072
    v_add_f32 v12, v96, v97
    v_add_f32 v12, v12, v98
    v_add_f32 v12, v12, v99
    v_add_f32 v12, v12, v100
    v_add_f32 v12, v12, v101
    v_add_f32 v12, v12, v102
    v_add_f32 v12, v12, v103
    v_add_f32 v12, v12, v104
    v_add_f32 v12, v12, v105
    v_add_f32 v12, v12, v106
    v_add_f32 v12, v12, v107
    v_add_f32 v12, v12, v108
    v_add_f32 v12, v12, v109
    v_add_f32 v12, v12, v110
    v_add_f32 v12, v12, v111
    buffer_store_dword v12, v13, s[20:23], s19 offen
    v_lshlrev_b32 v10, 16, v10
    v_mul_f32 v64, v10, v96
    v_mul_f32 v65, v10, v97
    v_mul_f32 v66, v10, v98
    v_mul_f32 v67, v10, v99
    v_mul_f32 v68, v10, v100
    v_mul_f32 v69, v10, v101
    v_mul_f32 v70, v10, v102
    v_mul_f32 v71, v10, v103
    v_mul_f32 v72, v10, v104
    v_mul_f32 v73, v10, v105
    v_mul_f32 v74, v10, v106
    v_mul_f32 v75, v10, v107
    v_mul_f32 v76, v10, v108
    v_mul_f32 v77, v10, v109
    v_mul_f32 v78, v10, v110
    v_mul_f32 v79, v10, v111
    v_add_f32_dpp v32, v96, v96 row_ror:8 row_mask:0xf bank_mask:0xf
    v_add_f32_dpp v33, v97, v97 row_ror:8 row_mask:0xf bank_mask:0xf
    v_add_f32_dpp v34, v98, v98 row_ror:8 row_mask:0xf bank_mask:0xf
    v_add_f32_dpp v35, v99, v99 row_ror:8 row_mask:0xf bank_mask:0xf
    v_add_f32_dpp v36, v100, v100 row_ror:8 row_mask:0xf bank_mask:0xf
    v_add_f32_dpp v37, v101, v101 row_ror:8 row_mask:0xf bank_mask:0xf
    v_add_f32_dpp v38, v102, v102 row_ror:8 row_mask:0xf bank_mask:0xf
    v_add_f32_dpp v39, v103, v103 row_ror:8 row_mask:0xf bank_mask:0xf
    v_add_f32_dpp v40, v104, v104 row_ror:8 row_mask:0xf bank_mask:0xf
    v_add_f32_dpp v41, v105, v105 row_ror:8 row_mask:0xf bank_mask:0xf
    v_add_f32_dpp v42, v106, v106 row_ror:8 row_mask:0xf bank_mask:0xf
    v_add_f32_dpp v43, v107, v107 row_ror:8 row_mask:0xf bank_mask:0xf
    v_add_f32_dpp v44, v108, v108 row_ror:8 row_mask:0xf bank_mask:0xf
    v_add_f32_dpp v45, v109, v109 row_ror:8 row_mask:0xf bank_mask:0xf
    v_add_f32_dpp v46, v110, v110 row_ror:8 row_mask:0xf bank_mask:0xf
    v_add_f32_dpp v47, v111, v111 row_ror:8 row_mask:0xf bank_mask:0xf
    v_add_f32_dpp v32, v32, v32 row_ror:4 row_mask:0xf bank_mask:0xf
    v_add_f32_dpp v33, v33, v33 row_ror:4 row_mask:0xf bank_mask:0xf
    v_add_f32_dpp v34, v34, v34 row_ror:4 row_mask:0xf bank_mask:0xf
    v_add_f32_dpp v35, v35, v35 row_ror:4 row_mask:0xf bank_mask:0xf
    v_add_f32_dpp v36, v36, v36 row_ror:4 row_mask:0xf bank_mask:0xf
    v_add_f32_dpp v37, v37, v37 row_ror:4 row_mask:0xf bank_mask:0xf
    v_add_f32_dpp v38, v38, v38 row_ror:4 row_mask:0xf bank_mask:0xf
    v_add_f32_dpp v39, v39, v39 row_ror:4 row_mask:0xf bank_mask:0xf
    v_add_f32_dpp v40, v40, v40 row_ror:4 row_mask:0xf bank_mask:0xf
    v_add_f32_dpp v41, v41, v41 row_ror:4 row_mask:0xf bank_mask:0xf
    v_add_f32_dpp v42, v42, v42 row_ror:4 row_mask:0xf bank_mask:0xf
    v_add_f32_dpp v43, v43, v43 row_ror:4 row_mask:0xf bank_mask:0xf
    v_add_f32_dpp v44, v44, v44 row_ror:4 row_mask:0xf bank_mask:0xf
    v_add_f32_dpp v45, v45, v45 row_ror:4 row_mask:0xf bank_mask:0xf
    v_add_f32_dpp v46, v46, v46 row_ror:4 row_mask:0xf bank_mask:0xf
    v_add_f32_dpp v47, v47, v47 row_ror:4 row_mask:0xf bank_mask:0xf
    v_add_f32_dpp v32, v32, v32 row_ror:2 row_mask:0xf bank_mask:0xf
    v_add_f32_dpp v33, v33, v33 row_ror:2 row_mask:0xf bank_mask:0xf
    v_add_f32_dpp v34, v34, v34 row_ror:2 row_mask:0xf bank_mask:0xf
    v_add_f32_dpp v35, v35, v35 row_ror:2 row_mask:0xf bank_mask:0xf
    v_add_f32_dpp v36, v36, v36 row_ror:2 row_mask:0xf bank_mask:0xf
    v_add_f32_dpp v37, v37, v37 row_ror:2 row_mask:0xf bank_mask:0xf
    v_add_f32_dpp v38, v38, v38 row_ror:2 row_mask:0xf bank_mask:0xf
    v_add_f32_dpp v39, v39, v39 row_ror:2 row_mask:0xf bank_mask:0xf
    v_add_f32_dpp v40, v40, v40 row_ror:2 row_mask:0xf bank_mask:0xf
    v_add_f32_dpp v41, v41, v41 row_ror:2 row_mask:0xf bank_mask:0xf
    v_add_f32_dpp v42, v42, v42 row_ror:2 row_mask:0xf bank_mask:0xf
    v_add_f32_dpp v43, v43, v43 row_ror:2 row_mask:0xf bank_mask:0xf
    v_add_f32_dpp v44, v44, v44 row_ror:2 row_mask:0xf bank_mask:0xf
    v_add_f32_dpp v45, v45, v45 row_ror:2 row_mask:0xf bank_mask:0xf
    v_add_f32_dpp v46, v46, v46 row_ror:2 row_mask:0xf bank_mask:0xf
    v_add_f32_dpp v47, v47, v47 row_ror:2 row_mask:0xf bank_mask:0xf
    v_add_f32_dpp v32, v32, v32 row_ror:1 row_mask:0xf bank_mask:0xf
    v_add_f32_dpp v33, v33, v33 row_ror:1 row_mask:0xf bank_mask:0xf
    v_add_f32_dpp v34, v34, v34 row_ror:1 row_mask:0xf bank_mask:0xf
    v_add_f32_dpp v35, v35, v35 row_ror:1 row_mask:0xf bank_mask:0xf
    v_add_f32_dpp v36, v36, v36 row_ror:1 row_mask:0xf bank_mask:0xf
    v_add_f32_dpp v37, v37, v37 row_ror:1 row_mask:0xf bank_mask:0xf
    v_add_f32_dpp v38, v38, v38 row_ror:1 row_mask:0xf bank_mask:0xf
    v_add_f32_dpp v39, v39, v39 row_ror:1 row_mask:0xf bank_mask:0xf
    v_add_f32_dpp v40, v40, v40 row_ror:1 row_mask:0xf bank_mask:0xf
    v_add_f32_dpp v41, v41, v41 row_ror:1 row_mask:0xf bank_mask:0xf
    v_add_f32_dpp v42, v42, v42 row_ror:1 row_mask:0xf bank_mask:0xf
    v_add_f32_dpp v43, v43, v43 row_ror:1 row_mask:0xf bank_mask:0xf
    v_add_f32_dpp v44, v44, v44 row_ror:1 row_mask:0xf bank_mask:0xf
    v_add_f32_dpp v45, v45, v45 row_ror:1 row_mask:0xf bank_mask:0xf
    v_add_f32_dpp v46, v46, v46 row_ror:1 row_mask:0xf bank_mask:0xf
    v_add_f32_dpp v47, v47, v47 row_ror:1 row_mask:0xf bank_mask:0xf
    v_add_f32_dpp v48, v64, v64 row_ror:8 row_mask:0xf bank_mask:0xf
    v_add_f32_dpp v49, v65, v65 row_ror:8 row_mask:0xf bank_mask:0xf
    v_add_f32_dpp v50, v66, v66 row_ror:8 row_mask:0xf bank_mask:0xf
    v_add_f32_dpp v51, v67, v67 row_ror:8 row_mask:0xf bank_mask:0xf
    v_add_f32_dpp v52, v68, v68 row_ror:8 row_mask:0xf bank_mask:0xf
    v_add_f32_dpp v53, v69, v69 row_ror:8 row_mask:0xf bank_mask:0xf
    v_add_f32_dpp v54, v70, v70 row_ror:8 row_mask:0xf bank_mask:0xf
    v_add_f32_dpp v55, v71, v71 row_ror:8 row_mask:0xf bank_mask:0xf
    v_add_f32_dpp v56, v72, v72 row_ror:8 row_mask:0xf bank_mask:0xf
    v_add_f32_dpp v57, v73, v73 row_ror:8 row_mask:0xf bank_mask:0xf
    v_add_f32_dpp v58, v74, v74 row_ror:8 row_mask:0xf bank_mask:0xf
    v_add_f32_dpp v59, v75, v75 row_ror:8 row_mask:0xf bank_mask:0xf
    v_add_f32_dpp v60, v76, v76 row_ror:8 row_mask:0xf bank_mask:0xf
    v_add_f32_dpp v61, v77, v77 row_ror:8 row_mask:0xf bank_mask:0xf
    v_add_f32_dpp v62, v78, v78 row_ror:8 row_mask:0xf bank_mask:0xf
    v_add_f32_dpp v63, v79, v79 row_ror:8 row_mask:0xf bank_mask:0xf
    v_add_f32_dpp v48, v48, v48 row_ror:4 row_mask:0xf bank_mask:0xf
    v_add_f32_dpp v49, v49, v49 row_ror:4 row_mask:0xf bank_mask:0xf
    v_add_f32_dpp v50, v50, v50 row_ror:4 row_mask:0xf bank_mask:0xf
    v_add_f32_dpp v51, v51, v51 row_ror:4 row_mask:0xf bank_mask:0xf
    v_add_f32_dpp v52, v52, v52 row_ror:4 row_mask:0xf bank_mask:0xf
    v_add_f32_dpp v53, v53, v53 row_ror:4 row_mask:0xf bank_mask:0xf
    v_add_f32_dpp v54, v54, v54 row_ror:4 row_mask:0xf bank_mask:0xf
    v_add_f32_dpp v55, v55, v55 row_ror:4 row_mask:0xf bank_mask:0xf
    v_add_f32_dpp v56, v56, v56 row_ror:4 row_mask:0xf bank_mask:0xf
    v_add_f32_dpp v57, v57, v57 row_ror:4 row_mask:0xf bank_mask:0xf
    v_add_f32_dpp v58, v58, v58 row_ror:4 row_mask:0xf bank_mask:0xf
    v_add_f32_dpp v59, v59, v59 row_ror:4 row_mask:0xf bank_mask:0xf
    v_add_f32_dpp v60, v60, v60 row_ror:4 row_mask:0xf bank_mask:0xf
    v_add_f32_dpp v61, v61, v61 row_ror:4 row_mask:0xf bank_mask:0xf
    v_add_f32_dpp v62, v62, v62 row_ror:4 row_mask:0xf bank_mask:0xf
    v_add_f32_dpp v63, v63, v63 row_ror:4 row_mask:0xf bank_mask:0xf
    v_add_f32_dpp v48, v48, v48 row_ror:2 row_mask:0xf bank_mask:0xf
    v_add_f32_dpp v49, v49, v49 row_ror:2 row_mask:0xf bank_mask:0xf
    v_add_f32_dpp v50, v50, v50 row_ror:2 row_mask:0xf bank_mask:0xf
    v_add_f32_dpp v51, v51, v51 row_ror:2 row_mask:0xf bank_mask:0xf
    v_add_f32_dpp v52, v52, v52 row_ror:2 row_mask:0xf bank_mask:0xf
    v_add_f32_dpp v53, v53, v53 row_ror:2 row_mask:0xf bank_mask:0xf
    v_add_f32_dpp v54, v54, v54 row_ror:2 row_mask:0xf bank_mask:0xf
    v_add_f32_dpp v55, v55, v55 row_ror:2 row_mask:0xf bank_mask:0xf
    v_add_f32_dpp v56, v56, v56 row_ror:2 row_mask:0xf bank_mask:0xf
    v_add_f32_dpp v57, v57, v57 row_ror:2 row_mask:0xf bank_mask:0xf
    v_add_f32_dpp v58, v58, v58 row_ror:2 row_mask:0xf bank_mask:0xf
    v_add_f32_dpp v59, v59, v59 row_ror:2 row_mask:0xf bank_mask:0xf
    v_add_f32_dpp v60, v60, v60 row_ror:2 row_mask:0xf bank_mask:0xf
    v_add_f32_dpp v61, v61, v61 row_ror:2 row_mask:0xf bank_mask:0xf
    v_add_f32_dpp v62, v62, v62 row_ror:2 row_mask:0xf bank_mask:0xf
    v_add_f32_dpp v63, v63, v63 row_ror:2 row_mask:0xf bank_mask:0xf
    v_add_f32_dpp v48, v48, v48 row_ror:1 row_mask:0xf bank_mask:0xf
    v_add_f32_dpp v49, v49, v49 row_ror:1 row_mask:0xf bank_mask:0xf
    v_add_f32_dpp v50, v50, v50 row_ror:1 row_mask:0xf bank_mask:0xf
    v_add_f32_dpp v51, v51, v51 row_ror:1 row_mask:0xf bank_mask:0xf
    v_add_f32_dpp v52, v52, v52 row_ror:1 row_mask:0xf bank_mask:0xf
    v_add_f32_dpp v53, v53, v53 row_ror:1 row_mask:0xf bank_mask:0xf
    v_add_f32_dpp v54, v54, v54 row_ror:1 row_mask:0xf bank_mask:0xf
    v_add_f32_dpp v55, v55, v55 row_ror:1 row_mask:0xf bank_mask:0xf
    v_add_f32_dpp v56, v56, v56 row_ror:1 row_mask:0xf bank_mask:0xf
    v_add_f32_dpp v57, v57, v57 row_ror:1 row_mask:0xf bank_mask:0xf
    v_add_f32_dpp v58, v58, v58 row_ror:1 row_mask:0xf bank_mask:0xf
    v_add_f32_dpp v59, v59, v59 row_ror:1 row_mask:0xf bank_mask:0xf
    v_add_f32_dpp v60, v60, v60 row_ror:1 row_mask:0xf bank_mask:0xf
    v_add_f32_dpp v61, v61, v61 row_ror:1 row_mask:0xf bank_mask:0xf
    v_add_f32_dpp v62, v62, v62 row_ror:1 row_mask:0xf bank_mask:0xf
    v_add_f32_dpp v63, v63, v63 row_ror:1 row_mask:0xf bank_mask:0xf
    s_add_u32 s19, s19, 8192
    s_add_u32 s18, s19, 4096
    s_mov_b32 exec_lo, 0x00010001
    s_mov_b32 exec_hi, 0x00010001
    buffer_store_dwordx4 v[32:35], v14, s[20:23], s19 offen offset:0
    buffer_store_dwordx4 v[36:39], v14, s[20:23], s19 offen offset:16
    buffer_store_dwordx4 v[40:43], v14, s[20:23], s19 offen offset:32
    buffer_store_dwordx4 v[44:47], v14, s[20:23], s19 offen offset:48
    s_cmp_lt_u32 s4, 16
    s_cbranch_scc1 K1_END
    buffer_store_dwordx4 v[48:51], v14, s[20:23], s18 offen offset:0
    buffer_store_dwordx4 v[52:55], v14, s[20:23], s18 offen offset:16
    buffer_store_dwordx4 v[56:59], v14, s[20:23], s18 offen offset:32
    buffer_store_dwordx4 v[60:63], v14, s[20:23], s18 offen offset:48
K1_END:
    s_endpgm
K1_CP:
    s_sub_u32 s3, s3, 1
    s_getpc_b64 s[40:41]
CP_1:
    s_add_u32 s40, s40, build_kernel-CP_1
    s_addc_u32 s41, s41, 0
    s_mov_b32 s42, CODE_END-build_kernel
    s_mov_b32 s43, 0x20000
    v_and_b32 v20, 63, v0
    v_lshlrev_b32 v20, 4, v20
    s_lshl_b32 s44, s3, 10
    buffer_load_dwordx4 v[24:27], v20, s[40:43], s44 offen
    s_add_u32 s44, s44, 15360
    buffer_load_dwordx4 v[24:27], v20, s[40:43], s44 offen
    s_add_u32 s44, s44, 15360
    buffer_load_dwordx4 v[24:27], v20, s[40:43], s44 offen
    s_add_u32 s44, s44, 15360
    buffer_load_dwordx4 v[24:27], v20, s[40:43], s44 offen
    s_add_u32 s44, s44, 15360
    s_endpgm
TR_START:
    s_waitcnt lgkmcnt(0)
    s_load_dwordx2 s[4:5], s[0:1], 0
    s_load_dwordx2 s[6:7], s[0:1], 24
    s_sub_u32 s10, s2, 132
    s_mul_i32 s10, s10, 13
    s_add_u32 s10, s10, s3
    s_cmp_ge_u32 s3, 13
    s_cbranch_scc1 K1_END
    s_cmp_ge_u32 s10, 1568
    s_cbranch_scc1 K1_END
    v_lshlrev_b32 v3, 4, v2
    v_lshrrev_b32 v4, 4, v2
    v_lshlrev_b32 v5, 1, v4
    s_lshl_b32 s24, s10, 12
    s_lshl_b32 s25, s10, 5
    s_lshl_b32 s27, s10, 7
    s_lshl_b32 s11, s3, 12
    s_waitcnt lgkmcnt(0)
    s_mov_b32 s12, s4
    s_mov_b32 s13, s5
    s_mov_b32 s14, 0x61a800
    s_mov_b32 s15, 0x20000
    s_mov_b32 s16, s6
    s_mov_b32 s17, s7
    s_mov_b32 s18, 0xc350
    s_mov_b32 s19, 0x20000
    s_mov_b32 s20, s8
    s_mov_b32 s21, s9
    s_mov_b32 s22, 0x620000
    s_mov_b32 s23, 0x20000
    buffer_load_dwordx4 v[8:11], v3, s[12:15], s24 offen offset:0
    buffer_load_dwordx4 v[12:15], v3, s[12:15], s24 offen offset:1024
    buffer_load_dwordx4 v[16:19], v3, s[12:15], s24 offen offset:2048
    buffer_load_dwordx4 v[20:23], v3, s[12:15], s24 offen offset:3072
    buffer_load_ushort v32, v5, s[16:19], s25 offen offset:0
    buffer_load_ushort v33, v5, s[16:19], s25 offen offset:8
    buffer_load_ushort v34, v5, s[16:19], s25 offen offset:16
    buffer_load_ushort v35, v5, s[16:19], s25 offen offset:24
    v_and_b32 v6, 15, v2
    v_and_b32 v7, 7, v2
    v_lshrrev_b32 v36, 1, v4
    v_xor_b32 v36, v36, v7
    v_and_b32 v37, 1, v4
    v_lshlrev_b32 v6, 8, v6
    v_lshl_add_u32 v6, v37, 3, v6
    v_add_u32 v6, s11, v6
    v_lshrrev_b32 v38, 3, v2
    v_lshrrev_b32 v39, 1, v38
    v_xor_b32 v39, v39, v7
    s_mov_b32 s26, 200704
    v_mul_u32_u24 v38, s26, v38
    v_lshl_add_u32 v40, v39, 4, v38
    v_xor_b32 v41, 64, v40
    v_add_u32 v42, s11, v3
    s_mov_b32 s26, 0xffff0000
    s_waitcnt vmcnt(3)
    v_lshlrev_b32 v32, 16, v32
    v_xor_b32 v37, 0, v36
    v_lshl_add_u32 v37, v37, 4, v6
    v_lshlrev_b32 v24, 16, v8
    v_and_b32 v25, s26, v8
    v_lshlrev_b32 v26, 16, v9
    v_and_b32 v27, s26, v9
    v_lshlrev_b32 v28, 16, v10
    v_and_b32 v29, s26, v10
    v_lshlrev_b32 v30, 16, v11
    v_and_b32 v31, s26, v11
    v_mul_f32 v24, v32, v24
    v_mul_f32 v25, v32, v25
    v_mul_f32 v26, v32, v26
    v_mul_f32 v27, v32, v27
    v_mul_f32 v28, v32, v28
    v_mul_f32 v29, v32, v29
    v_mul_f32 v30, v32, v30
    v_mul_f32 v31, v32, v31
    v_cvt_pk_bf16_f32 v8, v24, v25
    v_cvt_pk_bf16_f32 v9, v26, v27
    v_cvt_pk_bf16_f32 v10, v28, v29
    v_cvt_pk_bf16_f32 v11, v30, v31
    ds_write2_b64 v37, v[8:9], v[10:11] offset1:16
    s_waitcnt vmcnt(2)
    v_lshlrev_b32 v33, 16, v33
    v_xor_b32 v37, 2, v36
    v_lshl_add_u32 v37, v37, 4, v6
    v_lshlrev_b32 v24, 16, v12
    v_and_b32 v25, s26, v12
    v_lshlrev_b32 v26, 16, v13
    v_and_b32 v27, s26, v13
    v_lshlrev_b32 v28, 16, v14
    v_and_b32 v29, s26, v14
    v_lshlrev_b32 v30, 16, v15
    v_and_b32 v31, s26, v15
    v_mul_f32 v24, v33, v24
    v_mul_f32 v25, v33, v25
    v_mul_f32 v26, v33, v26
    v_mul_f32 v27, v33, v27
    v_mul_f32 v28, v33, v28
    v_mul_f32 v29, v33, v29
    v_mul_f32 v30, v33, v30
    v_mul_f32 v31, v33, v31
    v_cvt_pk_bf16_f32 v12, v24, v25
    v_cvt_pk_bf16_f32 v13, v26, v27
    v_cvt_pk_bf16_f32 v14, v28, v29
    v_cvt_pk_bf16_f32 v15, v30, v31
    ds_write2_b64 v37, v[12:13], v[14:15] offset1:16
    s_waitcnt vmcnt(1)
    v_lshlrev_b32 v34, 16, v34
    v_xor_b32 v37, 4, v36
    v_lshl_add_u32 v37, v37, 4, v6
    v_lshlrev_b32 v24, 16, v16
    v_and_b32 v25, s26, v16
    v_lshlrev_b32 v26, 16, v17
    v_and_b32 v27, s26, v17
    v_lshlrev_b32 v28, 16, v18
    v_and_b32 v29, s26, v18
    v_lshlrev_b32 v30, 16, v19
    v_and_b32 v31, s26, v19
    v_mul_f32 v24, v34, v24
    v_mul_f32 v25, v34, v25
    v_mul_f32 v26, v34, v26
    v_mul_f32 v27, v34, v27
    v_mul_f32 v28, v34, v28
    v_mul_f32 v29, v34, v29
    v_mul_f32 v30, v34, v30
    v_mul_f32 v31, v34, v31
    v_cvt_pk_bf16_f32 v16, v24, v25
    v_cvt_pk_bf16_f32 v17, v26, v27
    v_cvt_pk_bf16_f32 v18, v28, v29
    v_cvt_pk_bf16_f32 v19, v30, v31
    ds_write2_b64 v37, v[16:17], v[18:19] offset1:16
    s_waitcnt vmcnt(0)
    v_lshlrev_b32 v35, 16, v35
    v_xor_b32 v37, 6, v36
    v_lshl_add_u32 v37, v37, 4, v6
    v_lshlrev_b32 v24, 16, v20
    v_and_b32 v25, s26, v20
    v_lshlrev_b32 v26, 16, v21
    v_and_b32 v27, s26, v21
    v_lshlrev_b32 v28, 16, v22
    v_and_b32 v29, s26, v22
    v_lshlrev_b32 v30, 16, v23
    v_and_b32 v31, s26, v23
    v_mul_f32 v24, v35, v24
    v_mul_f32 v25, v35, v25
    v_mul_f32 v26, v35, v26
    v_mul_f32 v27, v35, v27
    v_mul_f32 v28, v35, v28
    v_mul_f32 v29, v35, v29
    v_mul_f32 v30, v35, v30
    v_mul_f32 v31, v35, v31
    v_cvt_pk_bf16_f32 v20, v24, v25
    v_cvt_pk_bf16_f32 v21, v26, v27
    v_cvt_pk_bf16_f32 v22, v28, v29
    v_cvt_pk_bf16_f32 v23, v30, v31
    ds_write2_b64 v37, v[20:21], v[22:23] offset1:16
    s_waitcnt lgkmcnt(0)
    ds_read_b128 v[8:11], v42 offset:0
    ds_read_b128 v[12:15], v42 offset:1024
    ds_read_b128 v[16:19], v42 offset:2048
    ds_read_b128 v[20:23], v42 offset:3072
    s_waitcnt lgkmcnt(3)
    buffer_store_dwordx4 v[8:11], v40, s[20:23], s27 offen
    s_add_u32 s27, s27, 1605632
    s_waitcnt lgkmcnt(2)
    buffer_store_dwordx4 v[12:15], v41, s[20:23], s27 offen
    s_add_u32 s27, s27, 1605632
    s_waitcnt lgkmcnt(1)
    buffer_store_dwordx4 v[16:19], v40, s[20:23], s27 offen
    s_add_u32 s27, s27, 1605632
    s_waitcnt lgkmcnt(0)
    buffer_store_dwordx4 v[20:23], v41, s[20:23], s27 offen
    s_endpgm
.text
.globl build_kernel
.p2align 8
.type build_kernel,@function
build_kernel:

    s_cmp_ge_u32 s2, 249
    s_cbranch_scc1 K2_END
    s_load_dwordx2 s[8:9], s[0:1], 88
    s_load_dwordx2 s[4:5], s[0:1], 24
    s_load_dwordx2 s[6:7], s[0:1], 80
    v_lshrrev_b32 v1, 6, v0
    v_and_b32 v2, 63, v0
    v_lshrrev_b32 v3, 5, v0
    v_readfirstlane_b32 s3, v1
    v_and_b32 v4, 31, v0
    s_cmp_ge_u32 s2, 201
    s_cbranch_scc1 K2_WARM
    s_cmp_ge_u32 s2, 168
    s_cbranch_scc1 W2_START
    s_mul_i32 s10, s2, 21846
    s_lshr_b32 s10, s10, 16
    s_mul_i32 s11, s10, 3
    s_sub_u32 s11, s2, s11
    v_lshlrev_b32 v5, 2, v3
    s_lshl_b32 s12, s2, 9
    v_lshlrev_b32 v7, 4, v0
    v_mov_b32 v8, 0
    v_mov_b32 v9, 0
    v_mov_b32 v10, 0
    v_mov_b32 v11, 0
    ds_write_b128 v7, v[8:11]
    s_and_b32 s13, s3, 3
    s_mul_i32 s13, s13, 0x80008
    s_add_u32 s14, s13, 0xc410c40
    s_add_u32 s13, s13, 0x1f811f80
    v_mov_b32 v8, s13
    v_add_u32 v9, 0x20002, v8
    v_add_u32 v10, 0x40004, v8
    v_add_u32 v11, 0x60006, v8
    v_mov_b32 v20, s14
    v_add_u32 v21, 0x20002, v20
    v_add_u32 v22, 0x40004, v20
    v_add_u32 v23, 0x60006, v20
    s_min_u32 s64, s11, 1
    s_waitcnt lgkmcnt(0)
    s_add_u32 s16, s8, s12
    s_addc_u32 s17, s9, 0
    s_add_u32 s16, s16, 0x3290000
    s_addc_u32 s17, s17, 0
    s_mov_b32 s18, 400
    s_mov_b32 s19, 0x20000
    s_add_u32 s20, s8, 0x3100000
    s_addc_u32 s21, s9, 0
    s_mov_b32 s22, 0x186a00
    s_mov_b32 s23, 0x20000
    s_mov_b32 s24, s4
    s_mov_b32 s25, s5
    s_mov_b32 s26, 0xc350
    s_mov_b32 s27, 0x20000
    buffer_load_dword v12, v5, s[16:19], 0 offen offset:0
    buffer_load_dword v13, v5, s[16:19], 0 offen offset:128
    buffer_load_dword v14, v5, s[16:19], 0 offen offset:256
    buffer_load_dword v15, v5, s[16:19], 0 offen offset:384
    s_mul_i32 s13, s10, 896
    v_lshl_add_u32 v16, v0, 1, s13
    buffer_load_ushort v16, v16, s[24:27], 0 offen
    s_cmp_ge_u32 s3, 12
    s_cbranch_scc1 K2_NOSTG
    v_mul_u32_u24 v7, 400, v2
    v_lshl_add_u32 v7, v1, 4, v7
    ds_write_b128 v7, v[8:11] offset:16896
    ds_write_b128 v7, v[20:23] offset:17088
K2_NOSTG:
    v_mul_u32_u24 v17, 16000, v3
    v_lshl_add_u32 v17, v4, 2, v17
    v_mov_b32 v18, 1
    v_add_u32 v19, 32, v4
    s_mov_b32 s14, 0xffff
    s_mov_b32 s66, 0x1e220d25
    s_cmp_eq_u32 s11, 1
    s_cselect_b32 s66, 0x2026122b, s66
    s_cmp_eq_u32 s11, 2
    s_cselect_b32 s66, 0x1f241028, s66
    s_mov_b32 s67, 0x1808
    s_cmp_eq_u32 s11, 1
    s_cselect_b32 s67, 0x180b, s67
    s_cmp_eq_u32 s11, 2
    s_cselect_b32 s67, 0x180a, s67
    s_mov_b32 s68, 0x8654333
    s_cmp_eq_u32 s11, 1
    s_cselect_b32 s68, 0xb876565, s68
    s_cmp_eq_u32 s11, 2
    s_cselect_b32 s68, 0xa765444, s68
    s_mov_b32 s69, 0x4
    s_cmp_eq_u32 s11, 1
    s_cselect_b32 s69, 0x6, s69
    s_cmp_eq_u32 s11, 2
    s_cselect_b32 s69, 0x5, s69
    s_mov_b32 s70, 0x5
    s_cmp_eq_u32 s11, 1
    s_cselect_b32 s70, 0x9, s70
    s_cmp_eq_u32 s11, 2
    s_cselect_b32 s70, 0xf, s70
    s_mov_b32 s71, 0x6443322
    s_cmp_eq_u32 s11, 1
    s_cselect_b32 s71, 0x7554433, s71
    s_cmp_eq_u32 s11, 2
    s_cselect_b32 s71, 0x7554433, s71
    s_mov_b32 s48, 0x1d220c27
    s_mov_b32 s49, 0x1806
    s_cmp_lt_u32 s3, 8
    s_cselect_b32 s48, s66, s48
    s_cselect_b32 s49, s67, s49
    s_cselect_b32 s50, s64, 0
    s_and_b32 s51, s3, 7
    s_lshl_b32 s51, s51, 3
    s_lshr_b64 s[48:49], s[48:49], s51
    s_lshl_b32 s48, s48, 1
    v_subrev_u32 v6, s48, v4
    v_lshlrev_b32 v6, v6, v18
    v_or_b32 v6, s50, v6
    v_lshlrev_b32 v62, 2, v0
    ds_write_b32 v62, v6 offset:46592
    s_waitcnt vmcnt(4)
    v_and_b32 v20, s14, v12
    v_lshrrev_b32 v24, 16, v12
    v_lshl_add_u32 v20, v20, 2, v17
    v_cmp_lt_u32 s[30:31], v4, v24
    v_cmp_lt_u32 s[38:39], v19, v24
    s_mov_b32 s13, 0
    buffer_load_dword v28, v20, s[20:23], s13 offen
    buffer_load_dword v32, v20, s[20:23], s13 offen offset:128
    s_waitcnt vmcnt(5)
    v_and_b32 v21, s14, v13
    v_lshrrev_b32 v25, 16, v13
    v_lshl_add_u32 v21, v21, 2, v17
    v_cmp_lt_u32 s[32:33], v4, v25
    v_cmp_lt_u32 s[40:41], v19, v25
    s_mov_b32 s13, 512000
    buffer_load_dword v29, v21, s[20:23], s13 offen
    buffer_load_dword v33, v21, s[20:23], s13 offen offset:128
    s_waitcnt vmcnt(6)
    v_and_b32 v22, s14, v14
    v_lshrrev_b32 v26, 16, v14
    v_lshl_add_u32 v22, v22, 2, v17
    v_cmp_lt_u32 s[34:35], v4, v26
    v_cmp_lt_u32 s[42:43], v19, v26
    s_mov_b32 s13, 1024000
    buffer_load_dword v30, v22, s[20:23], s13 offen
    buffer_load_dword v34, v22, s[20:23], s13 offen offset:128
    s_waitcnt vmcnt(7)
    v_and_b32 v23, s14, v15
    v_lshrrev_b32 v27, 16, v15
    v_lshl_add_u32 v23, v23, 2, v17
    v_cmp_lt_u32 s[36:37], v4, v27
    v_cmp_lt_u32 s[44:45], v19, v27
    s_mov_b32 s13, 1536000
    buffer_load_dword v31, v23, s[20:23], s13 offen
    buffer_load_dword v35, v23, s[20:23], s13 offen offset:128
    v_max_u32 v36, v24, v25
    v_max3_u32 v36, v36, v26, v27
    v_cmp_lt_u32 vcc, 64, v36
    s_waitcnt lgkmcnt(0)
    s_barrier
    s_mov_b64 s[46:47], vcc
    s_waitcnt vmcnt(7)
    s_mov_b64 exec, s[30:31]
    v_lshrrev_b32 v36, 14, v28
    v_and_b32 v36, 0xffc, v36
    ds_add_rtn_u32 v44, v36, v18
    s_waitcnt vmcnt(6)
    s_mov_b64 exec, s[38:39]
    s_cbranch_execz K2_A4
    v_lshrrev_b32 v40, 14, v32
    v_and_b32 v40, 0xffc, v40
    ds_add_rtn_u32 v48, v40, v18
K2_A4:
    s_waitcnt vmcnt(5)
    s_mov_b64 exec, s[32:33]
    v_lshrrev_b32 v37, 14, v29
    v_and_b32 v37, 0xffc, v37
    ds_add_rtn_u32 v45, v37, v18
    s_waitcnt vmcnt(4)
    s_mov_b64 exec, s[40:41]
    s_cbranch_execz K2_A5
    v_lshrrev_b32 v41, 14, v33
    v_and_b32 v41, 0xffc, v41
    ds_add_rtn_u32 v49, v41, v18
K2_A5:
    s_waitcnt vmcnt(3)
    s_mov_b64 exec, s[34:35]
    v_lshrrev_b32 v38, 14, v30
    v_and_b32 v38, 0xffc, v38
    ds_add_rtn_u32 v46, v38, v18
    s_waitcnt vmcnt(2)
    s_mov_b64 exec, s[42:43]
    s_cbranch_execz K2_A6
    v_lshrrev_b32 v42, 14, v34
    v_and_b32 v42, 0xffc, v42
    ds_add_rtn_u32 v50, v42, v18
K2_A6:
    s_waitcnt vmcnt(1)
    s_mov_b64 exec, s[36:37]
    s_cbranch_execz K2_A3
    v_lshrrev_b32 v39, 14, v31
    v_and_b32 v39, 0xffc, v39
    ds_add_rtn_u32 v47, v39, v18
K2_A3:
    s_waitcnt vmcnt(0)
    s_mov_b64 exec, s[44:45]
    s_cbranch_execz K2_A7
    v_lshrrev_b32 v43, 14, v35
    v_and_b32 v43, 0xffc, v43
    ds_add_rtn_u32 v51, v43, v18
K2_A7:
    s_mov_b64 exec, -1
    s_cmp_eq_u64 s[46:47], 0
    s_cbranch_scc1 K2_NOSLOWA
    ds_write_b32 v18, v18 offset:12287
    v_add_u32 v52, 64, v4
    v_add_u32 v53, 256, v20
    s_mov_b32 s13, 0
K2_SA0:
    v_cmp_lt_u32 vcc, v52, v24
    s_and_saveexec_b64 s[48:49], vcc
    s_cbranch_execz K2_SA0_E
    buffer_load_dword v54, v53, s[20:23], s13 offen
    s_waitcnt vmcnt(0)
    v_lshrrev_b32 v54, 14, v54
    v_and_b32 v54, 0xffc, v54
    ds_add_u32 v54, v18 offset:4096
    s_mov_b64 exec, s[48:49]
    v_add_u32 v52, 32, v52
    v_add_u32 v53, 128, v53
    s_branch K2_SA0
K2_SA0_E:
    s_mov_b64 exec, s[48:49]
    v_add_u32 v52, 64, v4
    v_add_u32 v53, 256, v21
    s_mov_b32 s13, 512000
K2_SA1:
    v_cmp_lt_u32 vcc, v52, v25
    s_and_saveexec_b64 s[48:49], vcc
    s_cbranch_execz K2_SA1_E
    buffer_load_dword v54, v53, s[20:23], s13 offen
    s_waitcnt vmcnt(0)
    v_lshrrev_b32 v54, 14, v54
    v_and_b32 v54, 0xffc, v54
    ds_add_u32 v54, v18 offset:4096
    s_mov_b64 exec, s[48:49]
    v_add_u32 v52, 32, v52
    v_add_u32 v53, 128, v53
    s_branch K2_SA1
K2_SA1_E:
    s_mov_b64 exec, s[48:49]
    v_add_u32 v52, 64, v4
    v_add_u32 v53, 256, v22
    s_mov_b32 s13, 1024000
K2_SA2:
    v_cmp_lt_u32 vcc, v52, v26
    s_and_saveexec_b64 s[48:49], vcc
    s_cbranch_execz K2_SA2_E
    buffer_load_dword v54, v53, s[20:23], s13 offen
    s_waitcnt vmcnt(0)
    v_lshrrev_b32 v54, 14, v54
    v_and_b32 v54, 0xffc, v54
    ds_add_u32 v54, v18 offset:4096
    s_mov_b64 exec, s[48:49]
    v_add_u32 v52, 32, v52
    v_add_u32 v53, 128, v53
    s_branch K2_SA2
K2_SA2_E:
    s_mov_b64 exec, s[48:49]
    v_add_u32 v52, 64, v4
    v_add_u32 v53, 256, v23
    s_mov_b32 s13, 1536000
K2_SA3:
    v_cmp_lt_u32 vcc, v52, v27
    s_and_saveexec_b64 s[48:49], vcc
    s_cbranch_execz K2_SA3_E
    buffer_load_dword v54, v53, s[20:23], s13 offen
    s_waitcnt vmcnt(0)
    v_lshrrev_b32 v54, 14, v54
    v_and_b32 v54, 0xffc, v54
    ds_add_u32 v54, v18 offset:4096
    s_mov_b64 exec, s[48:49]
    v_add_u32 v52, 32, v52
    v_add_u32 v53, 128, v53
    s_branch K2_SA3
K2_SA3_E:
    s_mov_b64 exec, s[48:49]
K2_NOSLOWA:
    s_waitcnt lgkmcnt(0)
    s_barrier
    s_mul_i32 s50, s10, 9363
    s_lshr_b32 s50, s50, 16
    s_mul_i32 s50, s50, 7
    s_sub_u32 s50, s10, s50
    s_mul_i32 s50, s50, 448
    v_lshlrev_b32 v52, 2, v0
    v_add_u32 v60, s50, v0
    s_cmp_ge_u32 s3, 7
    s_cbranch_scc1 K2_SKIP2
    v_lshlrev_b32 v1, 2, v4
    v_add_u32 v5, 1024, v1
    ds_read2st64_b32 v[54:55], v52 offset0:0 offset1:16
    ds_read2st64_b32 v[56:57], v52 offset0:8 offset1:24
    ds_read_b32 v17, v18 offset:12287
    ds_read2_b32 v[8:9], v1 offset0:0 offset1:32
    ds_read2_b32 v[10:11], v1 offset0:64 offset1:96
    ds_read2_b32 v[12:13], v1 offset0:128 offset1:160
    ds_read2_b32 v[14:15], v1 offset0:192 offset1:224
    ds_read2_b32 v[58:59], v5 offset0:0 offset1:32
    ds_read2_b32 v[62:63], v5 offset0:64 offset1:96
    s_waitcnt lgkmcnt(6)
    v_add_u32 v53, v54, v55
    v_add_u32 v6, v56, v57
    v_readfirstlane_b32 s13, v17
    ds_read2_b32 v[56:57], v5 offset0:128 offset1:160
    v_lshl_add_u32 v54, v53, 4, v3
    v_mov_b32 v55, 0
    s_cmp_eq_u32 s13, 0
    s_waitcnt lgkmcnt(0)
    s_cbranch_scc1 K2_NOC2
    ds_read_b32 v17, v1 offset:4096
    s_waitcnt lgkmcnt(0)
    v_add_u32 v8, v8, v17
    ds_read_b32 v17, v1 offset:4224
    s_waitcnt lgkmcnt(0)
    v_add_u32 v9, v9, v17
    ds_read_b32 v17, v1 offset:4352
    s_waitcnt lgkmcnt(0)
    v_add_u32 v10, v10, v17
    ds_read_b32 v17, v1 offset:4480
    s_waitcnt lgkmcnt(0)
    v_add_u32 v11, v11, v17
    ds_read_b32 v17, v1 offset:4608
    s_waitcnt lgkmcnt(0)
    v_add_u32 v12, v12, v17
    ds_read_b32 v17, v1 offset:4736
    s_waitcnt lgkmcnt(0)
    v_add_u32 v13, v13, v17
    ds_read_b32 v17, v1 offset:4864
    s_waitcnt lgkmcnt(0)
    v_add_u32 v14, v14, v17
    ds_read_b32 v17, v1 offset:4992
    s_waitcnt lgkmcnt(0)
    v_add_u32 v15, v15, v17
    ds_read_b32 v17, v1 offset:5120
    s_waitcnt lgkmcnt(0)
    v_add_u32 v58, v58, v17
    ds_read_b32 v17, v1 offset:5248
    s_waitcnt lgkmcnt(0)
    v_add_u32 v59, v59, v17
    ds_read_b32 v17, v1 offset:5376
    s_waitcnt lgkmcnt(0)
    v_add_u32 v62, v62, v17
    ds_read_b32 v17, v1 offset:5504
    s_waitcnt lgkmcnt(0)
    v_add_u32 v63, v63, v17
    ds_read_b32 v17, v1 offset:5632
    s_waitcnt lgkmcnt(0)
    v_add_u32 v56, v56, v17
    ds_read_b32 v17, v1 offset:5760
    s_waitcnt lgkmcnt(0)
    v_add_u32 v57, v57, v17
K2_NOC2:
    v_lshl_add_u32 v8, v8, 4, 0
    v_lshl_add_u32 v9, v9, 4, 1
    v_lshl_add_u32 v10, v10, 4, 2
    v_lshl_add_u32 v11, v11, 4, 3
    v_lshl_add_u32 v12, v12, 4, 4
    v_lshl_add_u32 v13, v13, 4, 5
    v_lshl_add_u32 v14, v14, 4, 6
    v_lshl_add_u32 v15, v15, 4, 7
    v_lshl_add_u32 v58, v58, 4, 8
    v_lshl_add_u32 v59, v59, 4, 9
    v_lshl_add_u32 v62, v62, 4, 10
    v_lshl_add_u32 v63, v63, 4, 11
    v_lshl_add_u32 v56, v56, 4, 12
    v_lshl_add_u32 v57, v57, 4, 13
    v_cmp_lt_u32 vcc, v8, v54
    v_cmp_lt_u32 s[48:49], v9, v54
    s_nop 0
    v_addc_co_u32 v55, vcc, 0, v55, vcc
    v_addc_co_u32 v55, vcc, 0, v55, s[48:49]
    v_cmp_lt_u32 vcc, v10, v54
    v_cmp_lt_u32 s[48:49], v11, v54
    s_nop 0
    v_addc_co_u32 v55, vcc, 0, v55, vcc
    v_addc_co_u32 v55, vcc, 0, v55, s[48:49]
    v_cmp_lt_u32 vcc, v12, v54
    v_cmp_lt_u32 s[48:49], v13, v54
    s_nop 0
    v_addc_co_u32 v55, vcc, 0, v55, vcc
    v_addc_co_u32 v55, vcc, 0, v55, s[48:49]
    v_cmp_lt_u32 vcc, v14, v54
    v_cmp_lt_u32 s[48:49], v15, v54
    s_nop 0
    v_addc_co_u32 v55, vcc, 0, v55, vcc
    v_addc_co_u32 v55, vcc, 0, v55, s[48:49]
    v_cmp_lt_u32 vcc, v58, v54
    v_cmp_lt_u32 s[48:49], v59, v54
    s_nop 0
    v_addc_co_u32 v55, vcc, 0, v55, vcc
    v_addc_co_u32 v55, vcc, 0, v55, s[48:49]
    v_cmp_lt_u32 vcc, v62, v54
    v_cmp_lt_u32 s[48:49], v63, v54
    s_nop 0
    v_addc_co_u32 v55, vcc, 0, v55, vcc
    v_addc_co_u32 v55, vcc, 0, v55, s[48:49]
    v_cmp_lt_u32 vcc, v56, v54
    v_cmp_lt_u32 s[48:49], v57, v54
    s_nop 0
    v_addc_co_u32 v55, vcc, 0, v55, vcc
    v_addc_co_u32 v55, vcc, 0, v55, s[48:49]
    v_mov_b32 v57, v55
    v_lshrrev_b32 v58, 1, v57
    v_and_b32 v57, 1, v57
    v_lshl_add_u32 v57, v57, 5, v4
    v_lshlrev_b32 v59, 2, v58
    ds_max_u32 v59, v53 offset:12544
    ds_max_u32 v59, v6 offset:12576
    v_add_u32 v61, s64, v53
    v_bfm_b32 v61, v61, 0
    v_bfm_b32 v6, v6, 0
    ds_write2st64_b32 v52, v61, v6 offset0:166 offset1:174
    s_mov_b32 s48, 0x1d220c27
    s_mov_b32 s49, 0x1806
    s_mov_b32 s13, 0x6565565
    s_mov_b32 s15, 0x30415627
    v_lshlrev_b32 v61, 1, v59
    v_lshrrev_b64 v[62:63], v61, s[66:67]
    v_lshrrev_b64 v[54:55], v61, s[48:49]
    v_lshrrev_b32 v61, v59, s68
    v_lshrrev_b32 v56, v59, s13
    v_mul_u32_u24 v63, 400, v57
    v_lshl_or_b32 v63, v58, 28, v63
    v_lshrrev_b32 v55, 5, v57
    v_lshl_or_b32 v63, v55, 27, v63
    v_and_b32 v62, 0xff, v62
    v_and_b32 v54, 0xff, v54
    v_and_b32 v61, 15, v61
    v_and_b32 v56, 15, v56
    v_lshl_add_u32 v62, v62, 2, v63
    v_lshl_or_b32 v61, v61, 15, v62
    v_lshl_add_u32 v54, v54, 2, v63
    v_lshl_or_b32 v54, v56, 15, v54
    v_add_u32 v54, 0x800000c0, v54
    ds_write2st64_b32 v52, v61, v54 offset0:50 offset1:58
    v_lshrrev_b32 v62, v59, s15
    s_cmp_eq_u32 s11, 1
    s_cbranch_scc1 K2_NOSCALE
    s_cmp_eq_u32 s11, 0
    s_cbranch_scc1 K2_DST
    s_add_u32 s52, s8, 0x34b0000
    s_addc_u32 s53, s9, 0
    s_mov_b32 s54, 0x1c000
    s_mov_b32 s55, 0x20000
    v_and_b32 v62, 15, v62
    v_lshlrev_b32 v62, 8, v62
    v_lshl_add_u32 v62, v57, 2, v62
    s_lshl_b32 s51, s10, 11
    v_lshlrev_b32 v16, 16, v16
    v_mul_f32 v16, v16, v16
    buffer_store_dword v16, v62, s[52:55], s51 offen
    s_branch K2_NOSCALE
K2_DST:
    s_add_u32 s52, s8, 0x3540000
    s_addc_u32 s53, s9, 0
    s_mov_b32 s54, 0xe000
    s_mov_b32 s55, 0x20000
    v_and_b32 v63, 3, v62
    v_bfe_u32 v62, v62, 2, 1
    v_lshlrev_b32 v62, 9, v62
    v_lshl_add_u32 v62, v57, 3, v62
    v_lshl_add_u32 v62, v63, 1, v62
    s_lshl_b32 s51, s10, 10
    buffer_store_short v60, v62, s[52:55], s51 offen
K2_NOSCALE:
    s_waitcnt lgkmcnt(0)
K2_SKIP2:
    s_barrier
    v_and_b32 v52, 15, v2
    v_lshlrev_b32 v52, 2, v52
    ds_read_b32 v53, v52 offset:12544
    ds_read_b32 v1, v18 offset:12287
    s_mov_b64 exec, s[30:31]
    ds_read_b32 v36, v36 offset:12800
    s_mov_b64 exec, s[32:33]
    ds_read_b32 v37, v37 offset:12800
    s_mov_b64 exec, s[34:35]
    ds_read_b32 v38, v38 offset:12800
    s_mov_b64 exec, s[36:37]
    ds_read_b32 v39, v39 offset:12800
    s_mov_b64 exec, s[38:39]
    ds_read_b32 v40, v40 offset:12800
    s_mov_b64 exec, s[40:41]
    ds_read_b32 v41, v41 offset:12800
    s_mov_b64 exec, s[42:43]
    ds_read_b32 v42, v42 offset:12800
    s_mov_b64 exec, s[44:45]
    ds_read_b32 v43, v43 offset:12800
    s_mov_b64 exec, -1
    s_mov_b32 s48, s68
    s_mov_b32 s49, 0x6565565
    v_lshrrev_b64 v[54:55], v52, s[48:49]
    v_and_b32 v55, 15, v54
    v_mov_b32 v56, s64
    v_cmp_gt_u32 vcc, 32, v52
    s_nop 1
    v_cndmask_b32 v56, 0, v56, vcc
    s_waitcnt lgkmcnt(0)
    v_add3_u32 v53, v53, v56, 1
    v_lshrrev_b32 v53, 1, v53
    v_cmp_ne_u32 vcc, 0, v55
    s_nop 1
    v_cndmask_b32 v53, 0, v53, vcc
    v_sub_u32 v54, v53, v55
    v_max_i32 v54, 0, v54
    v_cmp_ne_u32 vcc, 0, v54
    s_mov_b32 s48, s71
    s_mov_b32 s49, 0x3333333
    v_lshrrev_b64 v[56:57], v52, s[48:49]
    v_and_b32 v56, 15, v56
    v_max_u32 v56, v56, v53
    v_lshlrev_b32 v56, 1, v56
    v_bfm_b32 v56, v56, 0
    ds_write_b32 v52, v56 offset:12688
    v_mov_b32 v56, 0
    v_readfirstlane_b32 s72, v1
    s_add_u32 s56, s8, 0x4100000
    s_addc_u32 s57, s9, 0
    s_mov_b32 s58, 0x3400000
    s_mov_b32 s59, 0x20000
    s_cbranch_vccz K2_NOOVF
    s_mov_b32 s72, 1
    v_mov_b32 v57, v54
    s_nop 1
    v_add_u32_dpp v57, v57, v57 row_shr:1 row_mask:0xf bank_mask:0xf bound_ctrl:0
    s_nop 1
    v_add_u32_dpp v57, v57, v57 row_shr:2 row_mask:0xf bank_mask:0xf bound_ctrl:0
    s_nop 1
    v_add_u32_dpp v57, v57, v57 row_shr:4 row_mask:0xf bank_mask:0xf bound_ctrl:0
    s_nop 1
    v_add_u32_dpp v57, v57, v57 row_shr:8 row_mask:0xf bank_mask:0xf bound_ctrl:0
    s_nop 1
    v_readlane_b32 s60, v57, 15
    v_readlane_b32 s65, v57, 7
    v_sub_u32 v57, v57, v54
    s_lshl_b32 s60, s60, 8
    s_lshl_b32 s65, s65, 8
    s_cmp_lg_u32 s3, 0
    s_cbranch_scc1 K2_OV1
    s_mov_b64 exec, 1
    v_mov_b32 v58, s60
    v_mov_b32 v59, 0
    global_atomic_add v58, v59, v58, s[6:7] sc0 sc1
    s_waitcnt vmcnt(0)
    ds_write_b32 v59, v58 offset:12672
    s_waitcnt lgkmcnt(0)
    s_mov_b64 exec, -1
K2_OV1:
    s_barrier
    v_mov_b32 v59, 0
    ds_read_b32 v58, v59 offset:12672
    s_waitcnt lgkmcnt(0)
    s_nop 0
    v_readfirstlane_b32 s61, v58
    v_lshl_add_u32 v56, v57, 8, v58
    ds_write_b32 v52, v56 offset:12608
    v_lshlrev_b32 v59, 2, v0
    v_mov_b32 v62, 0x1f801f80
    v_mov_b32 v63, 0xc400c40
K2_OVF_FILL:
    v_cmp_gt_u32 s[48:49], s65, v59
    v_cmp_gt_u32 vcc, s60, v59
    s_nop 0
    v_cndmask_b32 v58, v63, v62, s[48:49]
    s_and_saveexec_b64 s[48:49], vcc
    s_cbranch_execz K2_OVF_FILL_E
    buffer_store_dword v58, v59, s[56:59], s61 offen
    s_mov_b64 exec, s[48:49]
    s_nop 0
    v_add_u32 v59, 4096, v59
    s_branch K2_OVF_FILL
K2_OVF_FILL_E:
    s_mov_b64 exec, s[48:49]
    s_waitcnt vmcnt(0) lgkmcnt(0)
    s_barrier
K2_NOOVF:
    s_cmp_lg_u32 s3, 8
    s_cbranch_scc1 K2_NOHDR
    s_add_u32 s52, s8, 0x34d0000
    s_addc_u32 s53, s9, 0
    s_mov_b32 s54, 0x3800
    s_mov_b32 s55, 0x20000
    s_mov_b32 s15, 0x30415627
    v_and_b32 v57, 28, v52
    v_lshrrev_b32 v57, v57, s15
    v_and_b32 v58, 3, v57
    v_bfe_u32 v57, v57, 2, 1
    v_lshlrev_b32 v57, 7, v57
    v_lshl_add_u32 v57, v58, 2, v57
    s_lshl_b32 s62, s11, 4
    s_add_u32 s62, s62, 16
    v_mov_b32 v58, s62
    v_cmp_gt_u32 vcc, 32, v52
    s_lshl_b32 s51, s10, 8
    s_movk_i32 s62, 0xff
    s_cmp_eq_u32 s11, 0
    v_cndmask_b32 v58, 0, v58, vcc
    s_cselect_b32 s62, 0xffff, s62
    v_add_u32 v57, v57, v58
    s_mov_b32 exec_lo, s62
    s_mov_b32 exec_hi, 0
    buffer_store_dword v53, v57, s[52:55], s51 offen
    buffer_store_dword v56, v57, s[52:55], s51 offen offset:64
    s_mov_b64 exec, -1
K2_NOHDR:
    s_cmp_ge_u32 s3, 7
    s_cbranch_scc1 K2_PL_N
    s_cmp_eq_u32 s11, 0
    s_cbranch_scc1 K2_PL_N
    v_mov_b32 v55, 0
    v_and_b32 v57, 0x7fff, v61
    v_bfe_u32 v59, v61, 15, 5
    v_mul_u32_u24 v58, 5243, v57
    v_lshlrev_b32 v59, 1, v59
    v_lshl_add_u32 v57, v55, 1, v57
    v_cmp_lt_u32 vcc, v55, v59
    v_lshrrev_b32 v58, 21, v58
    s_and_saveexec_b64 s[48:49], vcc
    ds_write_b16 v57, v60 offset:16896
    s_andn2_b64 exec, s[48:49], exec
    s_cbranch_execz K2_PL_N
    v_lshrrev_b32 v57, 26, v61
    v_and_b32 v57, 0x3c, v57
    ds_read_b32 v57, v57 offset:12608
    v_sub_u32 v55, v55, v59
    v_lshrrev_b32 v59, 1, v55
    v_and_b32 v55, 1, v55
    s_waitcnt lgkmcnt(0)
    v_lshl_add_u32 v57, v59, 8, v57
    v_lshl_add_u32 v57, v58, 2, v57
    v_lshl_add_u32 v57, v55, 1, v57
    buffer_store_short v60, v57, s[56:59], 0 offen
K2_PL_N:
    s_mov_b64 exec, -1
    s_cmp_lg_u32 s72, 0
    s_cbranch_scc1 K2_SIMPLE
    s_mov_b64 exec, s[30:31]
    v_add_u32 v44, s64, v44
    v_lshrrev_b32 v57, 20, v36
    v_and_b32 v59, 31, v28
    v_lshlrev_b32 v12, v44, v18
    v_lshl_or_b32 v57, v59, 2, v57
    ds_or_rtn_b32 v52, v57, v12 offset:46592
K2_G1_0:
    s_mov_b64 exec, s[32:33]
    v_add_u32 v45, s64, v45
    v_lshrrev_b32 v57, 20, v37
    v_and_b32 v59, 31, v29
    v_lshlrev_b32 v13, v45, v18
    v_lshl_or_b32 v57, v59, 2, v57
    ds_or_rtn_b32 v53, v57, v13 offset:46592
K2_G1_1:
    s_mov_b64 exec, s[34:35]
    v_add_u32 v46, s64, v46
    v_lshrrev_b32 v57, 20, v38
    v_and_b32 v59, 31, v30
    v_lshlrev_b32 v14, v46, v18
    v_lshl_or_b32 v57, v59, 2, v57
    ds_or_rtn_b32 v54, v57, v14 offset:46592
K2_G1_2:
    s_mov_b64 exec, s[36:37]
    s_cbranch_execz K2_G1_3
    v_add_u32 v47, s64, v47
    v_lshrrev_b32 v57, 20, v39
    v_and_b32 v59, 31, v31
    v_lshlrev_b32 v15, v47, v18
    v_lshl_or_b32 v57, v59, 2, v57
    ds_or_rtn_b32 v55, v57, v15 offset:46592
K2_G1_3:
    s_mov_b64 exec, s[38:39]
    s_cbranch_execz K2_G1_4
    v_add_u32 v48, s64, v48
    v_lshrrev_b32 v57, 20, v40
    v_and_b32 v59, 31, v32
    v_lshlrev_b32 v8, v48, v18
    v_lshl_or_b32 v57, v59, 2, v57
    ds_or_rtn_b32 v5, v57, v8 offset:46592
K2_G1_4:
    s_mov_b64 exec, s[40:41]
    s_cbranch_execz K2_G1_5
    v_add_u32 v49, s64, v49
    v_lshrrev_b32 v57, 20, v41
    v_and_b32 v59, 31, v33
    v_lshlrev_b32 v9, v49, v18
    v_lshl_or_b32 v57, v59, 2, v57
    ds_or_rtn_b32 v6, v57, v9 offset:46592
K2_G1_5:
    s_mov_b64 exec, s[42:43]
    s_cbranch_execz K2_G1_6
    v_add_u32 v50, s64, v50
    v_lshrrev_b32 v57, 20, v42
    v_and_b32 v59, 31, v34
    v_lshlrev_b32 v10, v50, v18
    v_lshl_or_b32 v57, v59, 2, v57
    ds_or_rtn_b32 v17, v57, v10 offset:46592
K2_G1_6:
    s_mov_b64 exec, s[44:45]
    s_cbranch_execz K2_G1_7
    v_add_u32 v51, s64, v51
    v_lshrrev_b32 v57, 20, v43
    v_and_b32 v59, 31, v35
    v_lshlrev_b32 v11, v51, v18
    v_lshl_or_b32 v57, v59, 2, v57
    ds_or_rtn_b32 v19, v57, v11 offset:46592
K2_G1_7:
    s_mul_i32 s74, s3, 4096
    s_add_u32 s74, s74, 50688
    s_mov_b32 s73, s74
    s_waitcnt lgkmcnt(0)
    s_mov_b64 exec, s[30:31]
    v_and_b32 v57, v52, v12
    v_lshrrev_b32 v58, 14, v28
    v_cmp_ne_u32 vcc, 0, v57
    v_and_b32 v58, 0xffc, v58
    v_mov_b32 v62, v28
    v_mov_b32 v63, v36
    v_mbcnt_lo_u32_b32 v59, vcc_lo, 0
    v_mbcnt_hi_u32_b32 v59, vcc_hi, v59
    s_bcnt1_i32_b64 s13, vcc
    v_lshl_add_u32 v59, v59, 3, s73
    s_and_saveexec_b64 s[48:49], vcc
    ds_xor_b32 v58, v12 offset:42496
    ds_write_b64 v59, v[62:63]
    s_lshl3_add_u32 s73, s13, s73
    s_andn2_b64 exec, s[48:49], vcc
    v_and_b32 v57, 0x7fff, v36
    v_lshl_add_u32 v57, v44, 1, v57
    ds_write_b16 v57, v28 offset:16896
K2_PL_G0:
    s_mov_b64 exec, s[32:33]
    v_and_b32 v57, v53, v13
    v_lshrrev_b32 v58, 14, v29
    v_cmp_ne_u32 vcc, 0, v57
    v_and_b32 v58, 0xffc, v58
    v_mov_b32 v62, v29
    v_mov_b32 v63, v37
    v_mbcnt_lo_u32_b32 v59, vcc_lo, 0
    v_mbcnt_hi_u32_b32 v59, vcc_hi, v59
    s_bcnt1_i32_b64 s13, vcc
    v_lshl_add_u32 v59, v59, 3, s73
    s_and_saveexec_b64 s[48:49], vcc
    ds_xor_b32 v58, v13 offset:42496
    ds_write_b64 v59, v[62:63]
    s_lshl3_add_u32 s73, s13, s73
    s_andn2_b64 exec, s[48:49], vcc
    v_and_b32 v57, 0x7fff, v37
    v_lshl_add_u32 v57, v45, 1, v57
    ds_write_b16 v57, v29 offset:16896
K2_PL_G1:
    s_mov_b64 exec, s[34:35]
    v_and_b32 v57, v54, v14
    v_lshrrev_b32 v58, 14, v30
    v_cmp_ne_u32 vcc, 0, v57
    v_and_b32 v58, 0xffc, v58
    v_mov_b32 v62, v30
    v_mov_b32 v63, v38
    v_mbcnt_lo_u32_b32 v59, vcc_lo, 0
    v_mbcnt_hi_u32_b32 v59, vcc_hi, v59
    s_bcnt1_i32_b64 s13, vcc
    v_lshl_add_u32 v59, v59, 3, s73
    s_and_saveexec_b64 s[48:49], vcc
    ds_xor_b32 v58, v14 offset:42496
    ds_write_b64 v59, v[62:63]
    s_lshl3_add_u32 s73, s13, s73
    s_andn2_b64 exec, s[48:49], vcc
    v_and_b32 v57, 0x7fff, v38
    v_lshl_add_u32 v57, v46, 1, v57
    ds_write_b16 v57, v30 offset:16896
K2_PL_G2:
    s_mov_b64 exec, s[36:37]
    s_cbranch_execz K2_PL_G3
    v_and_b32 v57, v55, v15
    v_lshrrev_b32 v58, 14, v31
    v_cmp_ne_u32 vcc, 0, v57
    v_and_b32 v58, 0xffc, v58
    v_mov_b32 v62, v31
    v_mov_b32 v63, v39
    v_mbcnt_lo_u32_b32 v59, vcc_lo, 0
    v_mbcnt_hi_u32_b32 v59, vcc_hi, v59
    s_bcnt1_i32_b64 s13, vcc
    v_lshl_add_u32 v59, v59, 3, s73
    s_and_saveexec_b64 s[48:49], vcc
    ds_xor_b32 v58, v15 offset:42496
    ds_write_b64 v59, v[62:63]
    s_lshl3_add_u32 s73, s13, s73
    s_andn2_b64 exec, s[48:49], vcc
    v_and_b32 v57, 0x7fff, v39
    v_lshl_add_u32 v57, v47, 1, v57
    ds_write_b16 v57, v31 offset:16896
K2_PL_G3:
    s_mov_b64 exec, s[38:39]
    s_cbranch_execz K2_PL_G4
    v_and_b32 v57, v5, v8
    v_lshrrev_b32 v58, 14, v32
    v_cmp_ne_u32 vcc, 0, v57
    v_and_b32 v58, 0xffc, v58
    v_mov_b32 v62, v32
    v_mov_b32 v63, v40
    v_mbcnt_lo_u32_b32 v59, vcc_lo, 0
    v_mbcnt_hi_u32_b32 v59, vcc_hi, v59
    s_bcnt1_i32_b64 s13, vcc
    v_lshl_add_u32 v59, v59, 3, s73
    s_and_saveexec_b64 s[48:49], vcc
    ds_xor_b32 v58, v8 offset:42496
    ds_write_b64 v59, v[62:63]
    s_lshl3_add_u32 s73, s13, s73
    s_andn2_b64 exec, s[48:49], vcc
    v_and_b32 v57, 0x7fff, v40
    v_lshl_add_u32 v57, v48, 1, v57
    ds_write_b16 v57, v32 offset:16896
K2_PL_G4:
    s_mov_b64 exec, s[40:41]
    s_cbranch_execz K2_PL_G5
    v_and_b32 v57, v6, v9
    v_lshrrev_b32 v58, 14, v33
    v_cmp_ne_u32 vcc, 0, v57
    v_and_b32 v58, 0xffc, v58
    v_mov_b32 v62, v33
    v_mov_b32 v63, v41
    v_mbcnt_lo_u32_b32 v59, vcc_lo, 0
    v_mbcnt_hi_u32_b32 v59, vcc_hi, v59
    s_bcnt1_i32_b64 s13, vcc
    v_lshl_add_u32 v59, v59, 3, s73
    s_and_saveexec_b64 s[48:49], vcc
    ds_xor_b32 v58, v9 offset:42496
    ds_write_b64 v59, v[62:63]
    s_lshl3_add_u32 s73, s13, s73
    s_andn2_b64 exec, s[48:49], vcc
    v_and_b32 v57, 0x7fff, v41
    v_lshl_add_u32 v57, v49, 1, v57
    ds_write_b16 v57, v33 offset:16896
K2_PL_G5:
    s_mov_b64 exec, s[42:43]
    s_cbranch_execz K2_PL_G6
    v_and_b32 v57, v17, v10
    v_lshrrev_b32 v58, 14, v34
    v_cmp_ne_u32 vcc, 0, v57
    v_and_b32 v58, 0xffc, v58
    v_mov_b32 v62, v34
    v_mov_b32 v63, v42
    v_mbcnt_lo_u32_b32 v59, vcc_lo, 0
    v_mbcnt_hi_u32_b32 v59, vcc_hi, v59
    s_bcnt1_i32_b64 s13, vcc
    v_lshl_add_u32 v59, v59, 3, s73
    s_and_saveexec_b64 s[48:49], vcc
    ds_xor_b32 v58, v10 offset:42496
    ds_write_b64 v59, v[62:63]
    s_lshl3_add_u32 s73, s13, s73
    s_andn2_b64 exec, s[48:49], vcc
    v_and_b32 v57, 0x7fff, v42
    v_lshl_add_u32 v57, v50, 1, v57
    ds_write_b16 v57, v34 offset:16896
K2_PL_G6:
    s_mov_b64 exec, s[44:45]
    s_cbranch_execz K2_PL_G7
    v_and_b32 v57, v19, v11
    v_lshrrev_b32 v58, 14, v35
    v_cmp_ne_u32 vcc, 0, v57
    v_and_b32 v58, 0xffc, v58
    v_mov_b32 v62, v35
    v_mov_b32 v63, v43
    v_mbcnt_lo_u32_b32 v59, vcc_lo, 0
    v_mbcnt_hi_u32_b32 v59, vcc_hi, v59
    s_bcnt1_i32_b64 s13, vcc
    v_lshl_add_u32 v59, v59, 3, s73
    s_and_saveexec_b64 s[48:49], vcc
    ds_xor_b32 v58, v11 offset:42496
    ds_write_b64 v59, v[62:63]
    s_lshl3_add_u32 s73, s13, s73
    s_andn2_b64 exec, s[48:49], vcc
    v_and_b32 v57, 0x7fff, v43
    v_lshl_add_u32 v57, v51, 1, v57
    ds_write_b16 v57, v35 offset:16896
K2_PL_G7:
    s_mov_b64 exec, -1
    v_lshl_add_u32 v21, v2, 3, s74
K2_GL:
    v_cmp_gt_u32 vcc, s73, v21
    s_and_saveexec_b64 s[62:63], vcc
    s_cbranch_execz K2_GE
    ds_read_b64 v[28:29], v21
    s_mov_b32 s75, 0
    s_mov_b64 s[30:31], exec
    s_waitcnt lgkmcnt(0)
    v_lshrrev_b32 v57, 26, v29
    v_lshrrev_b32 v22, 14, v28
    v_and_b32 v57, 0x3c, v57
    v_and_b32 v22, 0xffc, v22
    ds_read_b32 v24, v57 offset:12688
    v_and_b32 v59, 31, v28
    v_lshrrev_b32 v58, 20, v29
    v_lshl_or_b32 v23, v59, 2, v58
K2_GR:
    ds_read_b32 v25, v22 offset:42496
    ds_read_b32 v26, v23 offset:46592
    s_cmp_ge_u32 s75, 2
    s_cselect_b64 s[32:33], -1, 0
    s_add_u32 s75, s75, 1
    s_waitcnt lgkmcnt(0)
    v_bfi_b32 v25, v25, 0, v24
    v_bfi_b32 v26, v26, 0, v25
    v_cmp_eq_u32 vcc, 0, v26
    s_nop 1
    v_cndmask_b32 v26, v26, v25, vcc
    s_or_b64 s[32:33], s[32:33], vcc
    v_cmp_ne_u32 vcc, 0, v26
    v_ffbl_b32 v44, v26
    s_and_b64 exec, exec, vcc
    v_lshlrev_b32 v27, v44, v18
    ds_or_rtn_b32 v25, v22, v27 offset:42496
    ds_or_rtn_b32 v26, v23, v27 offset:46592
    s_waitcnt lgkmcnt(0)
    v_and_b32 v25, v25, v27
    v_and_b32 v26, v26, v27
    v_cmp_eq_u32 s[34:35], 0, v25
    v_cmp_eq_u32 s[36:37], 0, v26
    s_mov_b64 s[38:39], exec
    s_or_b64 s[32:33], s[32:33], s[36:37]
    s_and_b64 s[40:41], s[34:35], s[32:33]
    s_andn2_b64 s[30:31], s[30:31], s[40:41]
    s_andn2_b64 exec, s[34:35], s[32:33]
    ds_xor_b32 v22, v27 offset:42496
    s_andn2_b64 exec, s[36:37], s[34:35]
    ds_xor_b32 v23, v27 offset:46592
    s_mov_b64 exec, s[30:31]
    s_cbranch_execnz K2_GR
    s_and_b64 exec, s[62:63], s[62:63]
    v_cmp_gt_u32 vcc, s73, v21
    s_nop 0
    s_and_b64 exec, exec, vcc
    v_and_b32 v57, 0x7fff, v29
    v_lshl_add_u32 v57, v44, 1, v57
    ds_write_b16 v57, v28 offset:16896
K2_PL_GG:
    s_mov_b64 exec, s[62:63]
    v_add_u32 v21, 512, v21
    s_branch K2_GL
K2_GE:
    s_mov_b64 exec, s[62:63]
    s_branch K2_NOSLOWB
K2_SIMPLE:
    s_mov_b64 exec, s[30:31]
    v_add_u32 v44, s64, v44
    v_and_b32 v57, 0x7fff, v36
    v_bfe_u32 v59, v36, 15, 5
    v_mul_u32_u24 v58, 5243, v57
    v_lshlrev_b32 v59, 1, v59
    v_lshl_add_u32 v57, v44, 1, v57
    v_cmp_lt_u32 vcc, v44, v59
    v_lshrrev_b32 v58, 21, v58
    s_and_saveexec_b64 s[48:49], vcc
    ds_write_b16 v57, v28 offset:16896
    s_andn2_b64 exec, s[48:49], exec
    s_cbranch_execz K2_PL_0
    v_lshrrev_b32 v57, 26, v36
    v_and_b32 v57, 0x3c, v57
    ds_read_b32 v57, v57 offset:12608
    v_sub_u32 v44, v44, v59
    v_lshrrev_b32 v59, 1, v44
    v_and_b32 v44, 1, v44
    s_waitcnt lgkmcnt(0)
    v_lshl_add_u32 v57, v59, 8, v57
    v_lshl_add_u32 v57, v58, 2, v57
    v_lshl_add_u32 v57, v44, 1, v57
    buffer_store_short v28, v57, s[56:59], 0 offen
K2_PL_0:
    s_mov_b64 exec, s[32:33]
    v_add_u32 v45, s64, v45
    v_and_b32 v57, 0x7fff, v37
    v_bfe_u32 v59, v37, 15, 5
    v_mul_u32_u24 v58, 5243, v57
    v_lshlrev_b32 v59, 1, v59
    v_lshl_add_u32 v57, v45, 1, v57
    v_cmp_lt_u32 vcc, v45, v59
    v_lshrrev_b32 v58, 21, v58
    s_and_saveexec_b64 s[48:49], vcc
    ds_write_b16 v57, v29 offset:16896
    s_andn2_b64 exec, s[48:49], exec
    s_cbranch_execz K2_PL_1
    v_lshrrev_b32 v57, 26, v37
    v_and_b32 v57, 0x3c, v57
    ds_read_b32 v57, v57 offset:12608
    v_sub_u32 v45, v45, v59
    v_lshrrev_b32 v59, 1, v45
    v_and_b32 v45, 1, v45
    s_waitcnt lgkmcnt(0)
    v_lshl_add_u32 v57, v59, 8, v57
    v_lshl_add_u32 v57, v58, 2, v57
    v_lshl_add_u32 v57, v45, 1, v57
    buffer_store_short v29, v57, s[56:59], 0 offen
K2_PL_1:
    s_mov_b64 exec, s[34:35]
    v_add_u32 v46, s64, v46
    v_and_b32 v57, 0x7fff, v38
    v_bfe_u32 v59, v38, 15, 5
    v_mul_u32_u24 v58, 5243, v57
    v_lshlrev_b32 v59, 1, v59
    v_lshl_add_u32 v57, v46, 1, v57
    v_cmp_lt_u32 vcc, v46, v59
    v_lshrrev_b32 v58, 21, v58
    s_and_saveexec_b64 s[48:49], vcc
    ds_write_b16 v57, v30 offset:16896
    s_andn2_b64 exec, s[48:49], exec
    s_cbranch_execz K2_PL_2
    v_lshrrev_b32 v57, 26, v38
    v_and_b32 v57, 0x3c, v57
    ds_read_b32 v57, v57 offset:12608
    v_sub_u32 v46, v46, v59
    v_lshrrev_b32 v59, 1, v46
    v_and_b32 v46, 1, v46
    s_waitcnt lgkmcnt(0)
    v_lshl_add_u32 v57, v59, 8, v57
    v_lshl_add_u32 v57, v58, 2, v57
    v_lshl_add_u32 v57, v46, 1, v57
    buffer_store_short v30, v57, s[56:59], 0 offen
K2_PL_2:
    s_mov_b64 exec, s[36:37]
    v_add_u32 v47, s64, v47
    v_and_b32 v57, 0x7fff, v39
    v_bfe_u32 v59, v39, 15, 5
    v_mul_u32_u24 v58, 5243, v57
    v_lshlrev_b32 v59, 1, v59
    v_lshl_add_u32 v57, v47, 1, v57
    v_cmp_lt_u32 vcc, v47, v59
    v_lshrrev_b32 v58, 21, v58
    s_and_saveexec_b64 s[48:49], vcc
    ds_write_b16 v57, v31 offset:16896
    s_andn2_b64 exec, s[48:49], exec
    s_cbranch_execz K2_PL_3
    v_lshrrev_b32 v57, 26, v39
    v_and_b32 v57, 0x3c, v57
    ds_read_b32 v57, v57 offset:12608
    v_sub_u32 v47, v47, v59
    v_lshrrev_b32 v59, 1, v47
    v_and_b32 v47, 1, v47
    s_waitcnt lgkmcnt(0)
    v_lshl_add_u32 v57, v59, 8, v57
    v_lshl_add_u32 v57, v58, 2, v57
    v_lshl_add_u32 v57, v47, 1, v57
    buffer_store_short v31, v57, s[56:59], 0 offen
K2_PL_3:
    s_mov_b64 exec, s[38:39]
    s_cbranch_execz K2_PL_4
    v_add_u32 v48, s64, v48
    v_and_b32 v57, 0x7fff, v40
    v_bfe_u32 v59, v40, 15, 5
    v_mul_u32_u24 v58, 5243, v57
    v_lshlrev_b32 v59, 1, v59
    v_lshl_add_u32 v57, v48, 1, v57
    v_cmp_lt_u32 vcc, v48, v59
    v_lshrrev_b32 v58, 21, v58
    s_and_saveexec_b64 s[48:49], vcc
    ds_write_b16 v57, v32 offset:16896
    s_andn2_b64 exec, s[48:49], exec
    s_cbranch_execz K2_PL_4
    v_lshrrev_b32 v57, 26, v40
    v_and_b32 v57, 0x3c, v57
    ds_read_b32 v57, v57 offset:12608
    v_sub_u32 v48, v48, v59
    v_lshrrev_b32 v59, 1, v48
    v_and_b32 v48, 1, v48
    s_waitcnt lgkmcnt(0)
    v_lshl_add_u32 v57, v59, 8, v57
    v_lshl_add_u32 v57, v58, 2, v57
    v_lshl_add_u32 v57, v48, 1, v57
    buffer_store_short v32, v57, s[56:59], 0 offen
K2_PL_4:
    s_mov_b64 exec, s[40:41]
    s_cbranch_execz K2_PL_5
    v_add_u32 v49, s64, v49
    v_and_b32 v57, 0x7fff, v41
    v_bfe_u32 v59, v41, 15, 5
    v_mul_u32_u24 v58, 5243, v57
    v_lshlrev_b32 v59, 1, v59
    v_lshl_add_u32 v57, v49, 1, v57
    v_cmp_lt_u32 vcc, v49, v59
    v_lshrrev_b32 v58, 21, v58
    s_and_saveexec_b64 s[48:49], vcc
    ds_write_b16 v57, v33 offset:16896
    s_andn2_b64 exec, s[48:49], exec
    s_cbranch_execz K2_PL_5
    v_lshrrev_b32 v57, 26, v41
    v_and_b32 v57, 0x3c, v57
    ds_read_b32 v57, v57 offset:12608
    v_sub_u32 v49, v49, v59
    v_lshrrev_b32 v59, 1, v49
    v_and_b32 v49, 1, v49
    s_waitcnt lgkmcnt(0)
    v_lshl_add_u32 v57, v59, 8, v57
    v_lshl_add_u32 v57, v58, 2, v57
    v_lshl_add_u32 v57, v49, 1, v57
    buffer_store_short v33, v57, s[56:59], 0 offen
K2_PL_5:
    s_mov_b64 exec, s[42:43]
    s_cbranch_execz K2_PL_6
    v_add_u32 v50, s64, v50
    v_and_b32 v57, 0x7fff, v42
    v_bfe_u32 v59, v42, 15, 5
    v_mul_u32_u24 v58, 5243, v57
    v_lshlrev_b32 v59, 1, v59
    v_lshl_add_u32 v57, v50, 1, v57
    v_cmp_lt_u32 vcc, v50, v59
    v_lshrrev_b32 v58, 21, v58
    s_and_saveexec_b64 s[48:49], vcc
    ds_write_b16 v57, v34 offset:16896
    s_andn2_b64 exec, s[48:49], exec
    s_cbranch_execz K2_PL_6
    v_lshrrev_b32 v57, 26, v42
    v_and_b32 v57, 0x3c, v57
    ds_read_b32 v57, v57 offset:12608
    v_sub_u32 v50, v50, v59
    v_lshrrev_b32 v59, 1, v50
    v_and_b32 v50, 1, v50
    s_waitcnt lgkmcnt(0)
    v_lshl_add_u32 v57, v59, 8, v57
    v_lshl_add_u32 v57, v58, 2, v57
    v_lshl_add_u32 v57, v50, 1, v57
    buffer_store_short v34, v57, s[56:59], 0 offen
K2_PL_6:
    s_mov_b64 exec, s[44:45]
    s_cbranch_execz K2_PL_7
    v_add_u32 v51, s64, v51
    v_and_b32 v57, 0x7fff, v43
    v_bfe_u32 v59, v43, 15, 5
    v_mul_u32_u24 v58, 5243, v57
    v_lshlrev_b32 v59, 1, v59
    v_lshl_add_u32 v57, v51, 1, v57
    v_cmp_lt_u32 vcc, v51, v59
    v_lshrrev_b32 v58, 21, v58
    s_and_saveexec_b64 s[48:49], vcc
    ds_write_b16 v57, v35 offset:16896
    s_andn2_b64 exec, s[48:49], exec
    s_cbranch_execz K2_PL_7
    v_lshrrev_b32 v57, 26, v43
    v_and_b32 v57, 0x3c, v57
    ds_read_b32 v57, v57 offset:12608
    v_sub_u32 v51, v51, v59
    v_lshrrev_b32 v59, 1, v51
    v_and_b32 v51, 1, v51
    s_waitcnt lgkmcnt(0)
    v_lshl_add_u32 v57, v59, 8, v57
    v_lshl_add_u32 v57, v58, 2, v57
    v_lshl_add_u32 v57, v51, 1, v57
    buffer_store_short v35, v57, s[56:59], 0 offen
K2_PL_7:
    s_mov_b64 exec, -1
    s_cmp_eq_u64 s[46:47], 0
    s_cbranch_scc1 K2_NOSLOWB
    v_add_u32 v52, 64, v4
    v_add_u32 v53, 256, v20
    s_mov_b32 s13, 0
K2_SB0:
    v_cmp_lt_u32 vcc, v52, v24
    s_and_saveexec_b64 s[62:63], vcc
    s_cbranch_execz K2_SB0_E
    buffer_load_dword v28, v53, s[20:23], s13 offen
    s_waitcnt vmcnt(0)
    v_lshrrev_b32 v54, 14, v28
    v_and_b32 v54, 0xffc, v54
    ds_add_rtn_u32 v44, v54, v18 offset:8192
    ds_read_b32 v45, v54
    ds_read_b32 v36, v54 offset:12800
    s_waitcnt lgkmcnt(0)
    v_add3_u32 v44, v44, v45, s64
    v_and_b32 v57, 0x7fff, v36
    v_bfe_u32 v59, v36, 15, 5
    v_mul_u32_u24 v58, 5243, v57
    v_lshlrev_b32 v59, 1, v59
    v_lshl_add_u32 v57, v44, 1, v57
    v_cmp_lt_u32 vcc, v44, v59
    v_lshrrev_b32 v58, 21, v58
    s_and_saveexec_b64 s[48:49], vcc
    ds_write_b16 v57, v28 offset:16896
    s_andn2_b64 exec, s[48:49], exec
    s_cbranch_execz K2_PL_S0
    v_lshrrev_b32 v57, 26, v36
    v_and_b32 v57, 0x3c, v57
    ds_read_b32 v57, v57 offset:12608
    v_sub_u32 v44, v44, v59
    v_lshrrev_b32 v59, 1, v44
    v_and_b32 v44, 1, v44
    s_waitcnt lgkmcnt(0)
    v_lshl_add_u32 v57, v59, 8, v57
    v_lshl_add_u32 v57, v58, 2, v57
    v_lshl_add_u32 v57, v44, 1, v57
    buffer_store_short v28, v57, s[56:59], 0 offen
K2_PL_S0:
    s_mov_b64 exec, s[62:63]
    v_add_u32 v52, 32, v52
    v_add_u32 v53, 128, v53
    s_branch K2_SB0
K2_SB0_E:
    s_mov_b64 exec, s[62:63]
    v_add_u32 v52, 64, v4
    v_add_u32 v53, 256, v21
    s_mov_b32 s13, 512000
K2_SB1:
    v_cmp_lt_u32 vcc, v52, v25
    s_and_saveexec_b64 s[62:63], vcc
    s_cbranch_execz K2_SB1_E
    buffer_load_dword v28, v53, s[20:23], s13 offen
    s_waitcnt vmcnt(0)
    v_lshrrev_b32 v54, 14, v28
    v_and_b32 v54, 0xffc, v54
    ds_add_rtn_u32 v44, v54, v18 offset:8192
    ds_read_b32 v45, v54
    ds_read_b32 v36, v54 offset:12800
    s_waitcnt lgkmcnt(0)
    v_add3_u32 v44, v44, v45, s64
    v_and_b32 v57, 0x7fff, v36
    v_bfe_u32 v59, v36, 15, 5
    v_mul_u32_u24 v58, 5243, v57
    v_lshlrev_b32 v59, 1, v59
    v_lshl_add_u32 v57, v44, 1, v57
    v_cmp_lt_u32 vcc, v44, v59
    v_lshrrev_b32 v58, 21, v58
    s_and_saveexec_b64 s[48:49], vcc
    ds_write_b16 v57, v28 offset:16896
    s_andn2_b64 exec, s[48:49], exec
    s_cbranch_execz K2_PL_S1
    v_lshrrev_b32 v57, 26, v36
    v_and_b32 v57, 0x3c, v57
    ds_read_b32 v57, v57 offset:12608
    v_sub_u32 v44, v44, v59
    v_lshrrev_b32 v59, 1, v44
    v_and_b32 v44, 1, v44
    s_waitcnt lgkmcnt(0)
    v_lshl_add_u32 v57, v59, 8, v57
    v_lshl_add_u32 v57, v58, 2, v57
    v_lshl_add_u32 v57, v44, 1, v57
    buffer_store_short v28, v57, s[56:59], 0 offen
K2_PL_S1:
    s_mov_b64 exec, s[62:63]
    v_add_u32 v52, 32, v52
    v_add_u32 v53, 128, v53
    s_branch K2_SB1
K2_SB1_E:
    s_mov_b64 exec, s[62:63]
    v_add_u32 v52, 64, v4
    v_add_u32 v53, 256, v22
    s_mov_b32 s13, 1024000
K2_SB2:
    v_cmp_lt_u32 vcc, v52, v26
    s_and_saveexec_b64 s[62:63], vcc
    s_cbranch_execz K2_SB2_E
    buffer_load_dword v28, v53, s[20:23], s13 offen
    s_waitcnt vmcnt(0)
    v_lshrrev_b32 v54, 14, v28
    v_and_b32 v54, 0xffc, v54
    ds_add_rtn_u32 v44, v54, v18 offset:8192
    ds_read_b32 v45, v54
    ds_read_b32 v36, v54 offset:12800
    s_waitcnt lgkmcnt(0)
    v_add3_u32 v44, v44, v45, s64
    v_and_b32 v57, 0x7fff, v36
    v_bfe_u32 v59, v36, 15, 5
    v_mul_u32_u24 v58, 5243, v57
    v_lshlrev_b32 v59, 1, v59
    v_lshl_add_u32 v57, v44, 1, v57
    v_cmp_lt_u32 vcc, v44, v59
    v_lshrrev_b32 v58, 21, v58
    s_and_saveexec_b64 s[48:49], vcc
    ds_write_b16 v57, v28 offset:16896
    s_andn2_b64 exec, s[48:49], exec
    s_cbranch_execz K2_PL_S2
    v_lshrrev_b32 v57, 26, v36
    v_and_b32 v57, 0x3c, v57
    ds_read_b32 v57, v57 offset:12608
    v_sub_u32 v44, v44, v59
    v_lshrrev_b32 v59, 1, v44
    v_and_b32 v44, 1, v44
    s_waitcnt lgkmcnt(0)
    v_lshl_add_u32 v57, v59, 8, v57
    v_lshl_add_u32 v57, v58, 2, v57
    v_lshl_add_u32 v57, v44, 1, v57
    buffer_store_short v28, v57, s[56:59], 0 offen
K2_PL_S2:
    s_mov_b64 exec, s[62:63]
    v_add_u32 v52, 32, v52
    v_add_u32 v53, 128, v53
    s_branch K2_SB2
K2_SB2_E:
    s_mov_b64 exec, s[62:63]
    v_add_u32 v52, 64, v4
    v_add_u32 v53, 256, v23
    s_mov_b32 s13, 1536000
K2_SB3:
    v_cmp_lt_u32 vcc, v52, v27
    s_and_saveexec_b64 s[62:63], vcc
    s_cbranch_execz K2_SB3_E
    buffer_load_dword v28, v53, s[20:23], s13 offen
    s_waitcnt vmcnt(0)
    v_lshrrev_b32 v54, 14, v28
    v_and_b32 v54, 0xffc, v54
    ds_add_rtn_u32 v44, v54, v18 offset:8192
    ds_read_b32 v45, v54
    ds_read_b32 v36, v54 offset:12800
    s_waitcnt lgkmcnt(0)
    v_add3_u32 v44, v44, v45, s64
    v_and_b32 v57, 0x7fff, v36
    v_bfe_u32 v59, v36, 15, 5
    v_mul_u32_u24 v58, 5243, v57
    v_lshlrev_b32 v59, 1, v59
    v_lshl_add_u32 v57, v44, 1, v57
    v_cmp_lt_u32 vcc, v44, v59
    v_lshrrev_b32 v58, 21, v58
    s_and_saveexec_b64 s[48:49], vcc
    ds_write_b16 v57, v28 offset:16896
    s_andn2_b64 exec, s[48:49], exec
    s_cbranch_execz K2_PL_S3
    v_lshrrev_b32 v57, 26, v36
    v_and_b32 v57, 0x3c, v57
    ds_read_b32 v57, v57 offset:12608
    v_sub_u32 v44, v44, v59
    v_lshrrev_b32 v59, 1, v44
    v_and_b32 v44, 1, v44
    s_waitcnt lgkmcnt(0)
    v_lshl_add_u32 v57, v59, 8, v57
    v_lshl_add_u32 v57, v58, 2, v57
    v_lshl_add_u32 v57, v44, 1, v57
    buffer_store_short v28, v57, s[56:59], 0 offen
K2_PL_S3:
    s_mov_b64 exec, s[62:63]
    v_add_u32 v52, 32, v52
    v_add_u32 v53, 128, v53
    s_branch K2_SB3
K2_SB3_E:
    s_mov_b64 exec, s[62:63]
K2_NOSLOWB:
    s_waitcnt lgkmcnt(0)
    s_barrier
    s_cmp_ge_u32 s3, 12
    s_cbranch_scc1 K2_END
    ds_read_b128 v[8:11], v7 offset:16896
    ds_read_b128 v[12:15], v7 offset:17088
    v_lshlrev_b32 v16, 4, v2
    s_add_u32 s52, s8, 0x3a00000
    s_addc_u32 s53, s9, 0
    s_mov_b32 s54, 0x230000
    s_mov_b32 s55, 0x20000
    s_cmp_ge_u32 s3, 6
    s_cselect_b32 s48, 6, 0
    s_cselect_b32 s49, 20480, 0
    s_sub_u32 s48, s3, s48
    s_mul_i32 s51, s10, 40960
    s_add_u32 s51, s51, s49
    s_lshl_b32 s49, s48, 10
    s_add_u32 s51, s51, s49
    s_lshl_b32 s62, s70, 10
    s_add_u32 s62, s62, s51
    s_waitcnt lgkmcnt(0)
    s_cmp_ge_u32 s48, s69
    s_cbranch_scc1 K2_NOMAIN
    buffer_store_dwordx4 v[8:11], v16, s[52:55], s62 offen
K2_NOMAIN:
    s_cmp_lg_u32 s11, 0
    s_cbranch_scc1 K2_END
    s_cmp_ge_u32 s48, 5
    s_cbranch_scc1 K2_END
    buffer_store_dwordx4 v[12:15], v16, s[52:55], s51 offen
K2_END:
    s_endpgm
K2_WARM:
    s_and_b32 s10, s2, 7
    s_sub_u32 s11, s2, 201
    s_lshr_b32 s11, s11, 3
    s_lshl_b32 s11, s11, 4
    s_add_u32 s11, s11, s3
    s_lshl_b32 s11, s11, 10
    s_mul_i32 s10, s10, 200704
    v_lshlrev_b32 v7, 4, v2
    s_waitcnt lgkmcnt(0)
    s_add_u32 s12, s8, s10
    s_addc_u32 s13, s9, 0
    s_mov_b32 s14, 200704
    s_mov_b32 s15, 0x20000
    s_add_u32 s16, s11, 98304
    s_add_u32 s17, s11, 196608
    buffer_load_dwordx4 v[8:11], v7, s[12:15], s11 offen
    s_waitcnt vmcnt(0)
    buffer_load_dwordx4 v[12:15], v7, s[12:15], s16 offen
    s_waitcnt vmcnt(0)
    buffer_load_dwordx4 v[16:19], v7, s[12:15], s17 offen
    s_add_u32 s12, s12, 1605632
    s_addc_u32 s13, s13, 0
    buffer_load_dwordx4 v[8:11], v7, s[12:15], s11 offen
    s_waitcnt vmcnt(0)
    buffer_load_dwordx4 v[12:15], v7, s[12:15], s16 offen
    s_waitcnt vmcnt(0)
    buffer_load_dwordx4 v[16:19], v7, s[12:15], s17 offen
    s_add_u32 s12, s12, 1605632
    s_addc_u32 s13, s13, 0
    buffer_load_dwordx4 v[8:11], v7, s[12:15], s11 offen
    s_waitcnt vmcnt(0)
    buffer_load_dwordx4 v[12:15], v7, s[12:15], s16 offen
    s_waitcnt vmcnt(0)
    buffer_load_dwordx4 v[16:19], v7, s[12:15], s17 offen
    s_add_u32 s12, s12, 1605632
    s_addc_u32 s13, s13, 0
    buffer_load_dwordx4 v[8:11], v7, s[12:15], s11 offen
    s_waitcnt vmcnt(0)
    buffer_load_dwordx4 v[12:15], v7, s[12:15], s16 offen
    s_waitcnt vmcnt(0)
    buffer_load_dwordx4 v[16:19], v7, s[12:15], s17 offen
    s_endpgm
W2_START:
    s_cmp_lg_u32 s3, 0
    s_cbranch_scc1 W2_END
    s_waitcnt lgkmcnt(0)
    s_load_dwordx2 s[6:7], s[0:1], 64
    s_sub_u32 s4, s2, 168
    s_bfe_u32 s10, s4, 0x30001
    s_and_b32 s11, s4, 1
    v_and_b32 v4, 15, v2
    v_lshrrev_b32 v5, 4, v2
    v_lshrrev_b32 v6, 2, v4
    v_and_b32 v7, 3, v4
    v_lshl_add_u32 v6, v6, 3, v7
    v_lshlrev_b32 v3, 8, v6
    v_lshl_add_u32 v3, v5, 4, v3
    s_lshr_b32 s12, s10, 1
    s_and_b32 s13, s10, 1
    s_lshl_b32 s12, s12, 5
    s_lshl_b32 s13, s13, 2
    s_add_u32 s12, s12, s13
    v_add_lshl_u32 v8, v6, s12, 2
    v_lshlrev_b32 v9, 5, v5
    s_lshl_b32 s14, s11, 8
    v_add_u32 v9, s14, v9
    v_lshlrev_b32 v11, 4, v2
    s_lshl_b32 s15, s11, 14
    s_add_u32 s16, s15, 8192
    s_lshl_b32 s17, s12, 8
    v_lshlrev_b32 v13, 2, v2
    v_lshlrev_b32 v14, 6, v2
    v_and_b32 v15, 3, v2
    v_lshlrev_b32 v15, 5, v15
    v_bfe_u32 v12, v2, 2, 1
    v_lshl_add_u32 v15, v12, 8, v15
    v_mov_b32 v48, 0
    v_mov_b32 v49, 0
    v_mov_b32 v50, 0
    v_mov_b32 v51, 0
    ds_write_b128 v11, v[48:51]
    ds_write_b128 v11, v[48:51] offset:1024
    s_waitcnt lgkmcnt(0)
    s_add_u32 s20, s8, 0x3510000
    s_addc_u32 s21, s9, 0
    s_mov_b32 s22, 0x26000
    s_mov_b32 s23, 0x20000
    s_add_u32 s24, s8, 0x34f0000
    s_addc_u32 s25, s9, 0
    s_mov_b32 s26, 0x11400
    s_mov_b32 s27, 0x20000
    s_mov_b32 s28, s6
    s_mov_b32 s29, s7
    s_mov_b32 s30, 0x100
    s_mov_b32 s31, 0x20000
    s_cmp_eq_u32 s4, 32
    s_cbranch_scc1 W2_EXT
    s_lshl_b32 s18, s4, 12
    s_and_b32 s19, s4, 30
    s_lshl_b32 s19, s19, 8
    s_add_u32 s19, s19, 131072
    buffer_load_dword v52, v13, s[20:23], s19 offen
    buffer_load_dword v53, v13, s[20:23], s19 offen offset:256
    buffer_load_dwordx4 v[16:19], v11, s[20:23], s18 offen offset:0
    buffer_load_dwordx4 v[20:23], v11, s[20:23], s18 offen offset:1024
    buffer_load_dwordx4 v[24:27], v11, s[20:23], s18 offen offset:2048
    buffer_load_dwordx4 v[28:31], v11, s[20:23], s18 offen offset:3072
    s_mov_b32 s32, 0
    s_cmp_ge_u32 s4, 16
    s_cbranch_scc1 W2_NOROW
    s_mov_b32 s18, 139264
    buffer_load_dwordx4 v[32:35], v14, s[20:23], s18 offen offset:0
    buffer_load_dwordx4 v[36:39], v14, s[20:23], s18 offen offset:16
    buffer_load_dwordx4 v[40:43], v14, s[20:23], s18 offen offset:32
    buffer_load_dwordx4 v[44:47], v14, s[20:23], s18 offen offset:48
    s_waitcnt vmcnt(0)
    ds_add_f32 v15, v32 offset:0
    ds_add_f32 v15, v33 offset:4
    ds_add_f32 v15, v34 offset:8
    ds_add_f32 v15, v35 offset:12
    ds_add_f32 v15, v36 offset:16
    ds_add_f32 v15, v37 offset:20
    ds_add_f32 v15, v38 offset:24
    ds_add_f32 v15, v39 offset:28
    ds_add_f32 v15, v40 offset:128
    ds_add_f32 v15, v41 offset:132
    ds_add_f32 v15, v42 offset:136
    ds_add_f32 v15, v43 offset:140
    ds_add_f32 v15, v44 offset:144
    ds_add_f32 v15, v45 offset:148
    ds_add_f32 v15, v46 offset:152
    ds_add_f32 v15, v47 offset:156
    v_add_f32 v12, v32, v33
    v_add_f32 v12, v12, v34
    v_add_f32 v12, v12, v35
    v_add_f32 v12, v12, v36
    v_add_f32 v12, v12, v37
    v_add_f32 v12, v12, v38
    v_add_f32 v12, v12, v39
    v_add_f32 v12, v12, v40
    v_add_f32 v12, v12, v41
    v_add_f32 v12, v12, v42
    v_add_f32 v12, v12, v43
    v_add_f32 v12, v12, v44
    v_add_f32 v12, v12, v45
    v_add_f32 v12, v12, v46
    v_add_f32 v12, v12, v47
    s_nop 1
    v_add_f32_dpp v12, v12, v12 row_shr:1 row_mask:0xf bank_mask:0xf bound_ctrl:0
    s_nop 1
    v_add_f32_dpp v12, v12, v12 row_shr:2 row_mask:0xf bank_mask:0xf bound_ctrl:0
    s_nop 1
    v_add_f32_dpp v12, v12, v12 row_shr:4 row_mask:0xf bank_mask:0xf bound_ctrl:0
    s_nop 1
    v_add_f32_dpp v12, v12, v12 row_shr:8 row_mask:0xf bank_mask:0xf bound_ctrl:0
    s_nop 1
    v_add_f32_dpp v12, v12, v12 row_bcast:15 row_mask:0xa bank_mask:0xf
    s_nop 1
    v_add_f32_dpp v12, v12, v12 row_bcast:31 row_mask:0xc bank_mask:0xf
    s_nop 1
    v_readlane_b32 s32, v12, 63
    s_mov_b32 s33, 0x3e0293ee
    s_branch W2_R2
W2_NOROW:
    s_mov_b32 s33, 1.0
W2_R2:
    s_waitcnt vmcnt(0) lgkmcnt(0)
    v_add_f32 v52, v52, v53
    v_xor_b32 v54, 128, v13
    ds_read_b128 v[32:35], v9 offset:0
    ds_read_b128 v[36:39], v9 offset:16
    ds_read_b128 v[40:43], v9 offset:128
    ds_read_b128 v[44:47], v9 offset:144
    ds_swizzle_b32 v53, v52 offset:0x401F
    s_waitcnt lgkmcnt(0)
    v_add_f32 v52, v52, v53
    ds_bpermute_b32 v53, v54, v52
    s_mov_b32 s34, 0x3c000000
    s_mov_b32 s35, 0xbc000000
    v_mov_b32 v55, s32
    s_waitcnt lgkmcnt(0)
    v_add_f32 v52, v52, v53
    v_fma_f32 v52, v55, s34, -v52
    v_mul_f32 v52, s34, v52
    v_mul_f32 v52, s33, v52
    v_fma_f32 v16, v32, s35, v16
    v_fma_f32 v17, v33, s35, v17
    v_fma_f32 v18, v34, s35, v18
    v_fma_f32 v19, v35, s35, v19
    v_fma_f32 v20, v36, s35, v20
    v_fma_f32 v21, v37, s35, v21
    v_fma_f32 v22, v38, s35, v22
    v_fma_f32 v23, v39, s35, v23
    v_fma_f32 v24, v40, s35, v24
    v_fma_f32 v25, v41, s35, v25
    v_fma_f32 v26, v42, s35, v26
    v_fma_f32 v27, v43, s35, v27
    v_fma_f32 v28, v44, s35, v28
    v_fma_f32 v29, v45, s35, v29
    v_fma_f32 v30, v46, s35, v30
    v_fma_f32 v31, v47, s35, v31
    v_fma_f32 v16, v16, s33, v52
    v_fma_f32 v17, v17, s33, v52
    v_fma_f32 v18, v18, s33, v52
    v_fma_f32 v19, v19, s33, v52
    v_fma_f32 v20, v20, s33, v52
    v_fma_f32 v21, v21, s33, v52
    v_fma_f32 v22, v22, s33, v52
    v_fma_f32 v23, v23, s33, v52
    v_fma_f32 v24, v24, s33, v52
    v_fma_f32 v25, v25, s33, v52
    v_fma_f32 v26, v26, s33, v52
    v_fma_f32 v27, v27, s33, v52
    v_fma_f32 v28, v28, s33, v52
    v_fma_f32 v29, v29, s33, v52
    v_fma_f32 v30, v30, s33, v52
    v_fma_f32 v31, v31, s33, v52
    s_lshl_b32 s18, s4, 11
    v_cvt_pk_bf16_f32 v48, v16, v17
    v_cvt_pk_bf16_f32 v49, v18, v19
    v_cvt_pk_bf16_f32 v50, v20, v21
    v_cvt_pk_bf16_f32 v51, v22, v23
    buffer_store_dwordx4 v[48:51], v11, s[24:27], s18 offen offset:0
    v_cvt_pk_bf16_f32 v52, v24, v25
    v_cvt_pk_bf16_f32 v53, v26, v27
    v_cvt_pk_bf16_f32 v54, v28, v29
    v_cvt_pk_bf16_f32 v55, v30, v31
    buffer_store_dwordx4 v[52:55], v11, s[24:27], s18 offen offset:1024
    s_endpgm
W2_EXT:
    v_lshlrev_b32 v16, 1, v2
    buffer_load_ushort v52, v16, s[28:31], 0 offen
    buffer_load_ushort v53, v16, s[28:31], 0 offen offset:128
    s_mov_b32 s18, 143360
    buffer_load_dwordx4 v[32:35], v14, s[20:23], s18 offen offset:0
    buffer_load_dwordx4 v[36:39], v14, s[20:23], s18 offen offset:16
    buffer_load_dwordx4 v[40:43], v14, s[20:23], s18 offen offset:32
    buffer_load_dwordx4 v[44:47], v14, s[20:23], s18 offen offset:48
    s_waitcnt vmcnt(0)
    ds_add_f32 v15, v32 offset:1024
    ds_add_f32 v15, v33 offset:1028
    ds_add_f32 v15, v34 offset:1032
    ds_add_f32 v15, v35 offset:1036
    ds_add_f32 v15, v36 offset:1040
    ds_add_f32 v15, v37 offset:1044
    ds_add_f32 v15, v38 offset:1048
    ds_add_f32 v15, v39 offset:1052
    ds_add_f32 v15, v40 offset:1152
    ds_add_f32 v15, v41 offset:1156
    ds_add_f32 v15, v42 offset:1160
    ds_add_f32 v15, v43 offset:1164
    ds_add_f32 v15, v44 offset:1168
    ds_add_f32 v15, v45 offset:1172
    ds_add_f32 v15, v46 offset:1176
    ds_add_f32 v15, v47 offset:1180
    v_add_f32 v12, v32, v33
    v_add_f32 v12, v12, v34
    v_add_f32 v12, v12, v35
    v_add_f32 v12, v12, v36
    v_add_f32 v12, v12, v37
    v_add_f32 v12, v12, v38
    v_add_f32 v12, v12, v39
    v_add_f32 v12, v12, v40
    v_add_f32 v12, v12, v41
    v_add_f32 v12, v12, v42
    v_add_f32 v12, v12, v43
    v_add_f32 v12, v12, v44
    v_add_f32 v12, v12, v45
    v_add_f32 v12, v12, v46
    v_add_f32 v12, v12, v47
    s_nop 1
    v_add_f32_dpp v12, v12, v12 row_shr:1 row_mask:0xf bank_mask:0xf bound_ctrl:0
    s_nop 1
    v_add_f32_dpp v12, v12, v12 row_shr:2 row_mask:0xf bank_mask:0xf bound_ctrl:0
    s_nop 1
    v_add_f32_dpp v12, v12, v12 row_shr:4 row_mask:0xf bank_mask:0xf bound_ctrl:0
    s_nop 1
    v_add_f32_dpp v12, v12, v12 row_shr:8 row_mask:0xf bank_mask:0xf bound_ctrl:0
    s_nop 1
    v_add_f32_dpp v12, v12, v12 row_bcast:15 row_mask:0xa bank_mask:0xf
    s_nop 1
    v_add_f32_dpp v12, v12, v12 row_bcast:31 row_mask:0xc bank_mask:0xf
    s_nop 1
    v_readlane_b32 s32, v12, 63
    s_mov_b32 s18, 147456
    buffer_load_dwordx4 v[32:35], v14, s[20:23], s18 offen offset:0
    buffer_load_dwordx4 v[36:39], v14, s[20:23], s18 offen offset:16
    buffer_load_dwordx4 v[40:43], v14, s[20:23], s18 offen offset:32
    buffer_load_dwordx4 v[44:47], v14, s[20:23], s18 offen offset:48
    s_waitcnt vmcnt(0)
    ds_add_f32 v15, v32 offset:1536
    ds_add_f32 v15, v33 offset:1540
    ds_add_f32 v15, v34 offset:1544
    ds_add_f32 v15, v35 offset:1548
    ds_add_f32 v15, v36 offset:1552
    ds_add_f32 v15, v37 offset:1556
    ds_add_f32 v15, v38 offset:1560
    ds_add_f32 v15, v39 offset:1564
    ds_add_f32 v15, v40 offset:1664
    ds_add_f32 v15, v41 offset:1668
    ds_add_f32 v15, v42 offset:1672
    ds_add_f32 v15, v43 offset:1676
    ds_add_f32 v15, v44 offset:1680
    ds_add_f32 v15, v45 offset:1684
    ds_add_f32 v15, v46 offset:1688
    ds_add_f32 v15, v47 offset:1692
    v_add_f32 v12, v32, v33
    v_add_f32 v12, v12, v34
    v_add_f32 v12, v12, v35
    v_add_f32 v12, v12, v36
    v_add_f32 v12, v12, v37
    v_add_f32 v12, v12, v38
    v_add_f32 v12, v12, v39
    v_add_f32 v12, v12, v40
    v_add_f32 v12, v12, v41
    v_add_f32 v12, v12, v42
    v_add_f32 v12, v12, v43
    v_add_f32 v12, v12, v44
    v_add_f32 v12, v12, v45
    v_add_f32 v12, v12, v46
    v_add_f32 v12, v12, v47
    s_nop 1
    v_add_f32_dpp v12, v12, v12 row_shr:1 row_mask:0xf bank_mask:0xf bound_ctrl:0
    s_nop 1
    v_add_f32_dpp v12, v12, v12 row_shr:2 row_mask:0xf bank_mask:0xf bound_ctrl:0
    s_nop 1
    v_add_f32_dpp v12, v12, v12 row_shr:4 row_mask:0xf bank_mask:0xf bound_ctrl:0
    s_nop 1
    v_add_f32_dpp v12, v12, v12 row_shr:8 row_mask:0xf bank_mask:0xf bound_ctrl:0
    s_nop 1
    v_add_f32_dpp v12, v12, v12 row_bcast:15 row_mask:0xa bank_mask:0xf
    s_nop 1
    v_add_f32_dpp v12, v12, v12 row_bcast:31 row_mask:0xc bank_mask:0xf
    s_nop 1
    v_readlane_b32 s33, v12, 63
    v_lshlrev_b32 v52, 16, v52
    v_lshlrev_b32 v53, 16, v53
    v_mov_b32 v54, 1.0
    ds_write_b32 v13, v54
    ds_write_b32 v13, v54 offset:256
    ds_write_b32 v13, v52 offset:512
    ds_write_b32 v13, v53 offset:768
    v_add_f32 v12, v52, v53
    v_mov_b32 v55, s32
    v_mov_b32 v56, s33
    v_mul_f32 v55, 0xbc000000, v55
    v_mul_f32 v56, 0xbc000000, v56
    ds_add_f32 v13, v55 offset:1024
    ds_add_f32 v13, v55 offset:1280
    ds_add_f32 v13, v56 offset:1536
    ds_add_f32 v13, v56 offset:1792
    s_nop 1
    v_add_f32_dpp v12, v12, v12 row_shr:1 row_mask:0xf bank_mask:0xf bound_ctrl:0
    s_nop 1
    v_add_f32_dpp v12, v12, v12 row_shr:2 row_mask:0xf bank_mask:0xf bound_ctrl:0
    s_nop 1
    v_add_f32_dpp v12, v12, v12 row_shr:4 row_mask:0xf bank_mask:0xf bound_ctrl:0
    s_nop 1
    v_add_f32_dpp v12, v12, v12 row_shr:8 row_mask:0xf bank_mask:0xf bound_ctrl:0
    s_nop 1
    v_add_f32_dpp v12, v12, v12 row_bcast:15 row_mask:0xa bank_mask:0xf
    s_nop 1
    v_add_f32_dpp v12, v12, v12 row_bcast:31 row_mask:0xc bank_mask:0xf
    s_mov_b32 s18, 69632
    buffer_store_dword v12, v13, s[24:27], s18 offen
    v_lshlrev_b32 v17, 9, v7
    v_lshl_add_u32 v17, v5, 5, v17
    s_mov_b32 s18, 65536
    s_waitcnt lgkmcnt(0)
    ds_read_b128 v[32:35], v17 offset:0
    ds_read_b128 v[36:39], v17 offset:16
    ds_read_b128 v[40:43], v17 offset:128
    ds_read_b128 v[44:47], v17 offset:144
    ds_read_b128 v[48:51], v17 offset:256
    ds_read_b128 v[52:55], v17 offset:272
    ds_read_b128 v[56:59], v17 offset:384
    ds_read_b128 v[60:63], v17 offset:400
    s_waitcnt lgkmcnt(0)
    v_cvt_pk_bf16_f32 v16, v32, v33
    v_cvt_pk_bf16_f32 v17, v34, v35
    v_cvt_pk_bf16_f32 v18, v36, v37
    v_cvt_pk_bf16_f32 v19, v38, v39
    buffer_store_dwordx4 v[16:19], v11, s[24:27], s18 offen offset:0
    v_cvt_pk_bf16_f32 v20, v40, v41
    v_cvt_pk_bf16_f32 v21, v42, v43
    v_cvt_pk_bf16_f32 v22, v44, v45
    v_cvt_pk_bf16_f32 v23, v46, v47
    buffer_store_dwordx4 v[20:23], v11, s[24:27], s18 offen offset:1024
    v_cvt_pk_bf16_f32 v24, v48, v49
    v_cvt_pk_bf16_f32 v25, v50, v51
    v_cvt_pk_bf16_f32 v26, v52, v53
    v_cvt_pk_bf16_f32 v27, v54, v55
    buffer_store_dwordx4 v[24:27], v11, s[24:27], s18 offen offset:2048
    v_cvt_pk_bf16_f32 v28, v56, v57
    v_cvt_pk_bf16_f32 v29, v58, v59
    v_cvt_pk_bf16_f32 v30, v60, v61
    v_cvt_pk_bf16_f32 v31, v62, v63
    buffer_store_dwordx4 v[28:31], v11, s[24:27], s18 offen offset:3072
W2_END:
    s_endpgm
.text
.globl hops_kernel
.p2align 8
.type hops_kernel,@function
hops_kernel:

    s_cmp_ge_u32 s2, 256
    s_cbranch_scc1 K3_END
    s_load_dwordx2 s[8:9], s[0:1], 88
    v_lshrrev_b32 v1, 6, v0
    v_and_b32 v2, 63, v0
    s_and_b32 s4, s2, 7
    v_readfirstlane_b32 s3, v1
    s_lshr_b32 s5, s2, 6
    s_lshl_b32 s5, s5, 3
    s_add_u32 s4, s4, s5
    s_bfe_u32 s5, s2, 0x30003
    v_lshlrev_b32 v114, 4, v2
    s_mul_i32 s6, s4, 200704
    s_mul_i32 s7, s5, 25088
    s_mov_b32 s21, 0
    s_mov_b32 s22, 64768
    s_mov_b32 s23, 129536
    s_mov_b32 s20, 0
    s_waitcnt lgkmcnt(0)
    s_add_u32 s12, s8, s6
    s_addc_u32 s13, s9, 0
    s_mov_b32 s14, 200704
    s_mov_b32 s15, 0x20000
    s_lshl_b32 s65, s3, 10
    s_add_u32 s64, s7, s65
    s_add_u32 s65, s65, 129536
    s_mov_b32 m0, s65
    s_nop 0
    buffer_load_dwordx4 v114, s[12:15], s64 offen sc1 lds
    s_cmp_ge_u32 s3, 9
    s_cbranch_scc1 K3_I1
    s_add_u32 s64, s64, 16384
    s_add_u32 m0, s65, 16384
    s_cmp_lg_u32 s3, 8
    s_cbranch_scc1 K3_I0
    s_mov_b32 exec_hi, 0
K3_I0:
    buffer_load_dwordx4 v114, s[12:15], s64 offen sc1 lds
    s_mov_b64 exec, -1
K3_I1:
K3_I3:
    s_add_u32 s16, s12, s7
    s_addc_u32 s17, s13, 0
    s_add_u32 s16, s16, 6422528
    s_addc_u32 s17, s17, 0
    s_mov_b32 s18, 25088
    s_mov_b32 s19, 0x20000
    s_cmp_ge_u32 s3, 14
    s_cbranch_scc1 K3_HELPER
    s_mov_b32 s10, 0xb5a29380
    s_mov_b32 s11, 0x16d7c4
    s_lshl_b32 s6, s3, 2
    s_lshr_b64 s[10:11], s[10:11], s6
    s_and_b32 s4, s10, 15
    s_mul_i32 s6, s5, 14
    s_add_u32 s6, s6, s4
    s_lshl_b32 s7, s6, 7
    s_add_u32 s10, s8, s7
    s_addc_u32 s11, s9, 0
    s_add_u32 s10, s10, 0x34d0000
    s_addc_u32 s11, s11, 0
    s_load_dwordx16 s[32:47], s[10:11], 0
    s_load_dwordx16 s[48:63], s[10:11], 64
    s_mul_i32 s7, s6, 20480
    s_add_u32 s28, s8, s7
    s_addc_u32 s29, s9, 0
    s_add_u32 s28, s28, 0x3a00000
    s_addc_u32 s29, s29, 0
    s_mov_b32 s30, 20480
    s_mov_b32 s31, 0x20000
    s_mov_b32 s64, 0
    buffer_load_dwordx4 v[4:7], v114, s[28:31], s64 offen offset:0
    buffer_load_dwordx4 v[8:11], v114, s[28:31], s64 offen offset:1024
    buffer_load_dwordx4 v[12:15], v114, s[28:31], s64 offen offset:2048
    buffer_load_dwordx4 v[16:19], v114, s[28:31], s64 offen offset:3072
    s_mov_b32 s64, 4096
    buffer_load_dwordx4 v[20:23], v114, s[28:31], s64 offen offset:0
    s_lshl_b32 s7, s6, 9
    s_add_u32 s24, s8, s7
    s_addc_u32 s25, s9, 0
    s_add_u32 s24, s24, 0x3540000
    s_addc_u32 s25, s25, 0
    s_mov_b32 s26, 512
    s_mov_b32 s27, 0x20000
    v_lshlrev_b32 v0, 3, v2
    v_and_b32 v112, 15, v2
    v_lshrrev_b32 v1, 4, v2
    v_lshlrev_b32 v113, 2, v2
    buffer_load_dwordx2 v[2:3], v0, s[24:27], 0 offen
    s_add_u32 s24, s8, 0x4100000
    s_addc_u32 s25, s9, 0
    s_mov_b32 s26, 0x3400000
    s_mov_b32 s27, 0x20000
    v_lshlrev_b32 v1, 2, v1
    v_sub_u32 v112, v112, v1
    v_mov_b32 v0, 0x3f80
    v_mov_b32 v1, 0x3f800000
    v_cmp_eq_u32 s[64:65], 0, v112
    v_cmp_eq_u32 s[66:67], 1, v112
    v_cmp_eq_u32 s[10:11], 2, v112
    v_cmp_eq_u32 vcc, 3, v112
    v_cndmask_b32 v108, 0, v0, s[64:65]
    v_cndmask_b32 v109, 0, v0, s[10:11]
    v_cndmask_b32 v108, v108, v1, s[66:67]
    v_cndmask_b32 v109, v109, v1, vcc
    v_mov_b32 v110, v108
    v_mov_b32 v111, v109
    s_waitcnt vmcnt(6) lgkmcnt(0)
    s_barrier
    s_waitcnt vmcnt(0)
    s_mov_b32 s64, 4096
    buffer_load_dwordx4 v[24:27], v114, s[28:31], s64 offen offset:1024
    buffer_load_dwordx4 v[28:31], v114, s[28:31], s64 offen offset:2048
    buffer_load_dwordx4 v[32:35], v114, s[28:31], s64 offen offset:3072
    s_mov_b32 s64, 8192
    buffer_load_dwordx4 v[36:39], v114, s[28:31], s64 offen offset:0
    s_lshr_b32 s11, s4, 1
    s_lshl_b32 s11, s11, 2
    s_add_u32 s11, s11, 154928
    s_mov_b32 s7, 0
    s_mov_b32 s68, 154916
    s_mov_b32 s69, 154920
    s_mov_b32 s70, 154908
    s_mov_b32 s71, 154912
    s_add_u32 s12, s12, 6422528
    s_addc_u32 s13, s13, 0
K3_GOWN:
    s_bitcmp1_b32 s4, 0
    s_cbranch_scc1 K3_GB
    s_setprio 2
    v_mad_u32_u16 v116, v4, 8, s23
    v_mad_u32_u16 v118, v4, 8, s23 op_sel:[1,0,0,0]
    ds_read_b64 v[116:117], v116
    ds_read_b64 v[118:119], v118
    v_mad_u32_u16 v120, v5, 8, s23
    v_mad_u32_u16 v122, v5, 8, s23 op_sel:[1,0,0,0]
    ds_read_b64 v[120:121], v120
    ds_read_b64 v[122:123], v122
    v_mad_u32_u16 v124, v6, 8, s23
    v_mad_u32_u16 v126, v6, 8, s23 op_sel:[1,0,0,0]
    ds_read_b64 v[124:125], v124
    ds_read_b64 v[126:127], v126
    v_mad_u32_u16 v88, v10, 8, s23
    v_mad_u32_u16 v90, v10, 8, s23 op_sel:[1,0,0,0]
    ds_read_b64 v[88:89], v88
    ds_read_b64 v[90:91], v90
    s_waitcnt lgkmcnt(6)
    v_mfma_f32_16x16x32_bf16 v[92:95], v[108:111], v[116:119], 0
    v_mad_u32_u16 v116, v11, 8, s23
    v_mad_u32_u16 v118, v11, 8, s23 op_sel:[1,0,0,0]
    ds_read_b64 v[116:117], v116
    ds_read_b64 v[118:119], v118
    s_waitcnt lgkmcnt(6)
    v_mfma_f32_16x16x32_bf16 v[92:95], v[108:111], v[120:123], v[92:95]
    v_mad_u32_u16 v120, v12, 8, s23
    v_mad_u32_u16 v122, v12, 8, s23 op_sel:[1,0,0,0]
    ds_read_b64 v[120:121], v120
    ds_read_b64 v[122:123], v122
    s_waitcnt lgkmcnt(6)
    v_mfma_f32_16x16x32_bf16 v[92:95], v[108:111], v[124:127], v[92:95]
    s_cmp_gt_u32 s32, 3
    s_cbranch_scc1 K3_X000
K3_R000:
    v_mad_u32_u16 v124, v16, 8, s23
    v_mad_u32_u16 v126, v16, 8, s23 op_sel:[1,0,0,0]
    ds_read_b64 v[124:125], v124
    ds_read_b64 v[126:127], v126
    s_waitcnt lgkmcnt(6)
    v_mfma_f32_16x16x32_bf16 v[96:99], v[108:111], v[88:91], 0
    s_setprio 1
    v_mad_u32_u16 v88, v17, 8, s23
    v_mad_u32_u16 v90, v17, 8, s23 op_sel:[1,0,0,0]
    ds_read_b64 v[88:89], v88
    ds_read_b64 v[90:91], v90
    s_waitcnt lgkmcnt(6)
    v_mfma_f32_16x16x32_bf16 v[96:99], v[108:111], v[116:119], v[96:99]
    v_mad_u32_u16 v116, v18, 8, s23
    v_mad_u32_u16 v118, v18, 8, s23 op_sel:[1,0,0,0]
    ds_read_b64 v[116:117], v116
    ds_read_b64 v[118:119], v118
    s_waitcnt lgkmcnt(6)
    v_mfma_f32_16x16x32_bf16 v[96:99], v[108:111], v[120:123], v[96:99]
    s_cmp_gt_u32 s33, 3
    s_cbranch_scc1 K3_X001
K3_R001:
    s_waitcnt lgkmcnt(4)
    v_mfma_f32_16x16x32_bf16 v[100:103], v[108:111], v[124:127], 0
    s_waitcnt lgkmcnt(2)
    v_mfma_f32_16x16x32_bf16 v[100:103], v[108:111], v[88:91], v[100:103]
    s_setprio 0
    s_waitcnt lgkmcnt(0)
    v_mfma_f32_16x16x32_bf16 v[100:103], v[108:111], v[116:119], v[100:103]
    s_cmp_gt_u32 s34, 3
    s_cbranch_scc1 K3_X002
K3_R002:
    v_mov_b32 v0, 154880
    v_mov_b32 v1, 1
    s_mov_b64 exec, 1
    ds_add_u32 v0, v1 offset:12
    s_mov_b64 exec, -1
    s_cmp_eq_u32 s7, 0
    s_cbranch_scc1 K3_NP0
    s_mov_b32 s7, 0
    s_add_u32 s10, s20, 0
    v_mov_b32 v1, s10
    s_mov_b64 exec, 1
    s_waitcnt vmcnt(0)
    buffer_store_dword v1, off, s[28:31], s6 sc1
    s_mov_b64 exec, -1
K3_NP0:
    v_mov_b32 v0, 154880
    s_add_u32 s66, s20, 1
    s_mul_i32 s66, s66, 2
SP_2:
    ds_read_b32 v1, v0 offset:24
    s_waitcnt lgkmcnt(0)
    v_readfirstlane_b32 s67, v1
    s_cmp_ge_u32 s67, s66
    s_cbranch_scc1 SP_2_E
    s_sleep 1
    s_branch SP_2
SP_2_E:
    s_cmp_lg_u32 s20, 0
    s_cbranch_scc1 LL_3
    s_waitcnt vmcnt(0)
    s_mov_b32 s64, 8192
    buffer_load_dwordx4 v[40:43], v114, s[28:31], s64 offen offset:1024
    buffer_load_dwordx4 v[44:47], v114, s[28:31], s64 offen offset:2048
    buffer_load_dwordx4 v[48:51], v114, s[28:31], s64 offen offset:3072
    s_mov_b32 s64, 12288
    buffer_load_dwordx4 v[52:55], v114, s[28:31], s64 offen offset:0
    buffer_load_dwordx4 v[56:59], v114, s[28:31], s64 offen offset:1024
    buffer_load_dwordx4 v[60:63], v114, s[28:31], s64 offen offset:2048
LL_3:
    s_setprio 2
    v_mad_u32_u16 v116, v24, 8, s21
    v_mad_u32_u16 v118, v24, 8, s21 op_sel:[1,0,0,0]
    ds_read_b64 v[116:117], v116
    ds_read_b64 v[118:119], v118
    v_mad_u32_u16 v120, v25, 8, s21
    v_mad_u32_u16 v122, v25, 8, s21 op_sel:[1,0,0,0]
    ds_read_b64 v[120:121], v120
    ds_read_b64 v[122:123], v122
    v_mad_u32_u16 v124, v26, 8, s21
    v_mad_u32_u16 v126, v26, 8, s21 op_sel:[1,0,0,0]
    ds_read_b64 v[124:125], v124
    ds_read_b64 v[126:127], v126
    v_mad_u32_u16 v88, v27, 8, s21
    v_mad_u32_u16 v90, v27, 8, s21 op_sel:[1,0,0,0]
    ds_read_b64 v[88:89], v88
    ds_read_b64 v[90:91], v90
    s_waitcnt lgkmcnt(6)
    v_mfma_f32_16x16x32_bf16 v[92:95], v[108:111], v[116:119], v[92:95]
    v_mad_u32_u16 v116, v28, 8, s21
    v_mad_u32_u16 v118, v28, 8, s21 op_sel:[1,0,0,0]
    ds_read_b64 v[116:117], v116
    ds_read_b64 v[118:119], v118
    s_waitcnt lgkmcnt(6)
    v_mfma_f32_16x16x32_bf16 v[92:95], v[108:111], v[120:123], v[92:95]
    v_mad_u32_u16 v120, v29, 8, s21
    v_mad_u32_u16 v122, v29, 8, s21 op_sel:[1,0,0,0]
    ds_read_b64 v[120:121], v120
    ds_read_b64 v[122:123], v122
    s_waitcnt lgkmcnt(6)
    v_mfma_f32_16x16x32_bf16 v[92:95], v[108:111], v[124:127], v[92:95]
    v_mad_u32_u16 v124, v32, 8, s21
    v_mad_u32_u16 v126, v32, 8, s21 op_sel:[1,0,0,0]
    ds_read_b64 v[124:125], v124
    ds_read_b64 v[126:127], v126
    s_waitcnt lgkmcnt(6)
    v_mfma_f32_16x16x32_bf16 v[92:95], v[108:111], v[88:91], v[92:95]
    v_mad_u32_u16 v88, v33, 8, s21
    v_mad_u32_u16 v90, v33, 8, s21 op_sel:[1,0,0,0]
    ds_read_b64 v[88:89], v88
    ds_read_b64 v[90:91], v90
    s_waitcnt lgkmcnt(6)
    v_mfma_f32_16x16x32_bf16 v[92:95], v[108:111], v[116:119], v[92:95]
    s_setprio 1
    v_mad_u32_u16 v116, v34, 8, s21
    v_mad_u32_u16 v118, v34, 8, s21 op_sel:[1,0,0,0]
    ds_read_b64 v[116:117], v116
    ds_read_b64 v[118:119], v118
    s_waitcnt lgkmcnt(6)
    v_mfma_f32_16x16x32_bf16 v[92:95], v[108:111], v[120:123], v[92:95]
    s_cmp_gt_u32 s36, 6
    s_cbranch_scc1 K3_X010
K3_R010:
    v_mad_u32_u16 v120, v35, 8, s21
    v_mad_u32_u16 v122, v35, 8, s21 op_sel:[1,0,0,0]
    ds_read_b64 v[120:121], v120
    ds_read_b64 v[122:123], v122
    s_waitcnt lgkmcnt(6)
    v_mfma_f32_16x16x32_bf16 v[96:99], v[108:111], v[124:127], v[96:99]
    v_mov_b32 v0, 154880
    s_add_u32 s66, s20, 1
    s_mul_i32 s66, s66, 14
SP_4:
    ds_read_b32 v1, v0 offset:12
    s_waitcnt lgkmcnt(0)
    v_readfirstlane_b32 s67, v1
    s_cmp_ge_u32 s67, s66
    s_cbranch_scc1 SP_4_E
    s_sleep 1
    s_branch SP_4
SP_4_E:
    v_mad_u32_u16 v0, v2, 8, s23
    v_cvt_pk_bf16_f32 v112, v92, v93
    v_cvt_pk_bf16_f32 v113, v94, v95
    ds_write_b64 v0, v[112:113]
    v_mad_u32_u16 v124, v37, 8, s21
    v_mad_u32_u16 v126, v37, 8, s21 op_sel:[1,0,0,0]
    ds_read_b64 v[124:125], v124
    ds_read_b64 v[126:127], v126
    v_mfma_f32_16x16x32_bf16 v[96:99], v[108:111], v[88:91], v[96:99]
    v_mad_u32_u16 v88, v38, 8, s21
    v_mad_u32_u16 v90, v38, 8, s21 op_sel:[1,0,0,0]
    ds_read_b64 v[88:89], v88
    ds_read_b64 v[90:91], v90
    v_mfma_f32_16x16x32_bf16 v[96:99], v[108:111], v[116:119], v[96:99]
    v_mfma_f32_16x16x32_bf16 v[96:99], v[108:111], v[120:123], v[96:99]
    s_cmp_gt_u32 s37, 4
    s_cbranch_scc1 K3_X011
K3_R011:
    s_setprio 0
    s_waitcnt lgkmcnt(2)
    v_mfma_f32_16x16x32_bf16 v[100:103], v[108:111], v[124:127], v[100:103]
    s_nop 2
    v_mad_u32_u16 v0, v2, 8, s23 op_sel:[1,0,0,0]
    v_cvt_pk_bf16_f32 v112, v96, v97
    v_cvt_pk_bf16_f32 v113, v98, v99
    ds_write_b64 v0, v[112:113]
    s_waitcnt lgkmcnt(1)
    v_mfma_f32_16x16x32_bf16 v[100:103], v[108:111], v[88:91], v[100:103]
    s_cmp_gt_u32 s38, 2
    s_cbranch_scc1 K3_X012
K3_R012:
    s_nop 5
    v_mad_u32_u16 v0, v3, 8, s23
    v_cvt_pk_bf16_f32 v112, v100, v101
    v_cvt_pk_bf16_f32 v113, v102, v103
    ds_write_b64 v0, v[112:113]
    v_mov_b32 v0, s11
    v_writelane_b32 v0, s68, 1
    v_mov_b32 v1, 1
    s_mul_i32 s66, s20, 4
    s_add_u32 s66, s66, 2
    s_add_u32 s67, s20, 1
    s_lshl_b32 s67, s67, 1
    s_mov_b64 exec, 3
    s_waitcnt lgkmcnt(0)
    ds_add_u32 v0, v1
    v_mov_b32 v112, s66
    v_writelane_b32 v112, s67, 1
    v_writelane_b32 v0, s70, 1
HO_5:
    ds_read_b32 v1, v0
    s_waitcnt lgkmcnt(0)
    v_cmp_gt_u32 vcc, v112, v1
    s_nop 0
    s_cbranch_vccz HO_5_E
    s_sleep 1
    s_branch HO_5
HO_5_E:
    s_mov_b64 exec, -1
    s_cmp_lg_u32 s20, 0
    s_cbranch_scc1 LL_6
    s_waitcnt vmcnt(0)
    s_mov_b32 s64, 12288
    buffer_load_dwordx4 v[64:67], v114, s[28:31], s64 offen offset:3072
    s_mov_b32 s64, 16384
    buffer_load_dwordx4 v[68:71], v114, s[28:31], s64 offen offset:0
    buffer_load_dwordx4 v[72:75], v114, s[28:31], s64 offen offset:1024
    buffer_load_dwordx4 v[76:79], v114, s[28:31], s64 offen offset:2048
    buffer_load_dwordx4 v[80:83], v114, s[28:31], s64 offen offset:3072
    s_lshl_b32 s10, s6, 10
    s_add_u32 s28, s8, s10
    s_addc_u32 s29, s9, 0
    s_add_u32 s28, s28, 0x34b0000
    s_addc_u32 s29, s29, 0
    s_mov_b32 s30, 1024
    v_lshrrev_b32 v0, 2, v114
    buffer_load_dword v84, v0, s[28:31], 0 offen offset:0
    buffer_load_dword v85, v0, s[28:31], 0 offen offset:256
    buffer_load_dword v86, v0, s[28:31], 0 offen offset:512
    buffer_load_dword v87, v0, s[28:31], 0 offen offset:768
    s_and_b32 s10, s2, 7
    s_lshr_b32 s64, s2, 6
    s_lshl_b32 s64, s64, 3
    s_add_u32 s10, s10, s64
    s_lshl_b32 s10, s10, 11
    s_add_u32 s28, s8, s10
    s_addc_u32 s29, s9, 0
    s_add_u32 s28, s28, 0x34e0000
    s_addc_u32 s29, s29, 0
    s_mov_b32 s30, 2048
    s_mov_b32 s31, 0x20000
    s_lshr_b32 s10, s4, 1
    s_lshl_b32 s6, s10, 2
    s_cmp_ge_u32 s10, 2
    s_cselect_b32 s64, 1016, 0
    s_cmp_ge_u32 s10, 5
    s_cselect_b32 s64, 12, s64
    s_add_u32 s6, s6, s64
    s_lshl_b32 s10, s5, 7
    s_add_u32 s6, s6, s10
LL_6:
    s_cmp_lt_u32 s4, 4
    s_cbranch_scc1 K3_EA0
    s_setprio 1
    v_mad_u32_u16 v88, v40, 8, s23
    v_mad_u32_u16 v118, v40, 8, s22 op_sel:[1,0,0,0]
    ds_read_b64 v[116:117], v88
    ds_read_b64 v[118:119], v118
    v_mad_u32_u16 v120, v41, 8, s22
    v_mad_u32_u16 v122, v41, 8, s22 op_sel:[1,0,0,0]
    ds_read_b64 v[120:121], v120
    ds_read_b64 v[122:123], v122
    s_waitcnt lgkmcnt(2)
    v_mfma_f32_16x16x32_bf16 v[92:95], v[108:111], v[116:119], 0
    v_mad_u32_u16 v124, v42, 8, s22
    v_mad_u32_u16 v126, v42, 8, s22 op_sel:[1,0,0,0]
    ds_read_b64 v[124:125], v124
    ds_read_b64 v[126:127], v126
    s_waitcnt lgkmcnt(2)
    v_mfma_f32_16x16x32_bf16 v[92:95], v[108:111], v[120:123], v[92:95]
    v_mad_u32_u16 v100, v43, 8, s22
    v_mad_u32_u16 v102, v43, 8, s22 op_sel:[1,0,0,0]
    ds_read_b64 v[100:101], v100
    ds_read_b64 v[102:103], v102
    s_waitcnt lgkmcnt(2)
    v_mfma_f32_16x16x32_bf16 v[92:95], v[108:111], v[124:127], v[92:95]
    v_mad_u32_u16 v104, v44, 8, s22
    v_mad_u32_u16 v106, v44, 8, s22 op_sel:[1,0,0,0]
    ds_read_b64 v[104:105], v104
    ds_read_b64 v[106:107], v106
    s_waitcnt lgkmcnt(2)
    v_mfma_f32_16x16x32_bf16 v[92:95], v[108:111], v[100:103], v[92:95]
    v_mad_u32_u16 v116, v45, 8, s22
    v_mad_u32_u16 v118, v45, 8, s22 op_sel:[1,0,0,0]
    ds_read_b64 v[116:117], v116
    ds_read_b64 v[118:119], v118
    s_waitcnt lgkmcnt(2)
    v_mfma_f32_16x16x32_bf16 v[92:95], v[108:111], v[104:107], v[92:95]
    v_mad_u32_u16 v120, v46, 8, s22
    v_mad_u32_u16 v122, v46, 8, s22 op_sel:[1,0,0,0]
    ds_read_b64 v[120:121], v120
    ds_read_b64 v[122:123], v122
    s_waitcnt lgkmcnt(2)
    v_mfma_f32_16x16x32_bf16 v[92:95], v[108:111], v[116:119], v[92:95]
    v_mad_u32_u16 v89, v51, 8, s23
    v_mad_u32_u16 v126, v51, 8, s22 op_sel:[1,0,0,0]
    ds_read_b64 v[124:125], v89
    ds_read_b64 v[126:127], v126
    s_waitcnt lgkmcnt(2)
    v_mfma_f32_16x16x32_bf16 v[92:95], v[108:111], v[120:123], v[92:95]
    s_cmp_gt_u32 s40, 7
    s_cbranch_scc1 K3_X020
K3_R020:
    s_setprio 0
    v_mad_u32_u16 v100, v52, 8, s22
    v_mad_u32_u16 v102, v52, 8, s22 op_sel:[1,0,0,0]
    ds_read_b64 v[100:101], v100
    ds_read_b64 v[102:103], v102
    s_waitcnt lgkmcnt(2)
    v_mfma_f32_16x16x32_bf16 v[96:99], v[108:111], v[124:127], 0
    v_cvt_pk_bf16_f32 v112, v92, v93
    v_cvt_pk_bf16_f32 v113, v94, v95
    ds_write_b64 v88, v[112:113]
    v_mad_u32_u16 v104, v53, 8, s22
    v_mad_u32_u16 v106, v53, 8, s22 op_sel:[1,0,0,0]
    ds_read_b64 v[104:105], v104
    ds_read_b64 v[106:107], v106
    v_mad_u32_u16 v116, v54, 8, s22
    v_mad_u32_u16 v118, v54, 8, s22 op_sel:[1,0,0,0]
    ds_read_b64 v[116:117], v116
    ds_read_b64 v[118:119], v118
    v_mad_u32_u16 v120, v55, 8, s22
    v_mad_u32_u16 v122, v55, 8, s22 op_sel:[1,0,0,0]
    ds_read_b64 v[120:121], v120
    ds_read_b64 v[122:123], v122
    v_mad_u32_u16 v90, v58, 8, s23
    v_mad_u32_u16 v126, v58, 8, s22 op_sel:[1,0,0,0]
    ds_read_b64 v[124:125], v90
    ds_read_b64 v[126:127], v126
    s_waitcnt lgkmcnt(9)
    v_mfma_f32_16x16x32_bf16 v[96:99], v[108:111], v[100:103], v[96:99]
    v_mad_u32_u16 v100, v59, 8, s22
    v_mad_u32_u16 v102, v59, 8, s22 op_sel:[1,0,0,0]
    ds_read_b64 v[100:101], v100
    ds_read_b64 v[102:103], v102
    s_waitcnt lgkmcnt(8)
    v_mfma_f32_16x16x32_bf16 v[96:99], v[108:111], v[104:107], v[96:99]
    v_mad_u32_u16 v104, v60, 8, s22
    v_mad_u32_u16 v106, v60, 8, s22 op_sel:[1,0,0,0]
    ds_read_b64 v[104:105], v104
    ds_read_b64 v[106:107], v106
    s_waitcnt lgkmcnt(8)
    v_mfma_f32_16x16x32_bf16 v[96:99], v[108:111], v[116:119], v[96:99]
    s_waitcnt lgkmcnt(6)
    v_mfma_f32_16x16x32_bf16 v[96:99], v[108:111], v[120:123], v[96:99]
    s_cmp_gt_u32 s41, 5
    s_cbranch_scc1 K3_X021
K3_R021:
    s_waitcnt lgkmcnt(4)
    v_mfma_f32_16x16x32_bf16 v[92:95], v[108:111], v[124:127], 0
    s_nop 3
    v_cvt_pk_bf16_f32 v112, v96, v97
    v_cvt_pk_bf16_f32 v113, v98, v99
    ds_write_b64 v89, v[112:113]
    s_waitcnt lgkmcnt(3)
    v_mfma_f32_16x16x32_bf16 v[92:95], v[108:111], v[100:103], v[92:95]
    s_waitcnt lgkmcnt(1)
    v_mfma_f32_16x16x32_bf16 v[92:95], v[108:111], v[104:107], v[92:95]
    s_cmp_gt_u32 s42, 3
    s_cbranch_scc1 K3_X022
K3_R022:
    s_nop 5
    v_cvt_pk_bf16_f32 v112, v92, v93
    v_cvt_pk_bf16_f32 v113, v94, v95
    ds_write_b64 v90, v[112:113]
    v_mov_b32 v0, s11
    v_writelane_b32 v0, s69, 1
    v_mov_b32 v1, 1
    s_mul_i32 s66, s20, 4
    s_add_u32 s66, s66, 4
    s_add_u32 s67, s20, 1
    s_lshl_b32 s67, s67, 1
    s_mov_b64 exec, 3
    s_waitcnt lgkmcnt(0)
    ds_add_u32 v0, v1
    v_mov_b32 v112, s66
    v_writelane_b32 v112, s67, 1
    v_writelane_b32 v0, s71, 1
HO_7:
    ds_read_b32 v1, v0
    s_waitcnt lgkmcnt(0)
    v_cmp_gt_u32 vcc, v112, v1
    s_nop 0
    s_cbranch_vccz HO_7_E
    s_sleep 1
    s_branch HO_7
HO_7_E:
    s_mov_b64 exec, -1
    s_waitcnt vmcnt(0)
    s_setprio 1
    s_cmp_lt_u32 s4, 10
    s_cbranch_scc1 PM_8
    s_setprio 0
PM_8:
    v_mad_u32_u16 v88, v64, 8, s23
    v_mad_u32_u16 v118, v64, 8, s21 op_sel:[1,0,0,0]
    ds_read_b64 v[116:117], v88
    ds_read_b64 v[118:119], v118
    v_mad_u32_u16 v120, v65, 8, s21
    v_mad_u32_u16 v122, v65, 8, s21 op_sel:[1,0,0,0]
    ds_read_b64 v[120:121], v120
    ds_read_b64 v[122:123], v122
    s_waitcnt lgkmcnt(2)
    v_mfma_f32_16x16x32_bf16 v[92:95], v[108:111], v[116:119], 0
    v_mad_u32_u16 v124, v66, 8, s21
    v_mad_u32_u16 v126, v66, 8, s21 op_sel:[1,0,0,0]
    ds_read_b64 v[124:125], v124
    ds_read_b64 v[126:127], v126
    s_waitcnt lgkmcnt(2)
    v_mfma_f32_16x16x32_bf16 v[92:95], v[108:111], v[120:123], v[92:95]
    v_mad_u32_u16 v100, v67, 8, s21
    v_mad_u32_u16 v102, v67, 8, s21 op_sel:[1,0,0,0]
    ds_read_b64 v[100:101], v100
    ds_read_b64 v[102:103], v102
    s_waitcnt lgkmcnt(2)
    v_mfma_f32_16x16x32_bf16 v[92:95], v[108:111], v[124:127], v[92:95]
    v_mad_u32_u16 v104, v68, 8, s21
    v_mad_u32_u16 v106, v68, 8, s21 op_sel:[1,0,0,0]
    ds_read_b64 v[104:105], v104
    ds_read_b64 v[106:107], v106
    s_waitcnt lgkmcnt(2)
    v_mfma_f32_16x16x32_bf16 v[92:95], v[108:111], v[100:103], v[92:95]
    v_mad_u32_u16 v116, v69, 8, s21
    v_mad_u32_u16 v118, v69, 8, s21 op_sel:[1,0,0,0]
    ds_read_b64 v[116:117], v116
    ds_read_b64 v[118:119], v118
    s_waitcnt lgkmcnt(2)
    v_mfma_f32_16x16x32_bf16 v[92:95], v[108:111], v[104:107], v[92:95]
    v_mad_u32_u16 v120, v70, 8, s21
    v_mad_u32_u16 v122, v70, 8, s21 op_sel:[1,0,0,0]
    ds_read_b64 v[120:121], v120
    ds_read_b64 v[122:123], v122
    s_waitcnt lgkmcnt(2)
    v_mfma_f32_16x16x32_bf16 v[92:95], v[108:111], v[116:119], v[92:95]
    v_mad_u32_u16 v89, v74, 8, s23
    v_mad_u32_u16 v126, v74, 8, s21 op_sel:[1,0,0,0]
    ds_read_b64 v[124:125], v89
    ds_read_b64 v[126:127], v126
    s_waitcnt lgkmcnt(2)
    v_mfma_f32_16x16x32_bf16 v[92:95], v[108:111], v[120:123], v[92:95]
    s_cmp_gt_u32 s44, 7
    s_cbranch_scc1 K3_X030
K3_R030:
    v_mad_u32_u16 v100, v75, 8, s21
    v_mad_u32_u16 v102, v75, 8, s21 op_sel:[1,0,0,0]
    ds_read_b64 v[100:101], v100
    ds_read_b64 v[102:103], v102
    s_waitcnt lgkmcnt(2)
    v_mfma_f32_16x16x32_bf16 v[96:99], v[108:111], v[124:127], 0
    v_mul_f32 v92, v84, v92
    v_mul_f32 v93, v84, v93
    v_mul_f32 v94, v84, v94
    v_mul_f32 v95, v84, v95
    v_cvt_pk_bf16_f32 v112, v92, v93
    v_cvt_pk_bf16_f32 v113, v94, v95
    ds_write_b64 v88, v[112:113]
    v_mad_u32_u16 v104, v76, 8, s21
    v_mad_u32_u16 v106, v76, 8, s21 op_sel:[1,0,0,0]
    ds_read_b64 v[104:105], v104
    ds_read_b64 v[106:107], v106
    v_mad_u32_u16 v116, v77, 8, s21
    v_mad_u32_u16 v118, v77, 8, s21 op_sel:[1,0,0,0]
    ds_read_b64 v[116:117], v116
    ds_read_b64 v[118:119], v118
    v_mad_u32_u16 v120, v78, 8, s21
    v_mad_u32_u16 v122, v78, 8, s21 op_sel:[1,0,0,0]
    ds_read_b64 v[120:121], v120
    ds_read_b64 v[122:123], v122
    v_mad_u32_u16 v90, v80, 8, s23
    v_mad_u32_u16 v126, v80, 8, s21 op_sel:[1,0,0,0]
    ds_read_b64 v[124:125], v90
    ds_read_b64 v[126:127], v126
    s_waitcnt lgkmcnt(9)
    v_mfma_f32_16x16x32_bf16 v[96:99], v[108:111], v[100:103], v[96:99]
    v_mad_u32_u16 v100, v81, 8, s21
    v_mad_u32_u16 v102, v81, 8, s21 op_sel:[1,0,0,0]
    ds_read_b64 v[100:101], v100
    ds_read_b64 v[102:103], v102
    s_waitcnt lgkmcnt(8)
    v_mfma_f32_16x16x32_bf16 v[96:99], v[108:111], v[104:107], v[96:99]
    v_mad_u32_u16 v104, v82, 8, s21
    v_mad_u32_u16 v106, v82, 8, s21 op_sel:[1,0,0,0]
    ds_read_b64 v[104:105], v104
    ds_read_b64 v[106:107], v106
    s_waitcnt lgkmcnt(8)
    v_mfma_f32_16x16x32_bf16 v[96:99], v[108:111], v[116:119], v[96:99]
    s_waitcnt lgkmcnt(6)
    v_mfma_f32_16x16x32_bf16 v[96:99], v[108:111], v[120:123], v[96:99]
    s_cmp_gt_u32 s45, 5
    s_cbranch_scc1 K3_X031
K3_R031:
    s_waitcnt lgkmcnt(4)
    v_mfma_f32_16x16x32_bf16 v[92:95], v[108:111], v[124:127], 0
    s_nop 3
    v_mul_f32 v96, v85, v96
    v_mul_f32 v97, v85, v97
    v_mul_f32 v98, v85, v98
    v_mul_f32 v99, v85, v99
    v_cvt_pk_bf16_f32 v112, v96, v97
    v_cvt_pk_bf16_f32 v113, v98, v99
    ds_write_b64 v89, v[112:113]
    s_waitcnt lgkmcnt(3)
    v_mfma_f32_16x16x32_bf16 v[92:95], v[108:111], v[100:103], v[92:95]
    s_waitcnt lgkmcnt(1)
    v_mfma_f32_16x16x32_bf16 v[92:95], v[108:111], v[104:107], v[92:95]
    s_cmp_gt_u32 s46, 3
    s_cbranch_scc1 K3_X032
K3_R032:
    s_nop 5
    v_mul_f32 v92, v86, v92
    v_mul_f32 v93, v86, v93
    v_mul_f32 v94, v86, v94
    v_mul_f32 v95, v86, v95
    v_cvt_pk_bf16_f32 v112, v92, v93
    v_cvt_pk_bf16_f32 v113, v94, v95
    ds_write_b64 v90, v[112:113]
    s_waitcnt lgkmcnt(0)
    s_branch K3_GE
K3_EA0:
    s_setprio 2
    v_mad_u32_u16 v88, v40, 8, s23
    v_mad_u32_u16 v118, v40, 8, s22 op_sel:[1,0,0,0]
    ds_read_b64 v[116:117], v88
    ds_read_b64 v[118:119], v118
    v_mad_u32_u16 v120, v41, 8, s22
    v_mad_u32_u16 v122, v41, 8, s22 op_sel:[1,0,0,0]
    ds_read_b64 v[120:121], v120
    ds_read_b64 v[122:123], v122
    v_mad_u32_u16 v124, v42, 8, s22
    v_mad_u32_u16 v126, v42, 8, s22 op_sel:[1,0,0,0]
    ds_read_b64 v[124:125], v124
    ds_read_b64 v[126:127], v126
    v_mad_u32_u16 v100, v43, 8, s22
    v_mad_u32_u16 v102, v43, 8, s22 op_sel:[1,0,0,0]
    ds_read_b64 v[100:101], v100
    ds_read_b64 v[102:103], v102
    v_mad_u32_u16 v104, v44, 8, s22
    v_mad_u32_u16 v106, v44, 8, s22 op_sel:[1,0,0,0]
    ds_read_b64 v[104:105], v104
    ds_read_b64 v[106:107], v106
    s_waitcnt lgkmcnt(8)
    v_mfma_f32_16x16x32_bf16 v[92:95], v[108:111], v[116:119], 0
    v_mad_u32_u16 v116, v45, 8, s22
    v_mad_u32_u16 v118, v45, 8, s22 op_sel:[1,0,0,0]
    ds_read_b64 v[116:117], v116
    ds_read_b64 v[118:119], v118
    s_waitcnt lgkmcnt(8)
    v_mfma_f32_16x16x32_bf16 v[92:95], v[108:111], v[120:123], v[92:95]
    v_mad_u32_u16 v120, v46, 8, s22
    v_mad_u32_u16 v122, v46, 8, s22 op_sel:[1,0,0,0]
    ds_read_b64 v[120:121], v120
    ds_read_b64 v[122:123], v122
    s_waitcnt lgkmcnt(8)
    v_mfma_f32_16x16x32_bf16 v[92:95], v[108:111], v[124:127], v[92:95]
    v_mad_u32_u16 v89, v51, 8, s23
    v_mad_u32_u16 v126, v51, 8, s22 op_sel:[1,0,0,0]
    ds_read_b64 v[124:125], v89
    ds_read_b64 v[126:127], v126
    s_waitcnt lgkmcnt(8)
    v_mfma_f32_16x16x32_bf16 v[92:95], v[108:111], v[100:103], v[92:95]
    v_mad_u32_u16 v100, v52, 8, s22
    v_mad_u32_u16 v102, v52, 8, s22 op_sel:[1,0,0,0]
    ds_read_b64 v[100:101], v100
    ds_read_b64 v[102:103], v102
    s_waitcnt lgkmcnt(8)
    v_mfma_f32_16x16x32_bf16 v[92:95], v[108:111], v[104:107], v[92:95]
    v_mad_u32_u16 v104, v53, 8, s22
    v_mad_u32_u16 v106, v53, 8, s22 op_sel:[1,0,0,0]
    ds_read_b64 v[104:105], v104
    ds_read_b64 v[106:107], v106
    s_waitcnt lgkmcnt(8)
    v_mfma_f32_16x16x32_bf16 v[92:95], v[108:111], v[116:119], v[92:95]
    v_mad_u32_u16 v116, v54, 8, s22
    v_mad_u32_u16 v118, v54, 8, s22 op_sel:[1,0,0,0]
    ds_read_b64 v[116:117], v116
    ds_read_b64 v[118:119], v118
    s_waitcnt lgkmcnt(8)
    v_mfma_f32_16x16x32_bf16 v[92:95], v[108:111], v[120:123], v[92:95]
    s_cmp_gt_u32 s40, 7
    s_cbranch_scc1 K3_X020e
K3_R020e:
    v_mad_u32_u16 v120, v55, 8, s22
    v_mad_u32_u16 v122, v55, 8, s22 op_sel:[1,0,0,0]
    ds_read_b64 v[120:121], v120
    ds_read_b64 v[122:123], v122
    s_waitcnt lgkmcnt(8)
    v_mfma_f32_16x16x32_bf16 v[96:99], v[108:111], v[124:127], 0
    v_cvt_pk_bf16_f32 v112, v92, v93
    v_cvt_pk_bf16_f32 v113, v94, v95
    ds_write_b64 v88, v[112:113]
    v_mad_u32_u16 v90, v58, 8, s23
    v_mad_u32_u16 v126, v58, 8, s22 op_sel:[1,0,0,0]
    ds_read_b64 v[124:125], v90
    ds_read_b64 v[126:127], v126
    s_waitcnt lgkmcnt(9)
    v_mfma_f32_16x16x32_bf16 v[96:99], v[108:111], v[100:103], v[96:99]
    v_mad_u32_u16 v100, v59, 8, s22
    v_mad_u32_u16 v102, v59, 8, s22 op_sel:[1,0,0,0]
    ds_read_b64 v[100:101], v100
    ds_read_b64 v[102:103], v102
    s_waitcnt lgkmcnt(9)
    v_mfma_f32_16x16x32_bf16 v[96:99], v[108:111], v[104:107], v[96:99]
    v_mad_u32_u16 v104, v60, 8, s22
    v_mad_u32_u16 v106, v60, 8, s22 op_sel:[1,0,0,0]
    ds_read_b64 v[104:105], v104
    ds_read_b64 v[106:107], v106
    s_waitcnt lgkmcnt(9)
    v_mfma_f32_16x16x32_bf16 v[96:99], v[108:111], v[116:119], v[96:99]
    s_waitcnt lgkmcnt(7)
    v_mfma_f32_16x16x32_bf16 v[96:99], v[108:111], v[120:123], v[96:99]
    s_cmp_gt_u32 s41, 5
    s_cbranch_scc1 K3_X021e
K3_R021e:
    s_waitcnt lgkmcnt(4)
    v_mfma_f32_16x16x32_bf16 v[92:95], v[108:111], v[124:127], 0
    s_nop 3
    v_cvt_pk_bf16_f32 v112, v96, v97
    v_cvt_pk_bf16_f32 v113, v98, v99
    ds_write_b64 v89, v[112:113]
    s_waitcnt lgkmcnt(3)
    v_mfma_f32_16x16x32_bf16 v[92:95], v[108:111], v[100:103], v[92:95]
    s_waitcnt lgkmcnt(1)
    v_mfma_f32_16x16x32_bf16 v[92:95], v[108:111], v[104:107], v[92:95]
    s_cmp_gt_u32 s42, 3
    s_cbranch_scc1 K3_X022e
K3_R022e:
    s_nop 5
    v_cvt_pk_bf16_f32 v112, v92, v93
    v_cvt_pk_bf16_f32 v113, v94, v95
    ds_write_b64 v90, v[112:113]
    v_mov_b32 v0, s11
    v_writelane_b32 v0, s69, 1
    v_mov_b32 v1, 1
    s_mul_i32 s66, s20, 4
    s_add_u32 s66, s66, 4
    s_add_u32 s67, s20, 1
    s_lshl_b32 s67, s67, 1
    s_mov_b64 exec, 3
    s_waitcnt lgkmcnt(0)
    ds_add_u32 v0, v1
    v_mov_b32 v112, s66
    v_writelane_b32 v112, s67, 1
    v_writelane_b32 v0, s71, 1
HO_9:
    ds_read_b32 v1, v0
    s_waitcnt lgkmcnt(0)
    v_cmp_gt_u32 vcc, v112, v1
    s_nop 0
    s_cbranch_vccz HO_9_E
    s_sleep 1
    s_branch HO_9
HO_9_E:
    s_mov_b64 exec, -1
    s_waitcnt vmcnt(0)
K3_EB0:
    s_setprio 2
    v_mad_u32_u16 v88, v64, 8, s23
    v_mad_u32_u16 v118, v64, 8, s21 op_sel:[1,0,0,0]
    ds_read_b64 v[116:117], v88
    ds_read_b64 v[118:119], v118
    v_mad_u32_u16 v120, v65, 8, s21
    v_mad_u32_u16 v122, v65, 8, s21 op_sel:[1,0,0,0]
    ds_read_b64 v[120:121], v120
    ds_read_b64 v[122:123], v122
    v_mad_u32_u16 v124, v66, 8, s21
    v_mad_u32_u16 v126, v66, 8, s21 op_sel:[1,0,0,0]
    ds_read_b64 v[124:125], v124
    ds_read_b64 v[126:127], v126
    v_mad_u32_u16 v100, v67, 8, s21
    v_mad_u32_u16 v102, v67, 8, s21 op_sel:[1,0,0,0]
    ds_read_b64 v[100:101], v100
    ds_read_b64 v[102:103], v102
    v_mad_u32_u16 v104, v68, 8, s21
    v_mad_u32_u16 v106, v68, 8, s21 op_sel:[1,0,0,0]
    ds_read_b64 v[104:105], v104
    ds_read_b64 v[106:107], v106
    s_waitcnt lgkmcnt(8)
    v_mfma_f32_16x16x32_bf16 v[92:95], v[108:111], v[116:119], 0
    v_mad_u32_u16 v116, v69, 8, s21
    v_mad_u32_u16 v118, v69, 8, s21 op_sel:[1,0,0,0]
    ds_read_b64 v[116:117], v116
    ds_read_b64 v[118:119], v118
    s_waitcnt lgkmcnt(8)
    v_mfma_f32_16x16x32_bf16 v[92:95], v[108:111], v[120:123], v[92:95]
    v_mad_u32_u16 v120, v70, 8, s21
    v_mad_u32_u16 v122, v70, 8, s21 op_sel:[1,0,0,0]
    ds_read_b64 v[120:121], v120
    ds_read_b64 v[122:123], v122
    s_waitcnt lgkmcnt(8)
    v_mfma_f32_16x16x32_bf16 v[92:95], v[108:111], v[124:127], v[92:95]
    v_mad_u32_u16 v89, v74, 8, s23
    v_mad_u32_u16 v126, v74, 8, s21 op_sel:[1,0,0,0]
    ds_read_b64 v[124:125], v89
    ds_read_b64 v[126:127], v126
    s_waitcnt lgkmcnt(8)
    v_mfma_f32_16x16x32_bf16 v[92:95], v[108:111], v[100:103], v[92:95]
    v_mad_u32_u16 v100, v75, 8, s21
    v_mad_u32_u16 v102, v75, 8, s21 op_sel:[1,0,0,0]
    ds_read_b64 v[100:101], v100
    ds_read_b64 v[102:103], v102
    s_waitcnt lgkmcnt(8)
    v_mfma_f32_16x16x32_bf16 v[92:95], v[108:111], v[104:107], v[92:95]
    v_mad_u32_u16 v104, v76, 8, s21
    v_mad_u32_u16 v106, v76, 8, s21 op_sel:[1,0,0,0]
    ds_read_b64 v[104:105], v104
    ds_read_b64 v[106:107], v106
    s_waitcnt lgkmcnt(8)
    v_mfma_f32_16x16x32_bf16 v[92:95], v[108:111], v[116:119], v[92:95]
    v_mad_u32_u16 v116, v77, 8, s21
    v_mad_u32_u16 v118, v77, 8, s21 op_sel:[1,0,0,0]
    ds_read_b64 v[116:117], v116
    ds_read_b64 v[118:119], v118
    s_waitcnt lgkmcnt(8)
    v_mfma_f32_16x16x32_bf16 v[92:95], v[108:111], v[120:123], v[92:95]
    s_cmp_gt_u32 s44, 7
    s_cbranch_scc1 K3_X030e
K3_R030e:
    v_mad_u32_u16 v120, v78, 8, s21
    v_mad_u32_u16 v122, v78, 8, s21 op_sel:[1,0,0,0]
    ds_read_b64 v[120:121], v120
    ds_read_b64 v[122:123], v122
    s_waitcnt lgkmcnt(8)
    v_mfma_f32_16x16x32_bf16 v[96:99], v[108:111], v[124:127], 0
    v_mul_f32 v92, v84, v92
    v_mul_f32 v93, v84, v93
    v_mul_f32 v94, v84, v94
    v_mul_f32 v95, v84, v95
    v_cvt_pk_bf16_f32 v112, v92, v93
    v_cvt_pk_bf16_f32 v113, v94, v95
    ds_write_b64 v88, v[112:113]
    v_mad_u32_u16 v90, v80, 8, s23
    v_mad_u32_u16 v126, v80, 8, s21 op_sel:[1,0,0,0]
    ds_read_b64 v[124:125], v90
    ds_read_b64 v[126:127], v126
    s_waitcnt lgkmcnt(9)
    v_mfma_f32_16x16x32_bf16 v[96:99], v[108:111], v[100:103], v[96:99]
    v_mad_u32_u16 v100, v81, 8, s21
    v_mad_u32_u16 v102, v81, 8, s21 op_sel:[1,0,0,0]
    ds_read_b64 v[100:101], v100
    ds_read_b64 v[102:103], v102
    s_waitcnt lgkmcnt(9)
    v_mfma_f32_16x16x32_bf16 v[96:99], v[108:111], v[104:107], v[96:99]
    v_mad_u32_u16 v104, v82, 8, s21
    v_mad_u32_u16 v106, v82, 8, s21 op_sel:[1,0,0,0]
    ds_read_b64 v[104:105], v104
    ds_read_b64 v[106:107], v106
    s_waitcnt lgkmcnt(9)
    v_mfma_f32_16x16x32_bf16 v[96:99], v[108:111], v[116:119], v[96:99]
    s_waitcnt lgkmcnt(7)
    v_mfma_f32_16x16x32_bf16 v[96:99], v[108:111], v[120:123], v[96:99]
    s_cmp_gt_u32 s45, 5
    s_cbranch_scc1 K3_X031e
K3_R031e:
    s_waitcnt lgkmcnt(4)
    v_mfma_f32_16x16x32_bf16 v[92:95], v[108:111], v[124:127], 0
    s_nop 3
    v_mul_f32 v96, v85, v96
    v_mul_f32 v97, v85, v97
    v_mul_f32 v98, v85, v98
    v_mul_f32 v99, v85, v99
    v_cvt_pk_bf16_f32 v112, v96, v97
    v_cvt_pk_bf16_f32 v113, v98, v99
    ds_write_b64 v89, v[112:113]
    s_waitcnt lgkmcnt(3)
    v_mfma_f32_16x16x32_bf16 v[92:95], v[108:111], v[100:103], v[92:95]
    s_waitcnt lgkmcnt(1)
    v_mfma_f32_16x16x32_bf16 v[92:95], v[108:111], v[104:107], v[92:95]
    s_cmp_gt_u32 s46, 3
    s_cbranch_scc1 K3_X032e
K3_R032e:
    s_nop 5
    v_mul_f32 v92, v86, v92
    v_mul_f32 v93, v86, v93
    v_mul_f32 v94, v86, v94
    v_mul_f32 v95, v86, v95
    v_cvt_pk_bf16_f32 v112, v92, v93
    v_cvt_pk_bf16_f32 v113, v94, v95
    ds_write_b64 v90, v[112:113]
    s_waitcnt lgkmcnt(0)
    s_branch K3_GE
K3_GB:
    s_setprio 2
    v_mad_u32_u16 v116, v4, 8, s23
    v_mad_u32_u16 v118, v4, 8, s23 op_sel:[1,0,0,0]
    ds_read_b64 v[116:117], v116
    ds_read_b64 v[118:119], v118
    v_mad_u32_u16 v120, v5, 8, s23
    v_mad_u32_u16 v122, v5, 8, s23 op_sel:[1,0,0,0]
    ds_read_b64 v[120:121], v120
    ds_read_b64 v[122:123], v122
    v_mad_u32_u16 v124, v6, 8, s23
    v_mad_u32_u16 v126, v6, 8, s23 op_sel:[1,0,0,0]
    ds_read_b64 v[124:125], v124
    ds_read_b64 v[126:127], v126
    v_mad_u32_u16 v88, v9, 8, s23
    v_mad_u32_u16 v90, v9, 8, s23 op_sel:[1,0,0,0]
    ds_read_b64 v[88:89], v88
    ds_read_b64 v[90:91], v90
    s_waitcnt lgkmcnt(6)
    v_mfma_f32_16x16x32_bf16 v[92:95], v[108:111], v[116:119], 0
    v_mad_u32_u16 v116, v10, 8, s23
    v_mad_u32_u16 v118, v10, 8, s23 op_sel:[1,0,0,0]
    ds_read_b64 v[116:117], v116
    ds_read_b64 v[118:119], v118
    s_waitcnt lgkmcnt(6)
    v_mfma_f32_16x16x32_bf16 v[92:95], v[108:111], v[120:123], v[92:95]
    v_mad_u32_u16 v120, v11, 8, s23
    v_mad_u32_u16 v122, v11, 8, s23 op_sel:[1,0,0,0]
    ds_read_b64 v[120:121], v120
    ds_read_b64 v[122:123], v122
    s_waitcnt lgkmcnt(6)
    v_mfma_f32_16x16x32_bf16 v[92:95], v[108:111], v[124:127], v[92:95]
    s_cmp_gt_u32 s32, 3
    s_cbranch_scc1 K3_X100
K3_R100:
    v_mad_u32_u16 v124, v14, 8, s23
    v_mad_u32_u16 v126, v14, 8, s23 op_sel:[1,0,0,0]
    ds_read_b64 v[124:125], v124
    ds_read_b64 v[126:127], v126
    s_waitcnt lgkmcnt(6)
    v_mfma_f32_16x16x32_bf16 v[96:99], v[108:111], v[88:91], 0
    v_mad_u32_u16 v88, v15, 8, s23
    v_mad_u32_u16 v90, v15, 8, s23 op_sel:[1,0,0,0]
    ds_read_b64 v[88:89], v88
    ds_read_b64 v[90:91], v90
    s_waitcnt lgkmcnt(6)
    v_mfma_f32_16x16x32_bf16 v[96:99], v[108:111], v[116:119], v[96:99]
    s_setprio 1
    v_mad_u32_u16 v116, v16, 8, s23
    v_mad_u32_u16 v118, v16, 8, s23 op_sel:[1,0,0,0]
    ds_read_b64 v[116:117], v116
    ds_read_b64 v[118:119], v118
    s_waitcnt lgkmcnt(6)
    v_mfma_f32_16x16x32_bf16 v[96:99], v[108:111], v[120:123], v[96:99]
    s_cmp_gt_u32 s33, 3
    s_cbranch_scc1 K3_X101
K3_R101:
    v_mad_u32_u16 v120, v19, 8, s23
    v_mad_u32_u16 v122, v19, 8, s23 op_sel:[1,0,0,0]
    ds_read_b64 v[120:121], v120
    ds_read_b64 v[122:123], v122
    s_waitcnt lgkmcnt(6)
    v_mfma_f32_16x16x32_bf16 v[100:103], v[108:111], v[124:127], 0
    v_mad_u32_u16 v124, v20, 8, s23
    v_mad_u32_u16 v126, v20, 8, s23 op_sel:[1,0,0,0]
    ds_read_b64 v[124:125], v124
    ds_read_b64 v[126:127], v126
    s_waitcnt lgkmcnt(6)
    v_mfma_f32_16x16x32_bf16 v[100:103], v[108:111], v[88:91], v[100:103]
    v_mad_u32_u16 v88, v21, 8, s23
    v_mad_u32_u16 v90, v21, 8, s23 op_sel:[1,0,0,0]
    ds_read_b64 v[88:89], v88
    ds_read_b64 v[90:91], v90
    s_waitcnt lgkmcnt(6)
    v_mfma_f32_16x16x32_bf16 v[100:103], v[108:111], v[116:119], v[100:103]
    s_cmp_gt_u32 s34, 3
    s_cbranch_scc1 K3_X102
K3_R102:
    s_waitcnt lgkmcnt(4)
    v_mfma_f32_16x16x32_bf16 v[104:107], v[108:111], v[120:123], 0
    s_setprio 0
    s_waitcnt lgkmcnt(2)
    v_mfma_f32_16x16x32_bf16 v[104:107], v[108:111], v[124:127], v[104:107]
    s_waitcnt lgkmcnt(0)
    v_mfma_f32_16x16x32_bf16 v[104:107], v[108:111], v[88:91], v[104:107]
    s_cmp_gt_u32 s35, 3
    s_cbranch_scc1 K3_X103
K3_R103:
    v_mov_b32 v0, 154880
    v_mov_b32 v1, 1
    s_mov_b64 exec, 1
    ds_add_u32 v0, v1 offset:12
    s_mov_b64 exec, -1
    s_cmp_eq_u32 s7, 0
    s_cbranch_scc1 K3_NP1
    s_mov_b32 s7, 0
    s_add_u32 s10, s20, 0
    v_mov_b32 v1, s10
    s_mov_b64 exec, 1
    s_waitcnt vmcnt(0)
    buffer_store_dword v1, off, s[28:31], s6 sc1
    s_mov_b64 exec, -1
K3_NP1:
    v_mov_b32 v0, 154880
    s_add_u32 s66, s20, 1
    s_mul_i32 s66, s66, 2
SP_10:
    ds_read_b32 v1, v0 offset:24
    s_waitcnt lgkmcnt(0)
    v_readfirstlane_b32 s67, v1
    s_cmp_ge_u32 s67, s66
    s_cbranch_scc1 SP_10_E
    s_sleep 1
    s_branch SP_10
SP_10_E:
    s_cmp_lg_u32 s20, 0
    s_cbranch_scc1 LL_11
    s_waitcnt vmcnt(0)
    s_mov_b32 s64, 8192
    buffer_load_dwordx4 v[40:43], v114, s[28:31], s64 offen offset:1024
    buffer_load_dwordx4 v[44:47], v114, s[28:31], s64 offen offset:2048
    buffer_load_dwordx4 v[48:51], v114, s[28:31], s64 offen offset:3072
    s_mov_b32 s64, 12288
    buffer_load_dwordx4 v[52:55], v114, s[28:31], s64 offen offset:0
    buffer_load_dwordx4 v[56:59], v114, s[28:31], s64 offen offset:1024
    buffer_load_dwordx4 v[60:63], v114, s[28:31], s64 offen offset:2048
LL_11:
    s_setprio 2
    v_mad_u32_u16 v116, v24, 8, s21
    v_mad_u32_u16 v118, v24, 8, s21 op_sel:[1,0,0,0]
    ds_read_b64 v[116:117], v116
    ds_read_b64 v[118:119], v118
    v_mad_u32_u16 v120, v25, 8, s21
    v_mad_u32_u16 v122, v25, 8, s21 op_sel:[1,0,0,0]
    ds_read_b64 v[120:121], v120
    ds_read_b64 v[122:123], v122
    v_mad_u32_u16 v124, v26, 8, s21
    v_mad_u32_u16 v126, v26, 8, s21 op_sel:[1,0,0,0]
    ds_read_b64 v[124:125], v124
    ds_read_b64 v[126:127], v126
    v_mad_u32_u16 v88, v27, 8, s21
    v_mad_u32_u16 v90, v27, 8, s21 op_sel:[1,0,0,0]
    ds_read_b64 v[88:89], v88
    ds_read_b64 v[90:91], v90
    s_waitcnt lgkmcnt(6)
    v_mfma_f32_16x16x32_bf16 v[92:95], v[108:111], v[116:119], v[92:95]
    v_mad_u32_u16 v116, v30, 8, s21
    v_mad_u32_u16 v118, v30, 8, s21 op_sel:[1,0,0,0]
    ds_read_b64 v[116:117], v116
    ds_read_b64 v[118:119], v118
    s_waitcnt lgkmcnt(6)
    v_mfma_f32_16x16x32_bf16 v[92:95], v[108:111], v[120:123], v[92:95]
    v_mad_u32_u16 v120, v31, 8, s21
    v_mad_u32_u16 v122, v31, 8, s21 op_sel:[1,0,0,0]
    ds_read_b64 v[120:121], v120
    ds_read_b64 v[122:123], v122
    s_waitcnt lgkmcnt(6)
    v_mfma_f32_16x16x32_bf16 v[92:95], v[108:111], v[124:127], v[92:95]
    v_mad_u32_u16 v124, v32, 8, s21
    v_mad_u32_u16 v126, v32, 8, s21 op_sel:[1,0,0,0]
    ds_read_b64 v[124:125], v124
    ds_read_b64 v[126:127], v126
    s_waitcnt lgkmcnt(6)
    v_mfma_f32_16x16x32_bf16 v[92:95], v[108:111], v[88:91], v[92:95]
    s_cmp_gt_u32 s36, 4
    s_cbranch_scc1 K3_X110
K3_R110:
    v_mad_u32_u16 v88, v34, 8, s21
    v_mad_u32_u16 v90, v34, 8, s21 op_sel:[1,0,0,0]
    ds_read_b64 v[88:89], v88
    ds_read_b64 v[90:91], v90
    s_waitcnt lgkmcnt(6)
    v_mfma_f32_16x16x32_bf16 v[96:99], v[108:111], v[116:119], v[96:99]
    v_mov_b32 v0, 154880
    s_add_u32 s66, s20, 1
    s_mul_i32 s66, s66, 14
SP_12:
    ds_read_b32 v1, v0 offset:12
    s_waitcnt lgkmcnt(0)
    v_readfirstlane_b32 s67, v1
    s_cmp_ge_u32 s67, s66
    s_cbranch_scc1 SP_12_E
    s_sleep 1
    s_branch SP_12
SP_12_E:
    v_mad_u32_u16 v0, v2, 8, s23
    v_cvt_pk_bf16_f32 v112, v92, v93
    v_cvt_pk_bf16_f32 v113, v94, v95
    ds_write_b64 v0, v[112:113]
    s_setprio 1
    v_mad_u32_u16 v116, v35, 8, s21
    v_mad_u32_u16 v118, v35, 8, s21 op_sel:[1,0,0,0]
    ds_read_b64 v[116:117], v116
    ds_read_b64 v[118:119], v118
    v_mfma_f32_16x16x32_bf16 v[96:99], v[108:111], v[120:123], v[96:99]
    v_mad_u32_u16 v120, v36, 8, s21
    v_mad_u32_u16 v122, v36, 8, s21 op_sel:[1,0,0,0]
    ds_read_b64 v[120:121], v120
    ds_read_b64 v[122:123], v122
    v_mfma_f32_16x16x32_bf16 v[96:99], v[108:111], v[124:127], v[96:99]
    s_cmp_gt_u32 s37, 3
    s_cbranch_scc1 K3_X111
K3_R111:
    v_mad_u32_u16 v124, v37, 8, s21
    v_mad_u32_u16 v126, v37, 8, s21 op_sel:[1,0,0,0]
    ds_read_b64 v[124:125], v124
    ds_read_b64 v[126:127], v126
    v_mfma_f32_16x16x32_bf16 v[100:103], v[108:111], v[88:91], v[100:103]
    s_nop 0
    v_mad_u32_u16 v0, v2, 8, s23 op_sel:[1,0,0,0]
    v_cvt_pk_bf16_f32 v112, v96, v97
    v_cvt_pk_bf16_f32 v113, v98, v99
    ds_write_b64 v0, v[112:113]
    v_mad_u32_u16 v88, v38, 8, s21
    v_mad_u32_u16 v90, v38, 8, s21 op_sel:[1,0,0,0]
    ds_read_b64 v[88:89], v88
    ds_read_b64 v[90:91], v90
    s_waitcnt lgkmcnt(7)
    v_mfma_f32_16x16x32_bf16 v[100:103], v[108:111], v[116:119], v[100:103]
    s_waitcnt lgkmcnt(5)
    v_mfma_f32_16x16x32_bf16 v[100:103], v[108:111], v[120:123], v[100:103]
    s_cmp_gt_u32 s38, 3
    s_cbranch_scc1 K3_X112
K3_R112:
    s_setprio 0
    s_waitcnt lgkmcnt(3)
    v_mfma_f32_16x16x32_bf16 v[104:107], v[108:111], v[124:127], v[104:107]
    s_nop 2
    v_mad_u32_u16 v0, v3, 8, s23
    v_cvt_pk_bf16_f32 v112, v100, v101
    v_cvt_pk_bf16_f32 v113, v102, v103
    ds_write_b64 v0, v[112:113]
    s_waitcnt lgkmcnt(1)
    v_mfma_f32_16x16x32_bf16 v[104:107], v[108:111], v[88:91], v[104:107]
    s_cmp_gt_u32 s39, 2
    s_cbranch_scc1 K3_X113
K3_R113:
    s_nop 5
    v_mad_u32_u16 v0, v3, 8, s23 op_sel:[1,0,0,0]
    v_cvt_pk_bf16_f32 v112, v104, v105
    v_cvt_pk_bf16_f32 v113, v106, v107
    ds_write_b64 v0, v[112:113]
    v_mov_b32 v0, s11
    v_writelane_b32 v0, s68, 1
    v_mov_b32 v1, 1
    s_mul_i32 s66, s20, 4
    s_add_u32 s66, s66, 2
    s_add_u32 s67, s20, 1
    s_lshl_b32 s67, s67, 1
    s_mov_b64 exec, 3
    s_waitcnt lgkmcnt(0)
    ds_add_u32 v0, v1
    v_mov_b32 v112, s66
    v_writelane_b32 v112, s67, 1
    v_writelane_b32 v0, s70, 1
HO_13:
    ds_read_b32 v1, v0
    s_waitcnt lgkmcnt(0)
    v_cmp_gt_u32 vcc, v112, v1
    s_nop 0
    s_cbranch_vccz HO_13_E
    s_sleep 1
    s_branch HO_13
HO_13_E:
    s_mov_b64 exec, -1
    s_cmp_lg_u32 s20, 0
    s_cbranch_scc1 LL_14
    s_waitcnt vmcnt(0)
    s_mov_b32 s64, 12288
    buffer_load_dwordx4 v[64:67], v114, s[28:31], s64 offen offset:3072
    s_mov_b32 s64, 16384
    buffer_load_dwordx4 v[68:71], v114, s[28:31], s64 offen offset:0
    buffer_load_dwordx4 v[72:75], v114, s[28:31], s64 offen offset:1024
    buffer_load_dwordx4 v[76:79], v114, s[28:31], s64 offen offset:2048
    buffer_load_dwordx4 v[80:83], v114, s[28:31], s64 offen offset:3072
    s_lshl_b32 s10, s6, 10
    s_add_u32 s28, s8, s10
    s_addc_u32 s29, s9, 0
    s_add_u32 s28, s28, 0x34b0000
    s_addc_u32 s29, s29, 0
    s_mov_b32 s30, 1024
    v_lshrrev_b32 v0, 2, v114
    buffer_load_dword v84, v0, s[28:31], 0 offen offset:0
    buffer_load_dword v85, v0, s[28:31], 0 offen offset:256
    buffer_load_dword v86, v0, s[28:31], 0 offen offset:512
    buffer_load_dword v87, v0, s[28:31], 0 offen offset:768
    s_and_b32 s10, s2, 7
    s_lshr_b32 s64, s2, 6
    s_lshl_b32 s64, s64, 3
    s_add_u32 s10, s10, s64
    s_lshl_b32 s10, s10, 11
    s_add_u32 s28, s8, s10
    s_addc_u32 s29, s9, 0
    s_add_u32 s28, s28, 0x34e0000
    s_addc_u32 s29, s29, 0
    s_mov_b32 s30, 2048
    s_mov_b32 s31, 0x20000
    s_lshr_b32 s10, s4, 1
    s_lshl_b32 s6, s10, 2
    s_cmp_ge_u32 s10, 2
    s_cselect_b32 s64, 1016, 0
    s_cmp_ge_u32 s10, 5
    s_cselect_b32 s64, 12, s64
    s_add_u32 s6, s6, s64
    s_lshl_b32 s10, s5, 7
    s_add_u32 s6, s6, s10
LL_14:
    s_cmp_lt_u32 s4, 4
    s_cbranch_scc1 K3_EA1
    s_setprio 1
    v_mad_u32_u16 v88, v40, 8, s23
    v_mad_u32_u16 v118, v40, 8, s22 op_sel:[1,0,0,0]
    ds_read_b64 v[116:117], v88
    ds_read_b64 v[118:119], v118
    v_mad_u32_u16 v120, v41, 8, s22
    v_mad_u32_u16 v122, v41, 8, s22 op_sel:[1,0,0,0]
    ds_read_b64 v[120:121], v120
    ds_read_b64 v[122:123], v122
    s_waitcnt lgkmcnt(2)
    v_mfma_f32_16x16x32_bf16 v[92:95], v[108:111], v[116:119], 0
    v_mad_u32_u16 v124, v42, 8, s22
    v_mad_u32_u16 v126, v42, 8, s22 op_sel:[1,0,0,0]
    ds_read_b64 v[124:125], v124
    ds_read_b64 v[126:127], v126
    s_waitcnt lgkmcnt(2)
    v_mfma_f32_16x16x32_bf16 v[92:95], v[108:111], v[120:123], v[92:95]
    v_mad_u32_u16 v100, v43, 8, s22
    v_mad_u32_u16 v102, v43, 8, s22 op_sel:[1,0,0,0]
    ds_read_b64 v[100:101], v100
    ds_read_b64 v[102:103], v102
    s_waitcnt lgkmcnt(2)
    v_mfma_f32_16x16x32_bf16 v[92:95], v[108:111], v[124:127], v[92:95]
    v_mad_u32_u16 v104, v44, 8, s22
    v_mad_u32_u16 v106, v44, 8, s22 op_sel:[1,0,0,0]
    ds_read_b64 v[104:105], v104
    ds_read_b64 v[106:107], v106
    s_waitcnt lgkmcnt(2)
    v_mfma_f32_16x16x32_bf16 v[92:95], v[108:111], v[100:103], v[92:95]
    v_mad_u32_u16 v89, v48, 8, s23
    v_mad_u32_u16 v118, v48, 8, s22 op_sel:[1,0,0,0]
    ds_read_b64 v[116:117], v89
    ds_read_b64 v[118:119], v118
    s_waitcnt lgkmcnt(2)
    v_mfma_f32_16x16x32_bf16 v[92:95], v[108:111], v[104:107], v[92:95]
    s_cmp_gt_u32 s40, 5
    s_cbranch_scc1 K3_X120
K3_R120:
    v_mad_u32_u16 v120, v49, 8, s22
    v_mad_u32_u16 v122, v49, 8, s22 op_sel:[1,0,0,0]
    ds_read_b64 v[120:121], v120
    ds_read_b64 v[122:123], v122
    s_waitcnt lgkmcnt(2)
    v_mfma_f32_16x16x32_bf16 v[96:99], v[108:111], v[116:119], 0
    v_cvt_pk_bf16_f32 v112, v92, v93
    v_cvt_pk_bf16_f32 v113, v94, v95
    ds_write_b64 v88, v[112:113]
    v_mad_u32_u16 v124, v50, 8, s22
    v_mad_u32_u16 v126, v50, 8, s22 op_sel:[1,0,0,0]
    ds_read_b64 v[124:125], v124
    ds_read_b64 v[126:127], v126
    s_waitcnt lgkmcnt(3)
    v_mfma_f32_16x16x32_bf16 v[96:99], v[108:111], v[120:123], v[96:99]
    v_mad_u32_u16 v100, v51, 8, s22
    v_mad_u32_u16 v102, v51, 8, s22 op_sel:[1,0,0,0]
    ds_read_b64 v[100:101], v100
    ds_read_b64 v[102:103], v102
    s_waitcnt lgkmcnt(2)
    v_mfma_f32_16x16x32_bf16 v[96:99], v[108:111], v[124:127], v[96:99]
    s_setprio 0
    v_mad_u32_u16 v90, v54, 8, s23
    v_mad_u32_u16 v106, v54, 8, s22 op_sel:[1,0,0,0]
    ds_read_b64 v[104:105], v90
    ds_read_b64 v[106:107], v106
    v_mad_u32_u16 v116, v55, 8, s22
    v_mad_u32_u16 v118, v55, 8, s22 op_sel:[1,0,0,0]
    ds_read_b64 v[116:117], v116
    ds_read_b64 v[118:119], v118
    v_mad_u32_u16 v120, v56, 8, s22
    v_mad_u32_u16 v122, v56, 8, s22 op_sel:[1,0,0,0]
    ds_read_b64 v[120:121], v120
    ds_read_b64 v[122:123], v122
    v_mad_u32_u16 v124, v57, 8, s22
    v_mad_u32_u16 v126, v57, 8, s22 op_sel:[1,0,0,0]
    ds_read_b64 v[124:125], v124
    ds_read_b64 v[126:127], v126
    s_waitcnt lgkmcnt(8)
    v_mfma_f32_16x16x32_bf16 v[96:99], v[108:111], v[100:103], v[96:99]
    s_cmp_gt_u32 s41, 4
    s_cbranch_scc1 K3_X121
K3_R121:
    v_mad_u32_u16 v91, v59, 8, s23
    v_mad_u32_u16 v102, v59, 8, s22 op_sel:[1,0,0,0]
    ds_read_b64 v[100:101], v91
    ds_read_b64 v[102:103], v102
    s_waitcnt lgkmcnt(8)
    v_mfma_f32_16x16x32_bf16 v[92:95], v[108:111], v[104:107], 0
    v_cvt_pk_bf16_f32 v112, v96, v97
    v_cvt_pk_bf16_f32 v113, v98, v99
    ds_write_b64 v89, v[112:113]
    v_mad_u32_u16 v104, v60, 8, s22
    v_mad_u32_u16 v106, v60, 8, s22 op_sel:[1,0,0,0]
    ds_read_b64 v[104:105], v104
    ds_read_b64 v[106:107], v106
    s_waitcnt lgkmcnt(9)
    v_mfma_f32_16x16x32_bf16 v[92:95], v[108:111], v[116:119], v[92:95]
    v_mad_u32_u16 v116, v61, 8, s22
    v_mad_u32_u16 v118, v61, 8, s22 op_sel:[1,0,0,0]
    ds_read_b64 v[116:117], v116
    ds_read_b64 v[118:119], v118
    s_waitcnt lgkmcnt(9)
    v_mfma_f32_16x16x32_bf16 v[92:95], v[108:111], v[120:123], v[92:95]
    s_waitcnt lgkmcnt(7)
    v_mfma_f32_16x16x32_bf16 v[92:95], v[108:111], v[124:127], v[92:95]
    s_cmp_gt_u32 s42, 4
    s_cbranch_scc1 K3_X122
K3_R122:
    s_waitcnt lgkmcnt(5)
    v_mfma_f32_16x16x32_bf16 v[96:99], v[108:111], v[100:103], 0
    s_nop 3
    v_cvt_pk_bf16_f32 v112, v92, v93
    v_cvt_pk_bf16_f32 v113, v94, v95
    ds_write_b64 v90, v[112:113]
    s_waitcnt lgkmcnt(3)
    v_mfma_f32_16x16x32_bf16 v[96:99], v[108:111], v[104:107], v[96:99]
    s_waitcnt lgkmcnt(1)
    v_mfma_f32_16x16x32_bf16 v[96:99], v[108:111], v[116:119], v[96:99]
    s_cmp_gt_u32 s43, 3
    s_cbranch_scc1 K3_X123
K3_R123:
    s_nop 5
    v_cvt_pk_bf16_f32 v112, v96, v97
    v_cvt_pk_bf16_f32 v113, v98, v99
    ds_write_b64 v91, v[112:113]
    v_mov_b32 v0, s11
    v_writelane_b32 v0, s69, 1
    v_mov_b32 v1, 1
    s_mul_i32 s66, s20, 4
    s_add_u32 s66, s66, 4
    s_add_u32 s67, s20, 1
    s_lshl_b32 s67, s67, 1
    s_mov_b64 exec, 3
    s_waitcnt lgkmcnt(0)
    ds_add_u32 v0, v1
    v_mov_b32 v112, s66
    v_writelane_b32 v112, s67, 1
    v_writelane_b32 v0, s71, 1
HO_15:
    ds_read_b32 v1, v0
    s_waitcnt lgkmcnt(0)
    v_cmp_gt_u32 vcc, v112, v1
    s_nop 0
    s_cbranch_vccz HO_15_E
    s_sleep 1
    s_branch HO_15
HO_15_E:
    s_mov_b64 exec, -1
    s_waitcnt vmcnt(0)
    s_setprio 1
    s_cmp_lt_u32 s4, 10
    s_cbranch_scc1 PM_16
    s_setprio 0
PM_16:
    v_mad_u32_u16 v88, v64, 8, s23
    v_mad_u32_u16 v118, v64, 8, s21 op_sel:[1,0,0,0]
    ds_read_b64 v[116:117], v88
    ds_read_b64 v[118:119], v118
    v_mad_u32_u16 v120, v65, 8, s21
    v_mad_u32_u16 v122, v65, 8, s21 op_sel:[1,0,0,0]
    ds_read_b64 v[120:121], v120
    ds_read_b64 v[122:123], v122
    s_waitcnt lgkmcnt(2)
    v_mfma_f32_16x16x32_bf16 v[92:95], v[108:111], v[116:119], 0
    v_mad_u32_u16 v124, v66, 8, s21
    v_mad_u32_u16 v126, v66, 8, s21 op_sel:[1,0,0,0]
    ds_read_b64 v[124:125], v124
    ds_read_b64 v[126:127], v126
    s_waitcnt lgkmcnt(2)
    v_mfma_f32_16x16x32_bf16 v[92:95], v[108:111], v[120:123], v[92:95]
    v_mad_u32_u16 v100, v67, 8, s21
    v_mad_u32_u16 v102, v67, 8, s21 op_sel:[1,0,0,0]
    ds_read_b64 v[100:101], v100
    ds_read_b64 v[102:103], v102
    s_waitcnt lgkmcnt(2)
    v_mfma_f32_16x16x32_bf16 v[92:95], v[108:111], v[124:127], v[92:95]
    v_mad_u32_u16 v104, v68, 8, s21
    v_mad_u32_u16 v106, v68, 8, s21 op_sel:[1,0,0,0]
    ds_read_b64 v[104:105], v104
    ds_read_b64 v[106:107], v106
    s_waitcnt lgkmcnt(2)
    v_mfma_f32_16x16x32_bf16 v[92:95], v[108:111], v[100:103], v[92:95]
    v_mad_u32_u16 v89, v71, 8, s23
    v_mad_u32_u16 v118, v71, 8, s21 op_sel:[1,0,0,0]
    ds_read_b64 v[116:117], v89
    ds_read_b64 v[118:119], v118
    s_waitcnt lgkmcnt(2)
    v_mfma_f32_16x16x32_bf16 v[92:95], v[108:111], v[104:107], v[92:95]
    s_cmp_gt_u32 s44, 5
    s_cbranch_scc1 K3_X130
K3_R130:
    v_mad_u32_u16 v120, v72, 8, s21
    v_mad_u32_u16 v122, v72, 8, s21 op_sel:[1,0,0,0]
    ds_read_b64 v[120:121], v120
    ds_read_b64 v[122:123], v122
    s_waitcnt lgkmcnt(2)
    v_mfma_f32_16x16x32_bf16 v[96:99], v[108:111], v[116:119], 0
    v_mul_f32 v92, v84, v92
    v_mul_f32 v93, v84, v93
    v_mul_f32 v94, v84, v94
    v_mul_f32 v95, v84, v95
    v_cvt_pk_bf16_f32 v112, v92, v93
    v_cvt_pk_bf16_f32 v113, v94, v95
    ds_write_b64 v88, v[112:113]
    v_mad_u32_u16 v124, v73, 8, s21
    v_mad_u32_u16 v126, v73, 8, s21 op_sel:[1,0,0,0]
    ds_read_b64 v[124:125], v124
    ds_read_b64 v[126:127], v126
    s_waitcnt lgkmcnt(3)
    v_mfma_f32_16x16x32_bf16 v[96:99], v[108:111], v[120:123], v[96:99]
    v_mad_u32_u16 v100, v74, 8, s21
    v_mad_u32_u16 v102, v74, 8, s21 op_sel:[1,0,0,0]
    ds_read_b64 v[100:101], v100
    ds_read_b64 v[102:103], v102
    s_waitcnt lgkmcnt(2)
    v_mfma_f32_16x16x32_bf16 v[96:99], v[108:111], v[124:127], v[96:99]
    v_mad_u32_u16 v90, v76, 8, s23
    v_mad_u32_u16 v106, v76, 8, s21 op_sel:[1,0,0,0]
    ds_read_b64 v[104:105], v90
    ds_read_b64 v[106:107], v106
    v_mad_u32_u16 v116, v77, 8, s21
    v_mad_u32_u16 v118, v77, 8, s21 op_sel:[1,0,0,0]
    ds_read_b64 v[116:117], v116
    ds_read_b64 v[118:119], v118
    v_mad_u32_u16 v120, v78, 8, s21
    v_mad_u32_u16 v122, v78, 8, s21 op_sel:[1,0,0,0]
    ds_read_b64 v[120:121], v120
    ds_read_b64 v[122:123], v122
    v_mad_u32_u16 v124, v79, 8, s21
    v_mad_u32_u16 v126, v79, 8, s21 op_sel:[1,0,0,0]
    ds_read_b64 v[124:125], v124
    ds_read_b64 v[126:127], v126
    s_waitcnt lgkmcnt(8)
    v_mfma_f32_16x16x32_bf16 v[96:99], v[108:111], v[100:103], v[96:99]
    s_cmp_gt_u32 s45, 4
    s_cbranch_scc1 K3_X131
K3_R131:
    v_mad_u32_u16 v91, v80, 8, s23
    v_mad_u32_u16 v102, v80, 8, s21 op_sel:[1,0,0,0]
    ds_read_b64 v[100:101], v91
    ds_read_b64 v[102:103], v102
    s_waitcnt lgkmcnt(8)
    v_mfma_f32_16x16x32_bf16 v[92:95], v[108:111], v[104:107], 0
    v_mul_f32 v96, v85, v96
    v_mul_f32 v97, v85, v97
    v_mul_f32 v98, v85, v98
    v_mul_f32 v99, v85, v99
    v_cvt_pk_bf16_f32 v112, v96, v97
    v_cvt_pk_bf16_f32 v113, v98, v99
    ds_write_b64 v89, v[112:113]
    v_mad_u32_u16 v104, v81, 8, s21
    v_mad_u32_u16 v106, v81, 8, s21 op_sel:[1,0,0,0]
    ds_read_b64 v[104:105], v104
    ds_read_b64 v[106:107], v106
    s_waitcnt lgkmcnt(9)
    v_mfma_f32_16x16x32_bf16 v[92:95], v[108:111], v[116:119], v[92:95]
    v_mad_u32_u16 v116, v82, 8, s21
    v_mad_u32_u16 v118, v82, 8, s21 op_sel:[1,0,0,0]
    ds_read_b64 v[116:117], v116
    ds_read_b64 v[118:119], v118
    s_waitcnt lgkmcnt(9)
    v_mfma_f32_16x16x32_bf16 v[92:95], v[108:111], v[120:123], v[92:95]
    s_waitcnt lgkmcnt(7)
    v_mfma_f32_16x16x32_bf16 v[92:95], v[108:111], v[124:127], v[92:95]
    s_cmp_gt_u32 s46, 4
    s_cbranch_scc1 K3_X132
K3_R132:
    s_waitcnt lgkmcnt(5)
    v_mfma_f32_16x16x32_bf16 v[96:99], v[108:111], v[100:103], 0
    s_nop 3
    v_mul_f32 v92, v86, v92
    v_mul_f32 v93, v86, v93
    v_mul_f32 v94, v86, v94
    v_mul_f32 v95, v86, v95
    v_cvt_pk_bf16_f32 v112, v92, v93
    v_cvt_pk_bf16_f32 v113, v94, v95
    ds_write_b64 v90, v[112:113]
    s_waitcnt lgkmcnt(3)
    v_mfma_f32_16x16x32_bf16 v[96:99], v[108:111], v[104:107], v[96:99]
    s_waitcnt lgkmcnt(1)
    v_mfma_f32_16x16x32_bf16 v[96:99], v[108:111], v[116:119], v[96:99]
    s_cmp_gt_u32 s47, 3
    s_cbranch_scc1 K3_X133
K3_R133:
    s_nop 5
    v_mul_f32 v96, v87, v96
    v_mul_f32 v97, v87, v97
    v_mul_f32 v98, v87, v98
    v_mul_f32 v99, v87, v99
    v_cvt_pk_bf16_f32 v112, v96, v97
    v_cvt_pk_bf16_f32 v113, v98, v99
    ds_write_b64 v91, v[112:113]
    s_waitcnt lgkmcnt(0)
    s_branch K3_GE
K3_EA1:
    s_setprio 2
    v_mad_u32_u16 v88, v40, 8, s23
    v_mad_u32_u16 v118, v40, 8, s22 op_sel:[1,0,0,0]
    ds_read_b64 v[116:117], v88
    ds_read_b64 v[118:119], v118
    v_mad_u32_u16 v120, v41, 8, s22
    v_mad_u32_u16 v122, v41, 8, s22 op_sel:[1,0,0,0]
    ds_read_b64 v[120:121], v120
    ds_read_b64 v[122:123], v122
    v_mad_u32_u16 v124, v42, 8, s22
    v_mad_u32_u16 v126, v42, 8, s22 op_sel:[1,0,0,0]
    ds_read_b64 v[124:125], v124
    ds_read_b64 v[126:127], v126
    v_mad_u32_u16 v100, v43, 8, s22
    v_mad_u32_u16 v102, v43, 8, s22 op_sel:[1,0,0,0]
    ds_read_b64 v[100:101], v100
    ds_read_b64 v[102:103], v102
    v_mad_u32_u16 v104, v44, 8, s22
    v_mad_u32_u16 v106, v44, 8, s22 op_sel:[1,0,0,0]
    ds_read_b64 v[104:105], v104
    ds_read_b64 v[106:107], v106
    s_waitcnt lgkmcnt(8)
    v_mfma_f32_16x16x32_bf16 v[92:95], v[108:111], v[116:119], 0
    v_mad_u32_u16 v89, v48, 8, s23
    v_mad_u32_u16 v118, v48, 8, s22 op_sel:[1,0,0,0]
    ds_read_b64 v[116:117], v89
    ds_read_b64 v[118:119], v118
    s_waitcnt lgkmcnt(8)
    v_mfma_f32_16x16x32_bf16 v[92:95], v[108:111], v[120:123], v[92:95]
    v_mad_u32_u16 v120, v49, 8, s22
    v_mad_u32_u16 v122, v49, 8, s22 op_sel:[1,0,0,0]
    ds_read_b64 v[120:121], v120
    ds_read_b64 v[122:123], v122
    s_waitcnt lgkmcnt(8)
    v_mfma_f32_16x16x32_bf16 v[92:95], v[108:111], v[124:127], v[92:95]
    v_mad_u32_u16 v124, v50, 8, s22
    v_mad_u32_u16 v126, v50, 8, s22 op_sel:[1,0,0,0]
    ds_read_b64 v[124:125], v124
    ds_read_b64 v[126:127], v126
    s_waitcnt lgkmcnt(8)
    v_mfma_f32_16x16x32_bf16 v[92:95], v[108:111], v[100:103], v[92:95]
    v_mad_u32_u16 v100, v51, 8, s22
    v_mad_u32_u16 v102, v51, 8, s22 op_sel:[1,0,0,0]
    ds_read_b64 v[100:101], v100
    ds_read_b64 v[102:103], v102
    s_waitcnt lgkmcnt(8)
    v_mfma_f32_16x16x32_bf16 v[92:95], v[108:111], v[104:107], v[92:95]
    s_cmp_gt_u32 s40, 5
    s_cbranch_scc1 K3_X120e
K3_R120e:
    v_mad_u32_u16 v90, v54, 8, s23
    v_mad_u32_u16 v106, v54, 8, s22 op_sel:[1,0,0,0]
    ds_read_b64 v[104:105], v90
    ds_read_b64 v[106:107], v106
    s_waitcnt lgkmcnt(8)
    v_mfma_f32_16x16x32_bf16 v[96:99], v[108:111], v[116:119], 0
    v_cvt_pk_bf16_f32 v112, v92, v93
    v_cvt_pk_bf16_f32 v113, v94, v95
    ds_write_b64 v88, v[112:113]
    v_mad_u32_u16 v116, v55, 8, s22
    v_mad_u32_u16 v118, v55, 8, s22 op_sel:[1,0,0,0]
    ds_read_b64 v[116:117], v116
    ds_read_b64 v[118:119], v118
    s_waitcnt lgkmcnt(9)
    v_mfma_f32_16x16x32_bf16 v[96:99], v[108:111], v[120:123], v[96:99]
    v_mad_u32_u16 v120, v56, 8, s22
    v_mad_u32_u16 v122, v56, 8, s22 op_sel:[1,0,0,0]
    ds_read_b64 v[120:121], v120
    ds_read_b64 v[122:123], v122
    s_waitcnt lgkmcnt(9)
    v_mfma_f32_16x16x32_bf16 v[96:99], v[108:111], v[124:127], v[96:99]
    v_mad_u32_u16 v124, v57, 8, s22
    v_mad_u32_u16 v126, v57, 8, s22 op_sel:[1,0,0,0]
    ds_read_b64 v[124:125], v124
    ds_read_b64 v[126:127], v126
    s_waitcnt lgkmcnt(9)
    v_mfma_f32_16x16x32_bf16 v[96:99], v[108:111], v[100:103], v[96:99]
    s_cmp_gt_u32 s41, 4
    s_cbranch_scc1 K3_X121e
K3_R121e:
    v_mad_u32_u16 v91, v59, 8, s23
    v_mad_u32_u16 v102, v59, 8, s22 op_sel:[1,0,0,0]
    ds_read_b64 v[100:101], v91
    ds_read_b64 v[102:103], v102
    s_waitcnt lgkmcnt(9)
    v_mfma_f32_16x16x32_bf16 v[92:95], v[108:111], v[104:107], 0
    v_cvt_pk_bf16_f32 v112, v96, v97
    v_cvt_pk_bf16_f32 v113, v98, v99
    ds_write_b64 v89, v[112:113]
    v_mad_u32_u16 v104, v60, 8, s22
    v_mad_u32_u16 v106, v60, 8, s22 op_sel:[1,0,0,0]
    ds_read_b64 v[104:105], v104
    ds_read_b64 v[106:107], v106
    s_waitcnt lgkmcnt(9)
    v_mfma_f32_16x16x32_bf16 v[92:95], v[108:111], v[116:119], v[92:95]
    v_mad_u32_u16 v116, v61, 8, s22
    v_mad_u32_u16 v118, v61, 8, s22 op_sel:[1,0,0,0]
    ds_read_b64 v[116:117], v116
    ds_read_b64 v[118:119], v118
    s_waitcnt lgkmcnt(9)
    v_mfma_f32_16x16x32_bf16 v[92:95], v[108:111], v[120:123], v[92:95]
    s_waitcnt lgkmcnt(7)
    v_mfma_f32_16x16x32_bf16 v[92:95], v[108:111], v[124:127], v[92:95]
    s_cmp_gt_u32 s42, 4
    s_cbranch_scc1 K3_X122e
K3_R122e:
    s_waitcnt lgkmcnt(5)
    v_mfma_f32_16x16x32_bf16 v[96:99], v[108:111], v[100:103], 0
    s_nop 3
    v_cvt_pk_bf16_f32 v112, v92, v93
    v_cvt_pk_bf16_f32 v113, v94, v95
    ds_write_b64 v90, v[112:113]
    s_waitcnt lgkmcnt(3)
    v_mfma_f32_16x16x32_bf16 v[96:99], v[108:111], v[104:107], v[96:99]
    s_waitcnt lgkmcnt(1)
    v_mfma_f32_16x16x32_bf16 v[96:99], v[108:111], v[116:119], v[96:99]
    s_cmp_gt_u32 s43, 3
    s_cbranch_scc1 K3_X123e
K3_R123e:
    s_nop 5
    v_cvt_pk_bf16_f32 v112, v96, v97
    v_cvt_pk_bf16_f32 v113, v98, v99
    ds_write_b64 v91, v[112:113]
    v_mov_b32 v0, s11
    v_writelane_b32 v0, s69, 1
    v_mov_b32 v1, 1
    s_mul_i32 s66, s20, 4
    s_add_u32 s66, s66, 4
    s_add_u32 s67, s20, 1
    s_lshl_b32 s67, s67, 1
    s_mov_b64 exec, 3
    s_waitcnt lgkmcnt(0)
    ds_add_u32 v0, v1
    v_mov_b32 v112, s66
    v_writelane_b32 v112, s67, 1
    v_writelane_b32 v0, s71, 1
HO_17:
    ds_read_b32 v1, v0
    s_waitcnt lgkmcnt(0)
    v_cmp_gt_u32 vcc, v112, v1
    s_nop 0
    s_cbranch_vccz HO_17_E
    s_sleep 1
    s_branch HO_17
HO_17_E:
    s_mov_b64 exec, -1
    s_waitcnt vmcnt(0)
K3_EB1:
    s_setprio 2
    v_mad_u32_u16 v88, v64, 8, s23
    v_mad_u32_u16 v118, v64, 8, s21 op_sel:[1,0,0,0]
    ds_read_b64 v[116:117], v88
    ds_read_b64 v[118:119], v118
    v_mad_u32_u16 v120, v65, 8, s21
    v_mad_u32_u16 v122, v65, 8, s21 op_sel:[1,0,0,0]
    ds_read_b64 v[120:121], v120
    ds_read_b64 v[122:123], v122
    v_mad_u32_u16 v124, v66, 8, s21
    v_mad_u32_u16 v126, v66, 8, s21 op_sel:[1,0,0,0]
    ds_read_b64 v[124:125], v124
    ds_read_b64 v[126:127], v126
    v_mad_u32_u16 v100, v67, 8, s21
    v_mad_u32_u16 v102, v67, 8, s21 op_sel:[1,0,0,0]
    ds_read_b64 v[100:101], v100
    ds_read_b64 v[102:103], v102
    v_mad_u32_u16 v104, v68, 8, s21
    v_mad_u32_u16 v106, v68, 8, s21 op_sel:[1,0,0,0]
    ds_read_b64 v[104:105], v104
    ds_read_b64 v[106:107], v106
    s_waitcnt lgkmcnt(8)
    v_mfma_f32_16x16x32_bf16 v[92:95], v[108:111], v[116:119], 0
    v_mad_u32_u16 v89, v71, 8, s23
    v_mad_u32_u16 v118, v71, 8, s21 op_sel:[1,0,0,0]
    ds_read_b64 v[116:117], v89
    ds_read_b64 v[118:119], v118
    s_waitcnt lgkmcnt(8)
    v_mfma_f32_16x16x32_bf16 v[92:95], v[108:111], v[120:123], v[92:95]
    v_mad_u32_u16 v120, v72, 8, s21
    v_mad_u32_u16 v122, v72, 8, s21 op_sel:[1,0,0,0]
    ds_read_b64 v[120:121], v120
    ds_read_b64 v[122:123], v122
    s_waitcnt lgkmcnt(8)
    v_mfma_f32_16x16x32_bf16 v[92:95], v[108:111], v[124:127], v[92:95]
    v_mad_u32_u16 v124, v73, 8, s21
    v_mad_u32_u16 v126, v73, 8, s21 op_sel:[1,0,0,0]
    ds_read_b64 v[124:125], v124
    ds_read_b64 v[126:127], v126
    s_waitcnt lgkmcnt(8)
    v_mfma_f32_16x16x32_bf16 v[92:95], v[108:111], v[100:103], v[92:95]
    v_mad_u32_u16 v100, v74, 8, s21
    v_mad_u32_u16 v102, v74, 8, s21 op_sel:[1,0,0,0]
    ds_read_b64 v[100:101], v100
    ds_read_b64 v[102:103], v102
    s_waitcnt lgkmcnt(8)
    v_mfma_f32_16x16x32_bf16 v[92:95], v[108:111], v[104:107], v[92:95]
    s_cmp_gt_u32 s44, 5
    s_cbranch_scc1 K3_X130e
K3_R130e:
    v_mad_u32_u16 v90, v76, 8, s23
    v_mad_u32_u16 v106, v76, 8, s21 op_sel:[1,0,0,0]
    ds_read_b64 v[104:105], v90
    ds_read_b64 v[106:107], v106
    s_waitcnt lgkmcnt(8)
    v_mfma_f32_16x16x32_bf16 v[96:99], v[108:111], v[116:119], 0
    v_mul_f32 v92, v84, v92
    v_mul_f32 v93, v84, v93
    v_mul_f32 v94, v84, v94
    v_mul_f32 v95, v84, v95
    v_cvt_pk_bf16_f32 v112, v92, v93
    v_cvt_pk_bf16_f32 v113, v94, v95
    ds_write_b64 v88, v[112:113]
    v_mad_u32_u16 v116, v77, 8, s21
    v_mad_u32_u16 v118, v77, 8, s21 op_sel:[1,0,0,0]
    ds_read_b64 v[116:117], v116
    ds_read_b64 v[118:119], v118
    s_waitcnt lgkmcnt(9)
    v_mfma_f32_16x16x32_bf16 v[96:99], v[108:111], v[120:123], v[96:99]
    v_mad_u32_u16 v120, v78, 8, s21
    v_mad_u32_u16 v122, v78, 8, s21 op_sel:[1,0,0,0]
    ds_read_b64 v[120:121], v120
    ds_read_b64 v[122:123], v122
    s_waitcnt lgkmcnt(9)
    v_mfma_f32_16x16x32_bf16 v[96:99], v[108:111], v[124:127], v[96:99]
    v_mad_u32_u16 v124, v79, 8, s21
    v_mad_u32_u16 v126, v79, 8, s21 op_sel:[1,0,0,0]
    ds_read_b64 v[124:125], v124
    ds_read_b64 v[126:127], v126
    s_waitcnt lgkmcnt(9)
    v_mfma_f32_16x16x32_bf16 v[96:99], v[108:111], v[100:103], v[96:99]
    s_cmp_gt_u32 s45, 4
    s_cbranch_scc1 K3_X131e
K3_R131e:
    v_mad_u32_u16 v91, v80, 8, s23
    v_mad_u32_u16 v102, v80, 8, s21 op_sel:[1,0,0,0]
    ds_read_b64 v[100:101], v91
    ds_read_b64 v[102:103], v102
    s_waitcnt lgkmcnt(9)
    v_mfma_f32_16x16x32_bf16 v[92:95], v[108:111], v[104:107], 0
    v_mul_f32 v96, v85, v96
    v_mul_f32 v97, v85, v97
    v_mul_f32 v98, v85, v98
    v_mul_f32 v99, v85, v99
    v_cvt_pk_bf16_f32 v112, v96, v97
    v_cvt_pk_bf16_f32 v113, v98, v99
    ds_write_b64 v89, v[112:113]
    v_mad_u32_u16 v104, v81, 8, s21
    v_mad_u32_u16 v106, v81, 8, s21 op_sel:[1,0,0,0]
    ds_read_b64 v[104:105], v104
    ds_read_b64 v[106:107], v106
    s_waitcnt lgkmcnt(9)
    v_mfma_f32_16x16x32_bf16 v[92:95], v[108:111], v[116:119], v[92:95]
    v_mad_u32_u16 v116, v82, 8, s21
    v_mad_u32_u16 v118, v82, 8, s21 op_sel:[1,0,0,0]
    ds_read_b64 v[116:117], v116
    ds_read_b64 v[118:119], v118
    s_waitcnt lgkmcnt(9)
    v_mfma_f32_16x16x32_bf16 v[92:95], v[108:111], v[120:123], v[92:95]
    s_waitcnt lgkmcnt(7)
    v_mfma_f32_16x16x32_bf16 v[92:95], v[108:111], v[124:127], v[92:95]
    s_cmp_gt_u32 s46, 4
    s_cbranch_scc1 K3_X132e
K3_R132e:
    s_waitcnt lgkmcnt(5)
    v_mfma_f32_16x16x32_bf16 v[96:99], v[108:111], v[100:103], 0
    s_nop 3
    v_mul_f32 v92, v86, v92
    v_mul_f32 v93, v86, v93
    v_mul_f32 v94, v86, v94
    v_mul_f32 v95, v86, v95
    v_cvt_pk_bf16_f32 v112, v92, v93
    v_cvt_pk_bf16_f32 v113, v94, v95
    ds_write_b64 v90, v[112:113]
    s_waitcnt lgkmcnt(3)
    v_mfma_f32_16x16x32_bf16 v[96:99], v[108:111], v[104:107], v[96:99]
    s_waitcnt lgkmcnt(1)
    v_mfma_f32_16x16x32_bf16 v[96:99], v[108:111], v[116:119], v[96:99]
    s_cmp_gt_u32 s47, 3
    s_cbranch_scc1 K3_X133e
K3_R133e:
    s_nop 5
    v_mul_f32 v96, v87, v96
    v_mul_f32 v97, v87, v97
    v_mul_f32 v98, v87, v98
    v_mul_f32 v99, v87, v99
    v_cvt_pk_bf16_f32 v112, v96, v97
    v_cvt_pk_bf16_f32 v113, v98, v99
    ds_write_b64 v91, v[112:113]
    s_waitcnt lgkmcnt(0)
K3_GE:
    v_mov_b32 v0, 154880
    v_mov_b32 v1, 1
    s_mov_b64 exec, 1
    ds_add_u32 v0, v1 offset:44
    s_mov_b64 exec, -1
    s_setprio 3
    s_lshr_b32 s10, s4, 1
    s_lshl_b32 s64, s10, 2
    s_add_u32 s64, s64, 154960
    v_mov_b32 v0, s64
    s_mov_b64 exec, 1
    ds_add_rtn_u32 v1, v0, v1
    s_mov_b64 exec, -1
    s_mul_i32 s64, s10, 3584
    v_add_u32 v124, s64, v114
    v_add_u32 v125, 129536, v124
    s_waitcnt lgkmcnt(0)
    v_readfirstlane_b32 s65, v1
    s_bitcmp1_b32 s65, 0
    s_cbranch_scc0 K3_E2
    ds_read_b128 v[92:95], v125 offset:0
    ds_read_b128 v[96:99], v125 offset:1024
    ds_read_b128 v[100:103], v125 offset:2048
    ds_read_b128 v[104:107], v125 offset:3072
    s_waitcnt lgkmcnt(3)
    buffer_store_dwordx4 v[92:95], v124, s[16:19], 0 offen offset:0 sc1
    s_waitcnt lgkmcnt(2)
    buffer_store_dwordx4 v[96:99], v124, s[16:19], 0 offen offset:1024 sc1
    s_waitcnt lgkmcnt(1)
    buffer_store_dwordx4 v[100:103], v124, s[16:19], 0 offen offset:2048 sc1
    s_waitcnt lgkmcnt(0)
    s_mov_b32 exec_hi, 0
    buffer_store_dwordx4 v[104:107], v124, s[16:19], 0 offen offset:3072 sc1
    s_mov_b64 exec, -1
    s_mov_b32 s7, 1
    s_cmp_ge_u32 s4, 10
    s_cbranch_scc1 K3_E2
    s_mov_b32 s7, 0
    s_add_u32 s10, s20, 1
    v_mov_b32 v1, s10
    s_mov_b64 exec, 1
    s_waitcnt vmcnt(0)
    buffer_store_dword v1, off, s[28:31], s6 sc1
    s_cmp_ge_u32 s4, 4
    s_cselect_b32 s64, 4, 0
    s_add_u32 s64, s64, 154880
    v_mov_b32 v0, s64
    v_mov_b32 v112, 1
    ds_add_u32 v0, v112
    s_mov_b64 exec, -1
K3_E2:
    s_setprio 0
    s_cmp_eq_u32 s20, 6
    s_cbranch_scc1 K3_END
    v_mov_b32 v0, 154880
    s_add_u32 s66, s20, 1
    s_mul_i32 s66, s66, 14
SP_18:
    ds_read_b32 v1, v0 offset:44
    s_waitcnt lgkmcnt(0)
    v_readfirstlane_b32 s67, v1
    s_cmp_ge_u32 s67, s66
    s_cbranch_scc1 SP_18_E
    s_sleep 1
    s_branch SP_18
SP_18_E:
    s_add_u32 s20, s20, 1
    s_add_u32 s16, s16, 6422528
    s_addc_u32 s17, s17, 0
    s_add_u32 s12, s12, 6422528
    s_addc_u32 s13, s13, 0
    s_mov_b32 s10, s21
    s_mov_b32 s21, s22
    s_mov_b32 s22, s10
    s_branch K3_GOWN
K3_X000:
    v_mad_u32_u16 v124, v7, 8, s23
    v_mad_u32_u16 v126, v7, 8, s23 op_sel:[1,0,0,0]
    ds_read_b64 v[124:125], v124
    ds_read_b64 v[126:127], v126
    s_waitcnt lgkmcnt(0)
    v_mfma_f32_16x16x32_bf16 v[92:95], v[108:111], v[124:127], v[92:95]
    s_cmp_le_u32 s32, 4
    s_cbranch_scc1 K3_Y000
    v_mad_u32_u16 v124, v8, 8, s23
    v_mad_u32_u16 v126, v8, 8, s23 op_sel:[1,0,0,0]
    ds_read_b64 v[124:125], v124
    ds_read_b64 v[126:127], v126
    s_waitcnt lgkmcnt(0)
    v_mfma_f32_16x16x32_bf16 v[92:95], v[108:111], v[124:127], v[92:95]
    s_cmp_le_u32 s32, 5
    s_cbranch_scc1 K3_Y000
    v_mad_u32_u16 v124, v9, 8, s23
    v_mad_u32_u16 v126, v9, 8, s23 op_sel:[1,0,0,0]
    ds_read_b64 v[124:125], v124
    ds_read_b64 v[126:127], v126
    s_waitcnt lgkmcnt(0)
    v_mfma_f32_16x16x32_bf16 v[92:95], v[108:111], v[124:127], v[92:95]
    s_cmp_le_u32 s32, 6
    s_cbranch_scc1 K3_Y000
    s_mov_b32 s64, s48
    s_sub_u32 s65, s32, 6
    v_lshrrev_b32 v0, 2, v114
K3_O000:
    buffer_load_dword v1, v0, s[24:27], s64 offen
    s_add_u32 s64, s64, 256
    s_waitcnt vmcnt(0)
    v_mad_u32_u16 v124, v1, 8, s23
    v_mad_u32_u16 v126, v1, 8, s23 op_sel:[1,0,0,0]
    ds_read_b64 v[124:125], v124
    ds_read_b64 v[126:127], v126
    s_waitcnt lgkmcnt(0)
    v_mfma_f32_16x16x32_bf16 v[92:95], v[108:111], v[124:127], v[92:95]
    s_sub_u32 s65, s65, 1
    s_cmp_lg_u32 s65, 0
    s_cbranch_scc1 K3_O000
K3_Y000:
    s_branch K3_R000
K3_X001:
    v_mad_u32_u16 v120, v13, 8, s23
    v_mad_u32_u16 v122, v13, 8, s23 op_sel:[1,0,0,0]
    ds_read_b64 v[120:121], v120
    ds_read_b64 v[122:123], v122
    s_waitcnt lgkmcnt(0)
    v_mfma_f32_16x16x32_bf16 v[96:99], v[108:111], v[120:123], v[96:99]
    s_cmp_le_u32 s33, 4
    s_cbranch_scc1 K3_Y001
    v_mad_u32_u16 v120, v14, 8, s23
    v_mad_u32_u16 v122, v14, 8, s23 op_sel:[1,0,0,0]
    ds_read_b64 v[120:121], v120
    ds_read_b64 v[122:123], v122
    s_waitcnt lgkmcnt(0)
    v_mfma_f32_16x16x32_bf16 v[96:99], v[108:111], v[120:123], v[96:99]
    s_cmp_le_u32 s33, 5
    s_cbranch_scc1 K3_Y001
    v_mad_u32_u16 v120, v15, 8, s23
    v_mad_u32_u16 v122, v15, 8, s23 op_sel:[1,0,0,0]
    ds_read_b64 v[120:121], v120
    ds_read_b64 v[122:123], v122
    s_waitcnt lgkmcnt(0)
    v_mfma_f32_16x16x32_bf16 v[96:99], v[108:111], v[120:123], v[96:99]
    s_cmp_le_u32 s33, 6
    s_cbranch_scc1 K3_Y001
    s_mov_b32 s64, s49
    s_sub_u32 s65, s33, 6
    v_lshrrev_b32 v0, 2, v114
K3_O001:
    buffer_load_dword v1, v0, s[24:27], s64 offen
    s_add_u32 s64, s64, 256
    s_waitcnt vmcnt(0)
    v_mad_u32_u16 v120, v1, 8, s23
    v_mad_u32_u16 v122, v1, 8, s23 op_sel:[1,0,0,0]
    ds_read_b64 v[120:121], v120
    ds_read_b64 v[122:123], v122
    s_waitcnt lgkmcnt(0)
    v_mfma_f32_16x16x32_bf16 v[96:99], v[108:111], v[120:123], v[96:99]
    s_sub_u32 s65, s65, 1
    s_cmp_lg_u32 s65, 0
    s_cbranch_scc1 K3_O001
K3_Y001:
    s_branch K3_R001
K3_X002:
    v_mad_u32_u16 v116, v19, 8, s23
    v_mad_u32_u16 v118, v19, 8, s23 op_sel:[1,0,0,0]
    ds_read_b64 v[116:117], v116
    ds_read_b64 v[118:119], v118
    s_waitcnt lgkmcnt(0)
    v_mfma_f32_16x16x32_bf16 v[100:103], v[108:111], v[116:119], v[100:103]
    s_cmp_le_u32 s34, 4
    s_cbranch_scc1 K3_Y002
    v_mad_u32_u16 v116, v20, 8, s23
    v_mad_u32_u16 v118, v20, 8, s23 op_sel:[1,0,0,0]
    ds_read_b64 v[116:117], v116
    ds_read_b64 v[118:119], v118
    s_waitcnt lgkmcnt(0)
    v_mfma_f32_16x16x32_bf16 v[100:103], v[108:111], v[116:119], v[100:103]
    s_cmp_le_u32 s34, 5
    s_cbranch_scc1 K3_Y002
    v_mad_u32_u16 v116, v21, 8, s23
    v_mad_u32_u16 v118, v21, 8, s23 op_sel:[1,0,0,0]
    ds_read_b64 v[116:117], v116
    ds_read_b64 v[118:119], v118
    s_waitcnt lgkmcnt(0)
    v_mfma_f32_16x16x32_bf16 v[100:103], v[108:111], v[116:119], v[100:103]
    s_cmp_le_u32 s34, 6
    s_cbranch_scc1 K3_Y002
    s_mov_b32 s64, s50
    s_sub_u32 s65, s34, 6
    v_lshrrev_b32 v0, 2, v114
K3_O002:
    buffer_load_dword v1, v0, s[24:27], s64 offen
    s_add_u32 s64, s64, 256
    s_waitcnt vmcnt(0)
    v_mad_u32_u16 v116, v1, 8, s23
    v_mad_u32_u16 v118, v1, 8, s23 op_sel:[1,0,0,0]
    ds_read_b64 v[116:117], v116
    ds_read_b64 v[118:119], v118
    s_waitcnt lgkmcnt(0)
    v_mfma_f32_16x16x32_bf16 v[100:103], v[108:111], v[116:119], v[100:103]
    s_sub_u32 s65, s65, 1
    s_cmp_lg_u32 s65, 0
    s_cbranch_scc1 K3_O002
K3_Y002:
    s_branch K3_R002
K3_X010:
    v_mad_u32_u16 v120, v30, 8, s21
    v_mad_u32_u16 v122, v30, 8, s21 op_sel:[1,0,0,0]
    ds_read_b64 v[120:121], v120
    ds_read_b64 v[122:123], v122
    s_waitcnt lgkmcnt(0)
    v_mfma_f32_16x16x32_bf16 v[92:95], v[108:111], v[120:123], v[92:95]
    s_cmp_le_u32 s36, 7
    s_cbranch_scc1 K3_Y010
    v_mad_u32_u16 v120, v31, 8, s21
    v_mad_u32_u16 v122, v31, 8, s21 op_sel:[1,0,0,0]
    ds_read_b64 v[120:121], v120
    ds_read_b64 v[122:123], v122
    s_waitcnt lgkmcnt(0)
    v_mfma_f32_16x16x32_bf16 v[92:95], v[108:111], v[120:123], v[92:95]
    s_cmp_le_u32 s36, 8
    s_cbranch_scc1 K3_Y010
    s_mov_b32 s64, s52
    s_sub_u32 s65, s36, 8
    v_lshrrev_b32 v0, 2, v114
K3_O010:
    buffer_load_dword v1, v0, s[24:27], s64 offen
    s_add_u32 s64, s64, 256
    s_waitcnt vmcnt(0)
    v_mad_u32_u16 v120, v1, 8, s21
    v_mad_u32_u16 v122, v1, 8, s21 op_sel:[1,0,0,0]
    ds_read_b64 v[120:121], v120
    ds_read_b64 v[122:123], v122
    s_waitcnt lgkmcnt(0)
    v_mfma_f32_16x16x32_bf16 v[92:95], v[108:111], v[120:123], v[92:95]
    s_sub_u32 s65, s65, 1
    s_cmp_lg_u32 s65, 0
    s_cbranch_scc1 K3_O010
K3_Y010:
    s_branch K3_R010
K3_X011:
    v_mad_u32_u16 v120, v36, 8, s21
    v_mad_u32_u16 v122, v36, 8, s21 op_sel:[1,0,0,0]
    ds_read_b64 v[120:121], v120
    ds_read_b64 v[122:123], v122
    s_waitcnt lgkmcnt(0)
    v_mfma_f32_16x16x32_bf16 v[96:99], v[108:111], v[120:123], v[96:99]
    s_cmp_le_u32 s37, 5
    s_cbranch_scc1 K3_Y011
    s_mov_b32 s64, s53
    s_sub_u32 s65, s37, 5
    v_lshrrev_b32 v0, 2, v114
K3_O011:
    buffer_load_dword v1, v0, s[24:27], s64 offen
    s_add_u32 s64, s64, 256
    s_waitcnt vmcnt(0)
    v_mad_u32_u16 v120, v1, 8, s21
    v_mad_u32_u16 v122, v1, 8, s21 op_sel:[1,0,0,0]
    ds_read_b64 v[120:121], v120
    ds_read_b64 v[122:123], v122
    s_waitcnt lgkmcnt(0)
    v_mfma_f32_16x16x32_bf16 v[96:99], v[108:111], v[120:123], v[96:99]
    s_sub_u32 s65, s65, 1
    s_cmp_lg_u32 s65, 0
    s_cbranch_scc1 K3_O011
K3_Y011:
    s_branch K3_R011
K3_X012:
    v_mad_u32_u16 v88, v39, 8, s21
    v_mad_u32_u16 v90, v39, 8, s21 op_sel:[1,0,0,0]
    ds_read_b64 v[88:89], v88
    ds_read_b64 v[90:91], v90
    s_waitcnt lgkmcnt(0)
    v_mfma_f32_16x16x32_bf16 v[100:103], v[108:111], v[88:91], v[100:103]
    s_cmp_le_u32 s38, 3
    s_cbranch_scc1 K3_Y012
    s_mov_b32 s64, s54
    s_sub_u32 s65, s38, 3
    v_lshrrev_b32 v0, 2, v114
K3_O012:
    buffer_load_dword v1, v0, s[24:27], s64 offen
    s_add_u32 s64, s64, 256
    s_waitcnt vmcnt(0)
    v_mad_u32_u16 v88, v1, 8, s21
    v_mad_u32_u16 v90, v1, 8, s21 op_sel:[1,0,0,0]
    ds_read_b64 v[88:89], v88
    ds_read_b64 v[90:91], v90
    s_waitcnt lgkmcnt(0)
    v_mfma_f32_16x16x32_bf16 v[100:103], v[108:111], v[88:91], v[100:103]
    s_sub_u32 s65, s65, 1
    s_cmp_lg_u32 s65, 0
    s_cbranch_scc1 K3_O012
K3_Y012:
    s_branch K3_R012
K3_X020:
    v_mad_u32_u16 v120, v47, 8, s22
    v_mad_u32_u16 v122, v47, 8, s22 op_sel:[1,0,0,0]
    ds_read_b64 v[120:121], v120
    ds_read_b64 v[122:123], v122
    s_waitcnt lgkmcnt(0)
    v_mfma_f32_16x16x32_bf16 v[92:95], v[108:111], v[120:123], v[92:95]
    s_cmp_le_u32 s40, 8
    s_cbranch_scc1 K3_Y020
    v_mad_u32_u16 v120, v48, 8, s22
    v_mad_u32_u16 v122, v48, 8, s22 op_sel:[1,0,0,0]
    ds_read_b64 v[120:121], v120
    ds_read_b64 v[122:123], v122
    s_waitcnt lgkmcnt(0)
    v_mfma_f32_16x16x32_bf16 v[92:95], v[108:111], v[120:123], v[92:95]
    s_cmp_le_u32 s40, 9
    s_cbranch_scc1 K3_Y020
    v_mad_u32_u16 v120, v49, 8, s22
    v_mad_u32_u16 v122, v49, 8, s22 op_sel:[1,0,0,0]
    ds_read_b64 v[120:121], v120
    ds_read_b64 v[122:123], v122
    s_waitcnt lgkmcnt(0)
    v_mfma_f32_16x16x32_bf16 v[92:95], v[108:111], v[120:123], v[92:95]
    s_cmp_le_u32 s40, 10
    s_cbranch_scc1 K3_Y020
    v_mad_u32_u16 v120, v50, 8, s22
    v_mad_u32_u16 v122, v50, 8, s22 op_sel:[1,0,0,0]
    ds_read_b64 v[120:121], v120
    ds_read_b64 v[122:123], v122
    s_waitcnt lgkmcnt(0)
    v_mfma_f32_16x16x32_bf16 v[92:95], v[108:111], v[120:123], v[92:95]
    s_cmp_le_u32 s40, 11
    s_cbranch_scc1 K3_Y020
    s_mov_b32 s64, s56
    s_sub_u32 s65, s40, 11
    v_lshrrev_b32 v0, 2, v114
K3_O020:
    buffer_load_dword v1, v0, s[24:27], s64 offen
    s_add_u32 s64, s64, 256
    s_waitcnt vmcnt(0)
    v_mad_u32_u16 v120, v1, 8, s22
    v_mad_u32_u16 v122, v1, 8, s22 op_sel:[1,0,0,0]
    ds_read_b64 v[120:121], v120
    ds_read_b64 v[122:123], v122
    s_waitcnt lgkmcnt(0)
    v_mfma_f32_16x16x32_bf16 v[92:95], v[108:111], v[120:123], v[92:95]
    s_sub_u32 s65, s65, 1
    s_cmp_lg_u32 s65, 0
    s_cbranch_scc1 K3_O020
K3_Y020:
    s_branch K3_R020
K3_X021:
    v_mad_u32_u16 v120, v56, 8, s22
    v_mad_u32_u16 v122, v56, 8, s22 op_sel:[1,0,0,0]
    ds_read_b64 v[120:121], v120
    ds_read_b64 v[122:123], v122
    s_waitcnt lgkmcnt(0)
    v_mfma_f32_16x16x32_bf16 v[96:99], v[108:111], v[120:123], v[96:99]
    s_cmp_le_u32 s41, 6
    s_cbranch_scc1 K3_Y021
    v_mad_u32_u16 v120, v57, 8, s22
    v_mad_u32_u16 v122, v57, 8, s22 op_sel:[1,0,0,0]
    ds_read_b64 v[120:121], v120
    ds_read_b64 v[122:123], v122
    s_waitcnt lgkmcnt(0)
    v_mfma_f32_16x16x32_bf16 v[96:99], v[108:111], v[120:123], v[96:99]
    s_cmp_le_u32 s41, 7
    s_cbranch_scc1 K3_Y021
    s_mov_b32 s64, s57
    s_sub_u32 s65, s41, 7
    v_lshrrev_b32 v0, 2, v114
K3_O021:
    buffer_load_dword v1, v0, s[24:27], s64 offen
    s_add_u32 s64, s64, 256
    s_waitcnt vmcnt(0)
    v_mad_u32_u16 v120, v1, 8, s22
    v_mad_u32_u16 v122, v1, 8, s22 op_sel:[1,0,0,0]
    ds_read_b64 v[120:121], v120
    ds_read_b64 v[122:123], v122
    s_waitcnt lgkmcnt(0)
    v_mfma_f32_16x16x32_bf16 v[96:99], v[108:111], v[120:123], v[96:99]
    s_sub_u32 s65, s65, 1
    s_cmp_lg_u32 s65, 0
    s_cbranch_scc1 K3_O021
K3_Y021:
    s_branch K3_R021
K3_X022:
    v_mad_u32_u16 v104, v61, 8, s22
    v_mad_u32_u16 v106, v61, 8, s22 op_sel:[1,0,0,0]
    ds_read_b64 v[104:105], v104
    ds_read_b64 v[106:107], v106
    s_waitcnt lgkmcnt(0)
    v_mfma_f32_16x16x32_bf16 v[92:95], v[108:111], v[104:107], v[92:95]
    s_cmp_le_u32 s42, 4
    s_cbranch_scc1 K3_Y022
    v_mad_u32_u16 v104, v62, 8, s22
    v_mad_u32_u16 v106, v62, 8, s22 op_sel:[1,0,0,0]
    ds_read_b64 v[104:105], v104
    ds_read_b64 v[106:107], v106
    s_waitcnt lgkmcnt(0)
    v_mfma_f32_16x16x32_bf16 v[92:95], v[108:111], v[104:107], v[92:95]
    s_cmp_le_u32 s42, 5
    s_cbranch_scc1 K3_Y022
    v_mad_u32_u16 v104, v63, 8, s22
    v_mad_u32_u16 v106, v63, 8, s22 op_sel:[1,0,0,0]
    ds_read_b64 v[104:105], v104
    ds_read_b64 v[106:107], v106
    s_waitcnt lgkmcnt(0)
    v_mfma_f32_16x16x32_bf16 v[92:95], v[108:111], v[104:107], v[92:95]
    s_cmp_le_u32 s42, 6
    s_cbranch_scc1 K3_Y022
    s_mov_b32 s64, s58
    s_sub_u32 s65, s42, 6
    v_lshrrev_b32 v0, 2, v114
K3_O022:
    buffer_load_dword v1, v0, s[24:27], s64 offen
    s_add_u32 s64, s64, 256
    s_waitcnt vmcnt(0)
    v_mad_u32_u16 v104, v1, 8, s22
    v_mad_u32_u16 v106, v1, 8, s22 op_sel:[1,0,0,0]
    ds_read_b64 v[104:105], v104
    ds_read_b64 v[106:107], v106
    s_waitcnt lgkmcnt(0)
    v_mfma_f32_16x16x32_bf16 v[92:95], v[108:111], v[104:107], v[92:95]
    s_sub_u32 s65, s65, 1
    s_cmp_lg_u32 s65, 0
    s_cbranch_scc1 K3_O022
K3_Y022:
    s_branch K3_R022
K3_X030:
    v_mad_u32_u16 v120, v71, 8, s21
    v_mad_u32_u16 v122, v71, 8, s21 op_sel:[1,0,0,0]
    ds_read_b64 v[120:121], v120
    ds_read_b64 v[122:123], v122
    s_waitcnt lgkmcnt(0)
    v_mfma_f32_16x16x32_bf16 v[92:95], v[108:111], v[120:123], v[92:95]
    s_cmp_le_u32 s44, 8
    s_cbranch_scc1 K3_Y030
    v_mad_u32_u16 v120, v72, 8, s21
    v_mad_u32_u16 v122, v72, 8, s21 op_sel:[1,0,0,0]
    ds_read_b64 v[120:121], v120
    ds_read_b64 v[122:123], v122
    s_waitcnt lgkmcnt(0)
    v_mfma_f32_16x16x32_bf16 v[92:95], v[108:111], v[120:123], v[92:95]
    s_cmp_le_u32 s44, 9
    s_cbranch_scc1 K3_Y030
    v_mad_u32_u16 v120, v73, 8, s21
    v_mad_u32_u16 v122, v73, 8, s21 op_sel:[1,0,0,0]
    ds_read_b64 v[120:121], v120
    ds_read_b64 v[122:123], v122
    s_waitcnt lgkmcnt(0)
    v_mfma_f32_16x16x32_bf16 v[92:95], v[108:111], v[120:123], v[92:95]
    s_cmp_le_u32 s44, 10
    s_cbranch_scc1 K3_Y030
    s_mov_b32 s64, s60
    s_sub_u32 s65, s44, 10
    v_lshrrev_b32 v0, 2, v114
K3_O030:
    buffer_load_dword v1, v0, s[24:27], s64 offen
    s_add_u32 s64, s64, 256
    s_waitcnt vmcnt(0)
    v_mad_u32_u16 v120, v1, 8, s21
    v_mad_u32_u16 v122, v1, 8, s21 op_sel:[1,0,0,0]
    ds_read_b64 v[120:121], v120
    ds_read_b64 v[122:123], v122
    s_waitcnt lgkmcnt(0)
    v_mfma_f32_16x16x32_bf16 v[92:95], v[108:111], v[120:123], v[92:95]
    s_sub_u32 s65, s65, 1
    s_cmp_lg_u32 s65, 0
    s_cbranch_scc1 K3_O030
K3_Y030:
    s_branch K3_R030
K3_X031:
    v_mad_u32_u16 v120, v79, 8, s21
    v_mad_u32_u16 v122, v79, 8, s21 op_sel:[1,0,0,0]
    ds_read_b64 v[120:121], v120
    ds_read_b64 v[122:123], v122
    s_waitcnt lgkmcnt(0)
    v_mfma_f32_16x16x32_bf16 v[96:99], v[108:111], v[120:123], v[96:99]
    s_cmp_le_u32 s45, 6
    s_cbranch_scc1 K3_Y031
    s_mov_b32 s64, s61
    s_sub_u32 s65, s45, 6
    v_lshrrev_b32 v0, 2, v114
K3_O031:
    buffer_load_dword v1, v0, s[24:27], s64 offen
    s_add_u32 s64, s64, 256
    s_waitcnt vmcnt(0)
    v_mad_u32_u16 v120, v1, 8, s21
    v_mad_u32_u16 v122, v1, 8, s21 op_sel:[1,0,0,0]
    ds_read_b64 v[120:121], v120
    ds_read_b64 v[122:123], v122
    s_waitcnt lgkmcnt(0)
    v_mfma_f32_16x16x32_bf16 v[96:99], v[108:111], v[120:123], v[96:99]
    s_sub_u32 s65, s65, 1
    s_cmp_lg_u32 s65, 0
    s_cbranch_scc1 K3_O031
K3_Y031:
    s_branch K3_R031
K3_X032:
    v_mad_u32_u16 v104, v83, 8, s21
    v_mad_u32_u16 v106, v83, 8, s21 op_sel:[1,0,0,0]
    ds_read_b64 v[104:105], v104
    ds_read_b64 v[106:107], v106
    s_waitcnt lgkmcnt(0)
    v_mfma_f32_16x16x32_bf16 v[92:95], v[108:111], v[104:107], v[92:95]
    s_cmp_le_u32 s46, 4
    s_cbranch_scc1 K3_Y032
    s_mov_b32 s64, s62
    s_sub_u32 s65, s46, 4
    v_lshrrev_b32 v0, 2, v114
K3_O032:
    buffer_load_dword v1, v0, s[24:27], s64 offen
    s_add_u32 s64, s64, 256
    s_waitcnt vmcnt(0)
    v_mad_u32_u16 v104, v1, 8, s21
    v_mad_u32_u16 v106, v1, 8, s21 op_sel:[1,0,0,0]
    ds_read_b64 v[104:105], v104
    ds_read_b64 v[106:107], v106
    s_waitcnt lgkmcnt(0)
    v_mfma_f32_16x16x32_bf16 v[92:95], v[108:111], v[104:107], v[92:95]
    s_sub_u32 s65, s65, 1
    s_cmp_lg_u32 s65, 0
    s_cbranch_scc1 K3_O032
K3_Y032:
    s_branch K3_R032
K3_X020e:
    v_mad_u32_u16 v120, v47, 8, s22
    v_mad_u32_u16 v122, v47, 8, s22 op_sel:[1,0,0,0]
    ds_read_b64 v[120:121], v120
    ds_read_b64 v[122:123], v122
    s_waitcnt lgkmcnt(0)
    v_mfma_f32_16x16x32_bf16 v[92:95], v[108:111], v[120:123], v[92:95]
    s_cmp_le_u32 s40, 8
    s_cbranch_scc1 K3_Y020e
    v_mad_u32_u16 v120, v48, 8, s22
    v_mad_u32_u16 v122, v48, 8, s22 op_sel:[1,0,0,0]
    ds_read_b64 v[120:121], v120
    ds_read_b64 v[122:123], v122
    s_waitcnt lgkmcnt(0)
    v_mfma_f32_16x16x32_bf16 v[92:95], v[108:111], v[120:123], v[92:95]
    s_cmp_le_u32 s40, 9
    s_cbranch_scc1 K3_Y020e
    v_mad_u32_u16 v120, v49, 8, s22
    v_mad_u32_u16 v122, v49, 8, s22 op_sel:[1,0,0,0]
    ds_read_b64 v[120:121], v120
    ds_read_b64 v[122:123], v122
    s_waitcnt lgkmcnt(0)
    v_mfma_f32_16x16x32_bf16 v[92:95], v[108:111], v[120:123], v[92:95]
    s_cmp_le_u32 s40, 10
    s_cbranch_scc1 K3_Y020e
    v_mad_u32_u16 v120, v50, 8, s22
    v_mad_u32_u16 v122, v50, 8, s22 op_sel:[1,0,0,0]
    ds_read_b64 v[120:121], v120
    ds_read_b64 v[122:123], v122
    s_waitcnt lgkmcnt(0)
    v_mfma_f32_16x16x32_bf16 v[92:95], v[108:111], v[120:123], v[92:95]
    s_cmp_le_u32 s40, 11
    s_cbranch_scc1 K3_Y020e
    s_mov_b32 s64, s56
    s_sub_u32 s65, s40, 11
    v_lshrrev_b32 v0, 2, v114
K3_O020e:
    buffer_load_dword v1, v0, s[24:27], s64 offen
    s_add_u32 s64, s64, 256
    s_waitcnt vmcnt(0)
    v_mad_u32_u16 v120, v1, 8, s22
    v_mad_u32_u16 v122, v1, 8, s22 op_sel:[1,0,0,0]
    ds_read_b64 v[120:121], v120
    ds_read_b64 v[122:123], v122
    s_waitcnt lgkmcnt(0)
    v_mfma_f32_16x16x32_bf16 v[92:95], v[108:111], v[120:123], v[92:95]
    s_sub_u32 s65, s65, 1
    s_cmp_lg_u32 s65, 0
    s_cbranch_scc1 K3_O020e
K3_Y020e:
    s_branch K3_R020e
K3_X021e:
    v_mad_u32_u16 v120, v56, 8, s22
    v_mad_u32_u16 v122, v56, 8, s22 op_sel:[1,0,0,0]
    ds_read_b64 v[120:121], v120
    ds_read_b64 v[122:123], v122
    s_waitcnt lgkmcnt(0)
    v_mfma_f32_16x16x32_bf16 v[96:99], v[108:111], v[120:123], v[96:99]
    s_cmp_le_u32 s41, 6
    s_cbranch_scc1 K3_Y021e
    v_mad_u32_u16 v120, v57, 8, s22
    v_mad_u32_u16 v122, v57, 8, s22 op_sel:[1,0,0,0]
    ds_read_b64 v[120:121], v120
    ds_read_b64 v[122:123], v122
    s_waitcnt lgkmcnt(0)
    v_mfma_f32_16x16x32_bf16 v[96:99], v[108:111], v[120:123], v[96:99]
    s_cmp_le_u32 s41, 7
    s_cbranch_scc1 K3_Y021e
    s_mov_b32 s64, s57
    s_sub_u32 s65, s41, 7
    v_lshrrev_b32 v0, 2, v114
K3_O021e:
    buffer_load_dword v1, v0, s[24:27], s64 offen
    s_add_u32 s64, s64, 256
    s_waitcnt vmcnt(0)
    v_mad_u32_u16 v120, v1, 8, s22
    v_mad_u32_u16 v122, v1, 8, s22 op_sel:[1,0,0,0]
    ds_read_b64 v[120:121], v120
    ds_read_b64 v[122:123], v122
    s_waitcnt lgkmcnt(0)
    v_mfma_f32_16x16x32_bf16 v[96:99], v[108:111], v[120:123], v[96:99]
    s_sub_u32 s65, s65, 1
    s_cmp_lg_u32 s65, 0
    s_cbranch_scc1 K3_O021e
K3_Y021e:
    s_branch K3_R021e
K3_X022e:
    v_mad_u32_u16 v104, v61, 8, s22
    v_mad_u32_u16 v106, v61, 8, s22 op_sel:[1,0,0,0]
    ds_read_b64 v[104:105], v104
    ds_read_b64 v[106:107], v106
    s_waitcnt lgkmcnt(0)
    v_mfma_f32_16x16x32_bf16 v[92:95], v[108:111], v[104:107], v[92:95]
    s_cmp_le_u32 s42, 4
    s_cbranch_scc1 K3_Y022e
    v_mad_u32_u16 v104, v62, 8, s22
    v_mad_u32_u16 v106, v62, 8, s22 op_sel:[1,0,0,0]
    ds_read_b64 v[104:105], v104
    ds_read_b64 v[106:107], v106
    s_waitcnt lgkmcnt(0)
    v_mfma_f32_16x16x32_bf16 v[92:95], v[108:111], v[104:107], v[92:95]
    s_cmp_le_u32 s42, 5
    s_cbranch_scc1 K3_Y022e
    v_mad_u32_u16 v104, v63, 8, s22
    v_mad_u32_u16 v106, v63, 8, s22 op_sel:[1,0,0,0]
    ds_read_b64 v[104:105], v104
    ds_read_b64 v[106:107], v106
    s_waitcnt lgkmcnt(0)
    v_mfma_f32_16x16x32_bf16 v[92:95], v[108:111], v[104:107], v[92:95]
    s_cmp_le_u32 s42, 6
    s_cbranch_scc1 K3_Y022e
    s_mov_b32 s64, s58
    s_sub_u32 s65, s42, 6
    v_lshrrev_b32 v0, 2, v114
K3_O022e:
    buffer_load_dword v1, v0, s[24:27], s64 offen
    s_add_u32 s64, s64, 256
    s_waitcnt vmcnt(0)
    v_mad_u32_u16 v104, v1, 8, s22
    v_mad_u32_u16 v106, v1, 8, s22 op_sel:[1,0,0,0]
    ds_read_b64 v[104:105], v104
    ds_read_b64 v[106:107], v106
    s_waitcnt lgkmcnt(0)
    v_mfma_f32_16x16x32_bf16 v[92:95], v[108:111], v[104:107], v[92:95]
    s_sub_u32 s65, s65, 1
    s_cmp_lg_u32 s65, 0
    s_cbranch_scc1 K3_O022e
K3_Y022e:
    s_branch K3_R022e
K3_X030e:
    v_mad_u32_u16 v120, v71, 8, s21
    v_mad_u32_u16 v122, v71, 8, s21 op_sel:[1,0,0,0]
    ds_read_b64 v[120:121], v120
    ds_read_b64 v[122:123], v122
    s_waitcnt lgkmcnt(0)
    v_mfma_f32_16x16x32_bf16 v[92:95], v[108:111], v[120:123], v[92:95]
    s_cmp_le_u32 s44, 8
    s_cbranch_scc1 K3_Y030e
    v_mad_u32_u16 v120, v72, 8, s21
    v_mad_u32_u16 v122, v72, 8, s21 op_sel:[1,0,0,0]
    ds_read_b64 v[120:121], v120
    ds_read_b64 v[122:123], v122
    s_waitcnt lgkmcnt(0)
    v_mfma_f32_16x16x32_bf16 v[92:95], v[108:111], v[120:123], v[92:95]
    s_cmp_le_u32 s44, 9
    s_cbranch_scc1 K3_Y030e
    v_mad_u32_u16 v120, v73, 8, s21
    v_mad_u32_u16 v122, v73, 8, s21 op_sel:[1,0,0,0]
    ds_read_b64 v[120:121], v120
    ds_read_b64 v[122:123], v122
    s_waitcnt lgkmcnt(0)
    v_mfma_f32_16x16x32_bf16 v[92:95], v[108:111], v[120:123], v[92:95]
    s_cmp_le_u32 s44, 10
    s_cbranch_scc1 K3_Y030e
    s_mov_b32 s64, s60
    s_sub_u32 s65, s44, 10
    v_lshrrev_b32 v0, 2, v114
K3_O030e:
    buffer_load_dword v1, v0, s[24:27], s64 offen
    s_add_u32 s64, s64, 256
    s_waitcnt vmcnt(0)
    v_mad_u32_u16 v120, v1, 8, s21
    v_mad_u32_u16 v122, v1, 8, s21 op_sel:[1,0,0,0]
    ds_read_b64 v[120:121], v120
    ds_read_b64 v[122:123], v122
    s_waitcnt lgkmcnt(0)
    v_mfma_f32_16x16x32_bf16 v[92:95], v[108:111], v[120:123], v[92:95]
    s_sub_u32 s65, s65, 1
    s_cmp_lg_u32 s65, 0
    s_cbranch_scc1 K3_O030e
K3_Y030e:
    s_branch K3_R030e
K3_X031e:
    v_mad_u32_u16 v120, v79, 8, s21
    v_mad_u32_u16 v122, v79, 8, s21 op_sel:[1,0,0,0]
    ds_read_b64 v[120:121], v120
    ds_read_b64 v[122:123], v122
    s_waitcnt lgkmcnt(0)
    v_mfma_f32_16x16x32_bf16 v[96:99], v[108:111], v[120:123], v[96:99]
    s_cmp_le_u32 s45, 6
    s_cbranch_scc1 K3_Y031e
    s_mov_b32 s64, s61
    s_sub_u32 s65, s45, 6
    v_lshrrev_b32 v0, 2, v114
K3_O031e:
    buffer_load_dword v1, v0, s[24:27], s64 offen
    s_add_u32 s64, s64, 256
    s_waitcnt vmcnt(0)
    v_mad_u32_u16 v120, v1, 8, s21
    v_mad_u32_u16 v122, v1, 8, s21 op_sel:[1,0,0,0]
    ds_read_b64 v[120:121], v120
    ds_read_b64 v[122:123], v122
    s_waitcnt lgkmcnt(0)
    v_mfma_f32_16x16x32_bf16 v[96:99], v[108:111], v[120:123], v[96:99]
    s_sub_u32 s65, s65, 1
    s_cmp_lg_u32 s65, 0
    s_cbranch_scc1 K3_O031e
K3_Y031e:
    s_branch K3_R031e
K3_X032e:
    v_mad_u32_u16 v104, v83, 8, s21
    v_mad_u32_u16 v106, v83, 8, s21 op_sel:[1,0,0,0]
    ds_read_b64 v[104:105], v104
    ds_read_b64 v[106:107], v106
    s_waitcnt lgkmcnt(0)
    v_mfma_f32_16x16x32_bf16 v[92:95], v[108:111], v[104:107], v[92:95]
    s_cmp_le_u32 s46, 4
    s_cbranch_scc1 K3_Y032e
    s_mov_b32 s64, s62
    s_sub_u32 s65, s46, 4
    v_lshrrev_b32 v0, 2, v114
K3_O032e:
    buffer_load_dword v1, v0, s[24:27], s64 offen
    s_add_u32 s64, s64, 256
    s_waitcnt vmcnt(0)
    v_mad_u32_u16 v104, v1, 8, s21
    v_mad_u32_u16 v106, v1, 8, s21 op_sel:[1,0,0,0]
    ds_read_b64 v[104:105], v104
    ds_read_b64 v[106:107], v106
    s_waitcnt lgkmcnt(0)
    v_mfma_f32_16x16x32_bf16 v[92:95], v[108:111], v[104:107], v[92:95]
    s_sub_u32 s65, s65, 1
    s_cmp_lg_u32 s65, 0
    s_cbranch_scc1 K3_O032e
K3_Y032e:
    s_branch K3_R032e
K3_X100:
    v_mad_u32_u16 v124, v7, 8, s23
    v_mad_u32_u16 v126, v7, 8, s23 op_sel:[1,0,0,0]
    ds_read_b64 v[124:125], v124
    ds_read_b64 v[126:127], v126
    s_waitcnt lgkmcnt(0)
    v_mfma_f32_16x16x32_bf16 v[92:95], v[108:111], v[124:127], v[92:95]
    s_cmp_le_u32 s32, 4
    s_cbranch_scc1 K3_Y100
    v_mad_u32_u16 v124, v8, 8, s23
    v_mad_u32_u16 v126, v8, 8, s23 op_sel:[1,0,0,0]
    ds_read_b64 v[124:125], v124
    ds_read_b64 v[126:127], v126
    s_waitcnt lgkmcnt(0)
    v_mfma_f32_16x16x32_bf16 v[92:95], v[108:111], v[124:127], v[92:95]
    s_cmp_le_u32 s32, 5
    s_cbranch_scc1 K3_Y100
    s_mov_b32 s64, s48
    s_sub_u32 s65, s32, 5
    v_lshrrev_b32 v0, 2, v114
K3_O100:
    buffer_load_dword v1, v0, s[24:27], s64 offen
    s_add_u32 s64, s64, 256
    s_waitcnt vmcnt(0)
    v_mad_u32_u16 v124, v1, 8, s23
    v_mad_u32_u16 v126, v1, 8, s23 op_sel:[1,0,0,0]
    ds_read_b64 v[124:125], v124
    ds_read_b64 v[126:127], v126
    s_waitcnt lgkmcnt(0)
    v_mfma_f32_16x16x32_bf16 v[92:95], v[108:111], v[124:127], v[92:95]
    s_sub_u32 s65, s65, 1
    s_cmp_lg_u32 s65, 0
    s_cbranch_scc1 K3_O100
K3_Y100:
    s_branch K3_R100
K3_X101:
    v_mad_u32_u16 v120, v12, 8, s23
    v_mad_u32_u16 v122, v12, 8, s23 op_sel:[1,0,0,0]
    ds_read_b64 v[120:121], v120
    ds_read_b64 v[122:123], v122
    s_waitcnt lgkmcnt(0)
    v_mfma_f32_16x16x32_bf16 v[96:99], v[108:111], v[120:123], v[96:99]
    s_cmp_le_u32 s33, 4
    s_cbranch_scc1 K3_Y101
    v_mad_u32_u16 v120, v13, 8, s23
    v_mad_u32_u16 v122, v13, 8, s23 op_sel:[1,0,0,0]
    ds_read_b64 v[120:121], v120
    ds_read_b64 v[122:123], v122
    s_waitcnt lgkmcnt(0)
    v_mfma_f32_16x16x32_bf16 v[96:99], v[108:111], v[120:123], v[96:99]
    s_cmp_le_u32 s33, 5
    s_cbranch_scc1 K3_Y101
    s_mov_b32 s64, s49
    s_sub_u32 s65, s33, 5
    v_lshrrev_b32 v0, 2, v114
K3_O101:
    buffer_load_dword v1, v0, s[24:27], s64 offen
    s_add_u32 s64, s64, 256
    s_waitcnt vmcnt(0)
    v_mad_u32_u16 v120, v1, 8, s23
    v_mad_u32_u16 v122, v1, 8, s23 op_sel:[1,0,0,0]
    ds_read_b64 v[120:121], v120
    ds_read_b64 v[122:123], v122
    s_waitcnt lgkmcnt(0)
    v_mfma_f32_16x16x32_bf16 v[96:99], v[108:111], v[120:123], v[96:99]
    s_sub_u32 s65, s65, 1
    s_cmp_lg_u32 s65, 0
    s_cbranch_scc1 K3_O101
K3_Y101:
    s_branch K3_R101
K3_X102:
    v_mad_u32_u16 v116, v17, 8, s23
    v_mad_u32_u16 v118, v17, 8, s23 op_sel:[1,0,0,0]
    ds_read_b64 v[116:117], v116
    ds_read_b64 v[118:119], v118
    s_waitcnt lgkmcnt(0)
    v_mfma_f32_16x16x32_bf16 v[100:103], v[108:111], v[116:119], v[100:103]
    s_cmp_le_u32 s34, 4
    s_cbranch_scc1 K3_Y102
    v_mad_u32_u16 v116, v18, 8, s23
    v_mad_u32_u16 v118, v18, 8, s23 op_sel:[1,0,0,0]
    ds_read_b64 v[116:117], v116
    ds_read_b64 v[118:119], v118
    s_waitcnt lgkmcnt(0)
    v_mfma_f32_16x16x32_bf16 v[100:103], v[108:111], v[116:119], v[100:103]
    s_cmp_le_u32 s34, 5
    s_cbranch_scc1 K3_Y102
    s_mov_b32 s64, s50
    s_sub_u32 s65, s34, 5
    v_lshrrev_b32 v0, 2, v114
K3_O102:
    buffer_load_dword v1, v0, s[24:27], s64 offen
    s_add_u32 s64, s64, 256
    s_waitcnt vmcnt(0)
    v_mad_u32_u16 v116, v1, 8, s23
    v_mad_u32_u16 v118, v1, 8, s23 op_sel:[1,0,0,0]
    ds_read_b64 v[116:117], v116
    ds_read_b64 v[118:119], v118
    s_waitcnt lgkmcnt(0)
    v_mfma_f32_16x16x32_bf16 v[100:103], v[108:111], v[116:119], v[100:103]
    s_sub_u32 s65, s65, 1
    s_cmp_lg_u32 s65, 0
    s_cbranch_scc1 K3_O102
K3_Y102:
    s_branch K3_R102
K3_X103:
    v_mad_u32_u16 v88, v22, 8, s23
    v_mad_u32_u16 v90, v22, 8, s23 op_sel:[1,0,0,0]
    ds_read_b64 v[88:89], v88
    ds_read_b64 v[90:91], v90
    s_waitcnt lgkmcnt(0)
    v_mfma_f32_16x16x32_bf16 v[104:107], v[108:111], v[88:91], v[104:107]
    s_cmp_le_u32 s35, 4
    s_cbranch_scc1 K3_Y103
    v_mad_u32_u16 v88, v23, 8, s23
    v_mad_u32_u16 v90, v23, 8, s23 op_sel:[1,0,0,0]
    ds_read_b64 v[88:89], v88
    ds_read_b64 v[90:91], v90
    s_waitcnt lgkmcnt(0)
    v_mfma_f32_16x16x32_bf16 v[104:107], v[108:111], v[88:91], v[104:107]
    s_cmp_le_u32 s35, 5
    s_cbranch_scc1 K3_Y103
    s_mov_b32 s64, s51
    s_sub_u32 s65, s35, 5
    v_lshrrev_b32 v0, 2, v114
K3_O103:
    buffer_load_dword v1, v0, s[24:27], s64 offen
    s_add_u32 s64, s64, 256
    s_waitcnt vmcnt(0)
    v_mad_u32_u16 v88, v1, 8, s23
    v_mad_u32_u16 v90, v1, 8, s23 op_sel:[1,0,0,0]
    ds_read_b64 v[88:89], v88
    ds_read_b64 v[90:91], v90
    s_waitcnt lgkmcnt(0)
    v_mfma_f32_16x16x32_bf16 v[104:107], v[108:111], v[88:91], v[104:107]
    s_sub_u32 s65, s65, 1
    s_cmp_lg_u32 s65, 0
    s_cbranch_scc1 K3_O103
K3_Y103:
    s_branch K3_R103
K3_X110:
    v_mad_u32_u16 v88, v28, 8, s21
    v_mad_u32_u16 v90, v28, 8, s21 op_sel:[1,0,0,0]
    ds_read_b64 v[88:89], v88
    ds_read_b64 v[90:91], v90
    s_waitcnt lgkmcnt(0)
    v_mfma_f32_16x16x32_bf16 v[92:95], v[108:111], v[88:91], v[92:95]
    s_cmp_le_u32 s36, 5
    s_cbranch_scc1 K3_Y110
    v_mad_u32_u16 v88, v29, 8, s21
    v_mad_u32_u16 v90, v29, 8, s21 op_sel:[1,0,0,0]
    ds_read_b64 v[88:89], v88
    ds_read_b64 v[90:91], v90
    s_waitcnt lgkmcnt(0)
    v_mfma_f32_16x16x32_bf16 v[92:95], v[108:111], v[88:91], v[92:95]
    s_cmp_le_u32 s36, 6
    s_cbranch_scc1 K3_Y110
    s_mov_b32 s64, s52
    s_sub_u32 s65, s36, 6
    v_lshrrev_b32 v0, 2, v114
K3_O110:
    buffer_load_dword v1, v0, s[24:27], s64 offen
    s_add_u32 s64, s64, 256
    s_waitcnt vmcnt(0)
    v_mad_u32_u16 v88, v1, 8, s21
    v_mad_u32_u16 v90, v1, 8, s21 op_sel:[1,0,0,0]
    ds_read_b64 v[88:89], v88
    ds_read_b64 v[90:91], v90
    s_waitcnt lgkmcnt(0)
    v_mfma_f32_16x16x32_bf16 v[92:95], v[108:111], v[88:91], v[92:95]
    s_sub_u32 s65, s65, 1
    s_cmp_lg_u32 s65, 0
    s_cbranch_scc1 K3_O110
K3_Y110:
    s_branch K3_R110
K3_X111:
    v_mad_u32_u16 v124, v33, 8, s21
    v_mad_u32_u16 v126, v33, 8, s21 op_sel:[1,0,0,0]
    ds_read_b64 v[124:125], v124
    ds_read_b64 v[126:127], v126
    s_waitcnt lgkmcnt(0)
    v_mfma_f32_16x16x32_bf16 v[96:99], v[108:111], v[124:127], v[96:99]
    s_cmp_le_u32 s37, 4
    s_cbranch_scc1 K3_Y111
    s_mov_b32 s64, s53
    s_sub_u32 s65, s37, 4
    v_lshrrev_b32 v0, 2, v114
K3_O111:
    buffer_load_dword v1, v0, s[24:27], s64 offen
    s_add_u32 s64, s64, 256
    s_waitcnt vmcnt(0)
    v_mad_u32_u16 v124, v1, 8, s21
    v_mad_u32_u16 v126, v1, 8, s21 op_sel:[1,0,0,0]
    ds_read_b64 v[124:125], v124
    ds_read_b64 v[126:127], v126
    s_waitcnt lgkmcnt(0)
    v_mfma_f32_16x16x32_bf16 v[96:99], v[108:111], v[124:127], v[96:99]
    s_sub_u32 s65, s65, 1
    s_cmp_lg_u32 s65, 0
    s_cbranch_scc1 K3_O111
K3_Y111:
    s_branch K3_R111
K3_X112:
    s_mov_b32 s64, s54
    s_sub_u32 s65, s38, 3
    v_lshrrev_b32 v0, 2, v114
K3_O112:
    buffer_load_dword v1, v0, s[24:27], s64 offen
    s_add_u32 s64, s64, 256
    s_waitcnt vmcnt(0)
    v_mad_u32_u16 v120, v1, 8, s21
    v_mad_u32_u16 v122, v1, 8, s21 op_sel:[1,0,0,0]
    ds_read_b64 v[120:121], v120
    ds_read_b64 v[122:123], v122
    s_waitcnt lgkmcnt(0)
    v_mfma_f32_16x16x32_bf16 v[100:103], v[108:111], v[120:123], v[100:103]
    s_sub_u32 s65, s65, 1
    s_cmp_lg_u32 s65, 0
    s_cbranch_scc1 K3_O112
K3_Y112:
    s_branch K3_R112
K3_X113:
    v_mad_u32_u16 v88, v39, 8, s21
    v_mad_u32_u16 v90, v39, 8, s21 op_sel:[1,0,0,0]
    ds_read_b64 v[88:89], v88
    ds_read_b64 v[90:91], v90
    s_waitcnt lgkmcnt(0)
    v_mfma_f32_16x16x32_bf16 v[104:107], v[108:111], v[88:91], v[104:107]
    s_cmp_le_u32 s39, 3
    s_cbranch_scc1 K3_Y113
    s_mov_b32 s64, s55
    s_sub_u32 s65, s39, 3
    v_lshrrev_b32 v0, 2, v114
K3_O113:
    buffer_load_dword v1, v0, s[24:27], s64 offen
    s_add_u32 s64, s64, 256
    s_waitcnt vmcnt(0)
    v_mad_u32_u16 v88, v1, 8, s21
    v_mad_u32_u16 v90, v1, 8, s21 op_sel:[1,0,0,0]
    ds_read_b64 v[88:89], v88
    ds_read_b64 v[90:91], v90
    s_waitcnt lgkmcnt(0)
    v_mfma_f32_16x16x32_bf16 v[104:107], v[108:111], v[88:91], v[104:107]
    s_sub_u32 s65, s65, 1
    s_cmp_lg_u32 s65, 0
    s_cbranch_scc1 K3_O113
K3_Y113:
    s_branch K3_R113
K3_X120:
    v_mad_u32_u16 v104, v45, 8, s22
    v_mad_u32_u16 v106, v45, 8, s22 op_sel:[1,0,0,0]
    ds_read_b64 v[104:105], v104
    ds_read_b64 v[106:107], v106
    s_waitcnt lgkmcnt(0)
    v_mfma_f32_16x16x32_bf16 v[92:95], v[108:111], v[104:107], v[92:95]
    s_cmp_le_u32 s40, 6
    s_cbranch_scc1 K3_Y120
    v_mad_u32_u16 v104, v46, 8, s22
    v_mad_u32_u16 v106, v46, 8, s22 op_sel:[1,0,0,0]
    ds_read_b64 v[104:105], v104
    ds_read_b64 v[106:107], v106
    s_waitcnt lgkmcnt(0)
    v_mfma_f32_16x16x32_bf16 v[92:95], v[108:111], v[104:107], v[92:95]
    s_cmp_le_u32 s40, 7
    s_cbranch_scc1 K3_Y120
    v_mad_u32_u16 v104, v47, 8, s22
    v_mad_u32_u16 v106, v47, 8, s22 op_sel:[1,0,0,0]
    ds_read_b64 v[104:105], v104
    ds_read_b64 v[106:107], v106
    s_waitcnt lgkmcnt(0)
    v_mfma_f32_16x16x32_bf16 v[92:95], v[108:111], v[104:107], v[92:95]
    s_cmp_le_u32 s40, 8
    s_cbranch_scc1 K3_Y120
    s_mov_b32 s64, s56
    s_sub_u32 s65, s40, 8
    v_lshrrev_b32 v0, 2, v114
K3_O120:
    buffer_load_dword v1, v0, s[24:27], s64 offen
    s_add_u32 s64, s64, 256
    s_waitcnt vmcnt(0)
    v_mad_u32_u16 v104, v1, 8, s22
    v_mad_u32_u16 v106, v1, 8, s22 op_sel:[1,0,0,0]
    ds_read_b64 v[104:105], v104
    ds_read_b64 v[106:107], v106
    s_waitcnt lgkmcnt(0)
    v_mfma_f32_16x16x32_bf16 v[92:95], v[108:111], v[104:107], v[92:95]
    s_sub_u32 s65, s65, 1
    s_cmp_lg_u32 s65, 0
    s_cbranch_scc1 K3_O120
K3_Y120:
    s_branch K3_R120
K3_X121:
    v_mad_u32_u16 v100, v52, 8, s22
    v_mad_u32_u16 v102, v52, 8, s22 op_sel:[1,0,0,0]
    ds_read_b64 v[100:101], v100
    ds_read_b64 v[102:103], v102
    s_waitcnt lgkmcnt(0)
    v_mfma_f32_16x16x32_bf16 v[96:99], v[108:111], v[100:103], v[96:99]
    s_cmp_le_u32 s41, 5
    s_cbranch_scc1 K3_Y121
    v_mad_u32_u16 v100, v53, 8, s22
    v_mad_u32_u16 v102, v53, 8, s22 op_sel:[1,0,0,0]
    ds_read_b64 v[100:101], v100
    ds_read_b64 v[102:103], v102
    s_waitcnt lgkmcnt(0)
    v_mfma_f32_16x16x32_bf16 v[96:99], v[108:111], v[100:103], v[96:99]
    s_cmp_le_u32 s41, 6
    s_cbranch_scc1 K3_Y121
    s_mov_b32 s64, s57
    s_sub_u32 s65, s41, 6
    v_lshrrev_b32 v0, 2, v114
K3_O121:
    buffer_load_dword v1, v0, s[24:27], s64 offen
    s_add_u32 s64, s64, 256
    s_waitcnt vmcnt(0)
    v_mad_u32_u16 v100, v1, 8, s22
    v_mad_u32_u16 v102, v1, 8, s22 op_sel:[1,0,0,0]
    ds_read_b64 v[100:101], v100
    ds_read_b64 v[102:103], v102
    s_waitcnt lgkmcnt(0)
    v_mfma_f32_16x16x32_bf16 v[96:99], v[108:111], v[100:103], v[96:99]
    s_sub_u32 s65, s65, 1
    s_cmp_lg_u32 s65, 0
    s_cbranch_scc1 K3_O121
K3_Y121:
    s_branch K3_R121
K3_X122:
    v_mad_u32_u16 v124, v58, 8, s22
    v_mad_u32_u16 v126, v58, 8, s22 op_sel:[1,0,0,0]
    ds_read_b64 v[124:125], v124
    ds_read_b64 v[126:127], v126
    s_waitcnt lgkmcnt(0)
    v_mfma_f32_16x16x32_bf16 v[92:95], v[108:111], v[124:127], v[92:95]
    s_cmp_le_u32 s42, 5
    s_cbranch_scc1 K3_Y122
    s_mov_b32 s64, s58
    s_sub_u32 s65, s42, 5
    v_lshrrev_b32 v0, 2, v114
K3_O122:
    buffer_load_dword v1, v0, s[24:27], s64 offen
    s_add_u32 s64, s64, 256
    s_waitcnt vmcnt(0)
    v_mad_u32_u16 v124, v1, 8, s22
    v_mad_u32_u16 v126, v1, 8, s22 op_sel:[1,0,0,0]
    ds_read_b64 v[124:125], v124
    ds_read_b64 v[126:127], v126
    s_waitcnt lgkmcnt(0)
    v_mfma_f32_16x16x32_bf16 v[92:95], v[108:111], v[124:127], v[92:95]
    s_sub_u32 s65, s65, 1
    s_cmp_lg_u32 s65, 0
    s_cbranch_scc1 K3_O122
K3_Y122:
    s_branch K3_R122
K3_X123:
    v_mad_u32_u16 v116, v62, 8, s22
    v_mad_u32_u16 v118, v62, 8, s22 op_sel:[1,0,0,0]
    ds_read_b64 v[116:117], v116
    ds_read_b64 v[118:119], v118
    s_waitcnt lgkmcnt(0)
    v_mfma_f32_16x16x32_bf16 v[96:99], v[108:111], v[116:119], v[96:99]
    s_cmp_le_u32 s43, 4
    s_cbranch_scc1 K3_Y123
    v_mad_u32_u16 v116, v63, 8, s22
    v_mad_u32_u16 v118, v63, 8, s22 op_sel:[1,0,0,0]
    ds_read_b64 v[116:117], v116
    ds_read_b64 v[118:119], v118
    s_waitcnt lgkmcnt(0)
    v_mfma_f32_16x16x32_bf16 v[96:99], v[108:111], v[116:119], v[96:99]
    s_cmp_le_u32 s43, 5
    s_cbranch_scc1 K3_Y123
    s_mov_b32 s64, s59
    s_sub_u32 s65, s43, 5
    v_lshrrev_b32 v0, 2, v114
K3_O123:
    buffer_load_dword v1, v0, s[24:27], s64 offen
    s_add_u32 s64, s64, 256
    s_waitcnt vmcnt(0)
    v_mad_u32_u16 v116, v1, 8, s22
    v_mad_u32_u16 v118, v1, 8, s22 op_sel:[1,0,0,0]
    ds_read_b64 v[116:117], v116
    ds_read_b64 v[118:119], v118
    s_waitcnt lgkmcnt(0)
    v_mfma_f32_16x16x32_bf16 v[96:99], v[108:111], v[116:119], v[96:99]
    s_sub_u32 s65, s65, 1
    s_cmp_lg_u32 s65, 0
    s_cbranch_scc1 K3_O123
K3_Y123:
    s_branch K3_R123
K3_X130:
    v_mad_u32_u16 v104, v69, 8, s21
    v_mad_u32_u16 v106, v69, 8, s21 op_sel:[1,0,0,0]
    ds_read_b64 v[104:105], v104
    ds_read_b64 v[106:107], v106
    s_waitcnt lgkmcnt(0)
    v_mfma_f32_16x16x32_bf16 v[92:95], v[108:111], v[104:107], v[92:95]
    s_cmp_le_u32 s44, 6
    s_cbranch_scc1 K3_Y130
    v_mad_u32_u16 v104, v70, 8, s21
    v_mad_u32_u16 v106, v70, 8, s21 op_sel:[1,0,0,0]
    ds_read_b64 v[104:105], v104
    ds_read_b64 v[106:107], v106
    s_waitcnt lgkmcnt(0)
    v_mfma_f32_16x16x32_bf16 v[92:95], v[108:111], v[104:107], v[92:95]
    s_cmp_le_u32 s44, 7
    s_cbranch_scc1 K3_Y130
    s_mov_b32 s64, s60
    s_sub_u32 s65, s44, 7
    v_lshrrev_b32 v0, 2, v114
K3_O130:
    buffer_load_dword v1, v0, s[24:27], s64 offen
    s_add_u32 s64, s64, 256
    s_waitcnt vmcnt(0)
    v_mad_u32_u16 v104, v1, 8, s21
    v_mad_u32_u16 v106, v1, 8, s21 op_sel:[1,0,0,0]
    ds_read_b64 v[104:105], v104
    ds_read_b64 v[106:107], v106
    s_waitcnt lgkmcnt(0)
    v_mfma_f32_16x16x32_bf16 v[92:95], v[108:111], v[104:107], v[92:95]
    s_sub_u32 s65, s65, 1
    s_cmp_lg_u32 s65, 0
    s_cbranch_scc1 K3_O130
K3_Y130:
    s_branch K3_R130
K3_X131:
    v_mad_u32_u16 v100, v75, 8, s21
    v_mad_u32_u16 v102, v75, 8, s21 op_sel:[1,0,0,0]
    ds_read_b64 v[100:101], v100
    ds_read_b64 v[102:103], v102
    s_waitcnt lgkmcnt(0)
    v_mfma_f32_16x16x32_bf16 v[96:99], v[108:111], v[100:103], v[96:99]
    s_cmp_le_u32 s45, 5
    s_cbranch_scc1 K3_Y131
    s_mov_b32 s64, s61
    s_sub_u32 s65, s45, 5
    v_lshrrev_b32 v0, 2, v114
K3_O131:
    buffer_load_dword v1, v0, s[24:27], s64 offen
    s_add_u32 s64, s64, 256
    s_waitcnt vmcnt(0)
    v_mad_u32_u16 v100, v1, 8, s21
    v_mad_u32_u16 v102, v1, 8, s21 op_sel:[1,0,0,0]
    ds_read_b64 v[100:101], v100
    ds_read_b64 v[102:103], v102
    s_waitcnt lgkmcnt(0)
    v_mfma_f32_16x16x32_bf16 v[96:99], v[108:111], v[100:103], v[96:99]
    s_sub_u32 s65, s65, 1
    s_cmp_lg_u32 s65, 0
    s_cbranch_scc1 K3_O131
K3_Y131:
    s_branch K3_R131
K3_X132:
    s_mov_b32 s64, s62
    s_sub_u32 s65, s46, 4
    v_lshrrev_b32 v0, 2, v114
K3_O132:
    buffer_load_dword v1, v0, s[24:27], s64 offen
    s_add_u32 s64, s64, 256
    s_waitcnt vmcnt(0)
    v_mad_u32_u16 v124, v1, 8, s21
    v_mad_u32_u16 v126, v1, 8, s21 op_sel:[1,0,0,0]
    ds_read_b64 v[124:125], v124
    ds_read_b64 v[126:127], v126
    s_waitcnt lgkmcnt(0)
    v_mfma_f32_16x16x32_bf16 v[92:95], v[108:111], v[124:127], v[92:95]
    s_sub_u32 s65, s65, 1
    s_cmp_lg_u32 s65, 0
    s_cbranch_scc1 K3_O132
K3_Y132:
    s_branch K3_R132
K3_X133:
    v_mad_u32_u16 v116, v83, 8, s21
    v_mad_u32_u16 v118, v83, 8, s21 op_sel:[1,0,0,0]
    ds_read_b64 v[116:117], v116
    ds_read_b64 v[118:119], v118
    s_waitcnt lgkmcnt(0)
    v_mfma_f32_16x16x32_bf16 v[96:99], v[108:111], v[116:119], v[96:99]
    s_cmp_le_u32 s47, 4
    s_cbranch_scc1 K3_Y133
    s_mov_b32 s64, s63
    s_sub_u32 s65, s47, 4
    v_lshrrev_b32 v0, 2, v114
K3_O133:
    buffer_load_dword v1, v0, s[24:27], s64 offen
    s_add_u32 s64, s64, 256
    s_waitcnt vmcnt(0)
    v_mad_u32_u16 v116, v1, 8, s21
    v_mad_u32_u16 v118, v1, 8, s21 op_sel:[1,0,0,0]
    ds_read_b64 v[116:117], v116
    ds_read_b64 v[118:119], v118
    s_waitcnt lgkmcnt(0)
    v_mfma_f32_16x16x32_bf16 v[96:99], v[108:111], v[116:119], v[96:99]
    s_sub_u32 s65, s65, 1
    s_cmp_lg_u32 s65, 0
    s_cbranch_scc1 K3_O133
K3_Y133:
    s_branch K3_R133
K3_X120e:
    v_mad_u32_u16 v104, v45, 8, s22
    v_mad_u32_u16 v106, v45, 8, s22 op_sel:[1,0,0,0]
    ds_read_b64 v[104:105], v104
    ds_read_b64 v[106:107], v106
    s_waitcnt lgkmcnt(0)
    v_mfma_f32_16x16x32_bf16 v[92:95], v[108:111], v[104:107], v[92:95]
    s_cmp_le_u32 s40, 6
    s_cbranch_scc1 K3_Y120e
    v_mad_u32_u16 v104, v46, 8, s22
    v_mad_u32_u16 v106, v46, 8, s22 op_sel:[1,0,0,0]
    ds_read_b64 v[104:105], v104
    ds_read_b64 v[106:107], v106
    s_waitcnt lgkmcnt(0)
    v_mfma_f32_16x16x32_bf16 v[92:95], v[108:111], v[104:107], v[92:95]
    s_cmp_le_u32 s40, 7
    s_cbranch_scc1 K3_Y120e
    v_mad_u32_u16 v104, v47, 8, s22
    v_mad_u32_u16 v106, v47, 8, s22 op_sel:[1,0,0,0]
    ds_read_b64 v[104:105], v104
    ds_read_b64 v[106:107], v106
    s_waitcnt lgkmcnt(0)
    v_mfma_f32_16x16x32_bf16 v[92:95], v[108:111], v[104:107], v[92:95]
    s_cmp_le_u32 s40, 8
    s_cbranch_scc1 K3_Y120e
    s_mov_b32 s64, s56
    s_sub_u32 s65, s40, 8
    v_lshrrev_b32 v0, 2, v114
K3_O120e:
    buffer_load_dword v1, v0, s[24:27], s64 offen
    s_add_u32 s64, s64, 256
    s_waitcnt vmcnt(0)
    v_mad_u32_u16 v104, v1, 8, s22
    v_mad_u32_u16 v106, v1, 8, s22 op_sel:[1,0,0,0]
    ds_read_b64 v[104:105], v104
    ds_read_b64 v[106:107], v106
    s_waitcnt lgkmcnt(0)
    v_mfma_f32_16x16x32_bf16 v[92:95], v[108:111], v[104:107], v[92:95]
    s_sub_u32 s65, s65, 1
    s_cmp_lg_u32 s65, 0
    s_cbranch_scc1 K3_O120e
K3_Y120e:
    s_branch K3_R120e
K3_X121e:
    v_mad_u32_u16 v100, v52, 8, s22
    v_mad_u32_u16 v102, v52, 8, s22 op_sel:[1,0,0,0]
    ds_read_b64 v[100:101], v100
    ds_read_b64 v[102:103], v102
    s_waitcnt lgkmcnt(0)
    v_mfma_f32_16x16x32_bf16 v[96:99], v[108:111], v[100:103], v[96:99]
    s_cmp_le_u32 s41, 5
    s_cbranch_scc1 K3_Y121e
    v_mad_u32_u16 v100, v53, 8, s22
    v_mad_u32_u16 v102, v53, 8, s22 op_sel:[1,0,0,0]
    ds_read_b64 v[100:101], v100
    ds_read_b64 v[102:103], v102
    s_waitcnt lgkmcnt(0)
    v_mfma_f32_16x16x32_bf16 v[96:99], v[108:111], v[100:103], v[96:99]
    s_cmp_le_u32 s41, 6
    s_cbranch_scc1 K3_Y121e
    s_mov_b32 s64, s57
    s_sub_u32 s65, s41, 6
    v_lshrrev_b32 v0, 2, v114
K3_O121e:
    buffer_load_dword v1, v0, s[24:27], s64 offen
    s_add_u32 s64, s64, 256
    s_waitcnt vmcnt(0)
    v_mad_u32_u16 v100, v1, 8, s22
    v_mad_u32_u16 v102, v1, 8, s22 op_sel:[1,0,0,0]
    ds_read_b64 v[100:101], v100
    ds_read_b64 v[102:103], v102
    s_waitcnt lgkmcnt(0)
    v_mfma_f32_16x16x32_bf16 v[96:99], v[108:111], v[100:103], v[96:99]
    s_sub_u32 s65, s65, 1
    s_cmp_lg_u32 s65, 0
    s_cbranch_scc1 K3_O121e
K3_Y121e:
    s_branch K3_R121e
K3_X122e:
    v_mad_u32_u16 v124, v58, 8, s22
    v_mad_u32_u16 v126, v58, 8, s22 op_sel:[1,0,0,0]
    ds_read_b64 v[124:125], v124
    ds_read_b64 v[126:127], v126
    s_waitcnt lgkmcnt(0)
    v_mfma_f32_16x16x32_bf16 v[92:95], v[108:111], v[124:127], v[92:95]
    s_cmp_le_u32 s42, 5
    s_cbranch_scc1 K3_Y122e
    s_mov_b32 s64, s58
    s_sub_u32 s65, s42, 5
    v_lshrrev_b32 v0, 2, v114
K3_O122e:
    buffer_load_dword v1, v0, s[24:27], s64 offen
    s_add_u32 s64, s64, 256
    s_waitcnt vmcnt(0)
    v_mad_u32_u16 v124, v1, 8, s22
    v_mad_u32_u16 v126, v1, 8, s22 op_sel:[1,0,0,0]
    ds_read_b64 v[124:125], v124
    ds_read_b64 v[126:127], v126
    s_waitcnt lgkmcnt(0)
    v_mfma_f32_16x16x32_bf16 v[92:95], v[108:111], v[124:127], v[92:95]
    s_sub_u32 s65, s65, 1
    s_cmp_lg_u32 s65, 0
    s_cbranch_scc1 K3_O122e
K3_Y122e:
    s_branch K3_R122e
K3_X123e:
    v_mad_u32_u16 v116, v62, 8, s22
    v_mad_u32_u16 v118, v62, 8, s22 op_sel:[1,0,0,0]
    ds_read_b64 v[116:117], v116
    ds_read_b64 v[118:119], v118
    s_waitcnt lgkmcnt(0)
    v_mfma_f32_16x16x32_bf16 v[96:99], v[108:111], v[116:119], v[96:99]
    s_cmp_le_u32 s43, 4
    s_cbranch_scc1 K3_Y123e
    v_mad_u32_u16 v116, v63, 8, s22
    v_mad_u32_u16 v118, v63, 8, s22 op_sel:[1,0,0,0]
    ds_read_b64 v[116:117], v116
    ds_read_b64 v[118:119], v118
    s_waitcnt lgkmcnt(0)
    v_mfma_f32_16x16x32_bf16 v[96:99], v[108:111], v[116:119], v[96:99]
    s_cmp_le_u32 s43, 5
    s_cbranch_scc1 K3_Y123e
    s_mov_b32 s64, s59
    s_sub_u32 s65, s43, 5
    v_lshrrev_b32 v0, 2, v114
K3_O123e:
    buffer_load_dword v1, v0, s[24:27], s64 offen
    s_add_u32 s64, s64, 256
    s_waitcnt vmcnt(0)
    v_mad_u32_u16 v116, v1, 8, s22
    v_mad_u32_u16 v118, v1, 8, s22 op_sel:[1,0,0,0]
    ds_read_b64 v[116:117], v116
    ds_read_b64 v[118:119], v118
    s_waitcnt lgkmcnt(0)
    v_mfma_f32_16x16x32_bf16 v[96:99], v[108:111], v[116:119], v[96:99]
    s_sub_u32 s65, s65, 1
    s_cmp_lg_u32 s65, 0
    s_cbranch_scc1 K3_O123e
K3_Y123e:
    s_branch K3_R123e
K3_X130e:
    v_mad_u32_u16 v104, v69, 8, s21
    v_mad_u32_u16 v106, v69, 8, s21 op_sel:[1,0,0,0]
    ds_read_b64 v[104:105], v104
    ds_read_b64 v[106:107], v106
    s_waitcnt lgkmcnt(0)
    v_mfma_f32_16x16x32_bf16 v[92:95], v[108:111], v[104:107], v[92:95]
    s_cmp_le_u32 s44, 6
    s_cbranch_scc1 K3_Y130e
    v_mad_u32_u16 v104, v70, 8, s21
    v_mad_u32_u16 v106, v70, 8, s21 op_sel:[1,0,0,0]
    ds_read_b64 v[104:105], v104
    ds_read_b64 v[106:107], v106
    s_waitcnt lgkmcnt(0)
    v_mfma_f32_16x16x32_bf16 v[92:95], v[108:111], v[104:107], v[92:95]
    s_cmp_le_u32 s44, 7
    s_cbranch_scc1 K3_Y130e
    s_mov_b32 s64, s60
    s_sub_u32 s65, s44, 7
    v_lshrrev_b32 v0, 2, v114
K3_O130e:
    buffer_load_dword v1, v0, s[24:27], s64 offen
    s_add_u32 s64, s64, 256
    s_waitcnt vmcnt(0)
    v_mad_u32_u16 v104, v1, 8, s21
    v_mad_u32_u16 v106, v1, 8, s21 op_sel:[1,0,0,0]
    ds_read_b64 v[104:105], v104
    ds_read_b64 v[106:107], v106
    s_waitcnt lgkmcnt(0)
    v_mfma_f32_16x16x32_bf16 v[92:95], v[108:111], v[104:107], v[92:95]
    s_sub_u32 s65, s65, 1
    s_cmp_lg_u32 s65, 0
    s_cbranch_scc1 K3_O130e
K3_Y130e:
    s_branch K3_R130e
K3_X131e:
    v_mad_u32_u16 v100, v75, 8, s21
    v_mad_u32_u16 v102, v75, 8, s21 op_sel:[1,0,0,0]
    ds_read_b64 v[100:101], v100
    ds_read_b64 v[102:103], v102
    s_waitcnt lgkmcnt(0)
    v_mfma_f32_16x16x32_bf16 v[96:99], v[108:111], v[100:103], v[96:99]
    s_cmp_le_u32 s45, 5
    s_cbranch_scc1 K3_Y131e
    s_mov_b32 s64, s61
    s_sub_u32 s65, s45, 5
    v_lshrrev_b32 v0, 2, v114
K3_O131e:
    buffer_load_dword v1, v0, s[24:27], s64 offen
    s_add_u32 s64, s64, 256
    s_waitcnt vmcnt(0)
    v_mad_u32_u16 v100, v1, 8, s21
    v_mad_u32_u16 v102, v1, 8, s21 op_sel:[1,0,0,0]
    ds_read_b64 v[100:101], v100
    ds_read_b64 v[102:103], v102
    s_waitcnt lgkmcnt(0)
    v_mfma_f32_16x16x32_bf16 v[96:99], v[108:111], v[100:103], v[96:99]
    s_sub_u32 s65, s65, 1
    s_cmp_lg_u32 s65, 0
    s_cbranch_scc1 K3_O131e
K3_Y131e:
    s_branch K3_R131e
K3_X132e:
    s_mov_b32 s64, s62
    s_sub_u32 s65, s46, 4
    v_lshrrev_b32 v0, 2, v114
K3_O132e:
    buffer_load_dword v1, v0, s[24:27], s64 offen
    s_add_u32 s64, s64, 256
    s_waitcnt vmcnt(0)
    v_mad_u32_u16 v124, v1, 8, s21
    v_mad_u32_u16 v126, v1, 8, s21 op_sel:[1,0,0,0]
    ds_read_b64 v[124:125], v124
    ds_read_b64 v[126:127], v126
    s_waitcnt lgkmcnt(0)
    v_mfma_f32_16x16x32_bf16 v[92:95], v[108:111], v[124:127], v[92:95]
    s_sub_u32 s65, s65, 1
    s_cmp_lg_u32 s65, 0
    s_cbranch_scc1 K3_O132e
K3_Y132e:
    s_branch K3_R132e
K3_X133e:
    v_mad_u32_u16 v116, v83, 8, s21
    v_mad_u32_u16 v118, v83, 8, s21 op_sel:[1,0,0,0]
    ds_read_b64 v[116:117], v116
    ds_read_b64 v[118:119], v118
    s_waitcnt lgkmcnt(0)
    v_mfma_f32_16x16x32_bf16 v[96:99], v[108:111], v[116:119], v[96:99]
    s_cmp_le_u32 s47, 4
    s_cbranch_scc1 K3_Y133e
    s_mov_b32 s64, s63
    s_sub_u32 s65, s47, 4
    v_lshrrev_b32 v0, 2, v114
K3_O133e:
    buffer_load_dword v1, v0, s[24:27], s64 offen
    s_add_u32 s64, s64, 256
    s_waitcnt vmcnt(0)
    v_mad_u32_u16 v116, v1, 8, s21
    v_mad_u32_u16 v118, v1, 8, s21 op_sel:[1,0,0,0]
    ds_read_b64 v[116:117], v116
    ds_read_b64 v[118:119], v118
    s_waitcnt lgkmcnt(0)
    v_mfma_f32_16x16x32_bf16 v[96:99], v[108:111], v[116:119], v[96:99]
    s_sub_u32 s65, s65, 1
    s_cmp_lg_u32 s65, 0
    s_cbranch_scc1 K3_O133e
K3_Y133e:
    s_branch K3_R133e
K3_HELPER:
    s_setprio 3
    s_and_b32 s10, s2, 7
    s_lshr_b32 s64, s2, 6
    s_lshl_b32 s64, s64, 3
    s_add_u32 s10, s10, s64
    s_lshl_b32 s10, s10, 11
    s_add_u32 s28, s8, s10
    s_addc_u32 s29, s9, 0
    s_add_u32 s28, s28, 0x34e0000
    s_addc_u32 s29, s29, 0
    s_mov_b32 s30, 2048
    s_mov_b32 s31, 0x20000
    s_lshl_b32 s7, s5, 7
    v_mov_b32 v9, 0
    v_lshlrev_b32 v10, 2, v2
    v_add_u32 v11, 64512, v10
    ds_write_b32 v11, v9
    v_add_u32 v11, 129280, v10
    ds_write_b32 v11, v9
    v_add_u32 v11, 154624, v10
    ds_write_b32 v11, v9
    v_and_b32 v11, 0x7c, v10
    v_add_u32 v11, 154880, v11
    ds_write_b32 v11, v9
    s_sub_u32 s4, s3, 14
    s_lshl_b32 s4, s4, 2
    s_cmp_eq_u32 s3, 14
    s_cselect_b32 s6, 15, 7
    s_add_u32 s10, s4, 0
    s_cmp_ge_u32 s10, s5
    s_addc_u32 s10, s10, 0
    s_and_b32 s10, s10, 7
    s_lshl_b32 s56, s10, 7
    s_add_u32 s10, s4, 1
    s_cmp_ge_u32 s10, s5
    s_addc_u32 s10, s10, 0
    s_and_b32 s10, s10, 7
    s_lshl_b32 s57, s10, 7
    s_add_u32 s10, s4, 2
    s_cmp_ge_u32 s10, s5
    s_addc_u32 s10, s10, 0
    s_and_b32 s10, s10, 7
    s_lshl_b32 s58, s10, 7
    s_add_u32 s10, s4, 3
    s_cmp_ge_u32 s10, s5
    s_addc_u32 s10, s10, 0
    s_and_b32 s10, s10, 7
    s_lshl_b32 s59, s10, 7
    s_waitcnt vmcnt(0) lgkmcnt(0)
    s_barrier
    s_branch K3_HF0
K3_HL:
    v_mov_b32 v0, 154880
    s_add_u32 s66, s20, 0
    s_mul_i32 s66, s66, 14
SP_19:
    ds_read_b32 v1, v0 offset:44
    s_waitcnt lgkmcnt(0)
    v_readfirstlane_b32 s67, v1
    s_cmp_ge_u32 s67, s66
    s_cbranch_scc1 SP_19_E
    s_sleep 1
    s_branch SP_19
SP_19_E:
    s_mov_b32 s62, s20
    s_mov_b32 s7, s6
    s_mov_b32 s63, 4000000
    s_branch PL_20_W
PL_20:
    s_load_dwordx4 s[32:35], s[60:61], s56 glc
    s_load_dwordx4 s[36:39], s[60:61], s57 glc
    s_load_dwordx4 s[40:43], s[60:61], s58 glc
    s_load_dwordx4 s[44:47], s[60:61], s59 glc
PL_20_W:
    s_sub_u32 s63, s63, 1
    s_cmp_eq_u32 s63, 0
    s_cselect_b32 s62, 0, s62
    s_waitcnt lgkmcnt(0)
    s_min_u32 s32, s32, s33
    s_min_u32 s32, s32, s34
    s_bitcmp0_b32 s7, 0
    s_cbranch_scc1 PL_20_0
    s_cmp_lt_u32 s32, s62
    s_cbranch_scc1 PL_20_0
    s_bitset0_b32 s7, 0
    s_add_u32 s10, s4, 0
    s_cmp_ge_u32 s10, s5
    s_addc_u32 s64, s10, 0
    s_mul_i32 s64, s64, 25088
    s_add_u32 s64, s64, 7168
    s_mul_i32 s65, s10, 9216
    s_add_u32 s65, s65, s22
    s_mov_b32 m0, s65
    s_nop 0
    buffer_load_dwordx4 v114, s[12:15], s64 offen sc1 lds
    buffer_load_dwordx4 v114, s[12:15], s64 offen offset:1024 sc1 lds
    buffer_load_dwordx4 v114, s[12:15], s64 offen offset:2048 sc1 lds
    buffer_load_dwordx4 v114, s[12:15], s64 offen offset:3072 sc1 lds
    s_add_u32 s64, s64, 4096
    s_add_u32 s65, s65, 4096
    s_mov_b32 m0, s65
    s_nop 0
    buffer_load_dwordx4 v114, s[12:15], s64 offen sc1 lds
    buffer_load_dwordx4 v114, s[12:15], s64 offen offset:1024 sc1 lds
    buffer_load_dwordx4 v114, s[12:15], s64 offen offset:2048 sc1 lds
    buffer_load_dwordx4 v114, s[12:15], s64 offen offset:3072 sc1 lds
    s_add_u32 s64, s64, 4096
    s_add_u32 s65, s65, 4096
    s_mov_b32 m0, s65
    s_nop 0
    buffer_load_dwordx4 v114, s[12:15], s64 offen sc1 lds
PL_20_0:
    s_min_u32 s36, s36, s37
    s_min_u32 s36, s36, s38
    s_bitcmp0_b32 s7, 1
    s_cbranch_scc1 PL_20_1
    s_cmp_lt_u32 s36, s62
    s_cbranch_scc1 PL_20_1
    s_bitset0_b32 s7, 1
    s_add_u32 s10, s4, 1
    s_cmp_ge_u32 s10, s5
    s_addc_u32 s64, s10, 0
    s_mul_i32 s64, s64, 25088
    s_add_u32 s64, s64, 7168
    s_mul_i32 s65, s10, 9216
    s_add_u32 s65, s65, s22
    s_mov_b32 m0, s65
    s_nop 0
    buffer_load_dwordx4 v114, s[12:15], s64 offen sc1 lds
    buffer_load_dwordx4 v114, s[12:15], s64 offen offset:1024 sc1 lds
    buffer_load_dwordx4 v114, s[12:15], s64 offen offset:2048 sc1 lds
    buffer_load_dwordx4 v114, s[12:15], s64 offen offset:3072 sc1 lds
    s_add_u32 s64, s64, 4096
    s_add_u32 s65, s65, 4096
    s_mov_b32 m0, s65
    s_nop 0
    buffer_load_dwordx4 v114, s[12:15], s64 offen sc1 lds
    buffer_load_dwordx4 v114, s[12:15], s64 offen offset:1024 sc1 lds
    buffer_load_dwordx4 v114, s[12:15], s64 offen offset:2048 sc1 lds
    buffer_load_dwordx4 v114, s[12:15], s64 offen offset:3072 sc1 lds
    s_add_u32 s64, s64, 4096
    s_add_u32 s65, s65, 4096
    s_mov_b32 m0, s65
    s_nop 0
    buffer_load_dwordx4 v114, s[12:15], s64 offen sc1 lds
PL_20_1:
    s_min_u32 s40, s40, s41
    s_min_u32 s40, s40, s42
    s_bitcmp0_b32 s7, 2
    s_cbranch_scc1 PL_20_2
    s_cmp_lt_u32 s40, s62
    s_cbranch_scc1 PL_20_2
    s_bitset0_b32 s7, 2
    s_add_u32 s10, s4, 2
    s_cmp_ge_u32 s10, s5
    s_addc_u32 s64, s10, 0
    s_mul_i32 s64, s64, 25088
    s_add_u32 s64, s64, 7168
    s_mul_i32 s65, s10, 9216
    s_add_u32 s65, s65, s22
    s_mov_b32 m0, s65
    s_nop 0
    buffer_load_dwordx4 v114, s[12:15], s64 offen sc1 lds
    buffer_load_dwordx4 v114, s[12:15], s64 offen offset:1024 sc1 lds
    buffer_load_dwordx4 v114, s[12:15], s64 offen offset:2048 sc1 lds
    buffer_load_dwordx4 v114, s[12:15], s64 offen offset:3072 sc1 lds
    s_add_u32 s64, s64, 4096
    s_add_u32 s65, s65, 4096
    s_mov_b32 m0, s65
    s_nop 0
    buffer_load_dwordx4 v114, s[12:15], s64 offen sc1 lds
    buffer_load_dwordx4 v114, s[12:15], s64 offen offset:1024 sc1 lds
    buffer_load_dwordx4 v114, s[12:15], s64 offen offset:2048 sc1 lds
    buffer_load_dwordx4 v114, s[12:15], s64 offen offset:3072 sc1 lds
    s_add_u32 s64, s64, 4096
    s_add_u32 s65, s65, 4096
    s_mov_b32 m0, s65
    s_nop 0
    buffer_load_dwordx4 v114, s[12:15], s64 offen sc1 lds
PL_20_2:
    s_min_u32 s44, s44, s45
    s_min_u32 s44, s44, s46
    s_bitcmp0_b32 s7, 3
    s_cbranch_scc1 PL_20_3
    s_cmp_lt_u32 s44, s62
    s_cbranch_scc1 PL_20_3
    s_bitset0_b32 s7, 3
    s_add_u32 s10, s4, 3
    s_cmp_ge_u32 s10, s5
    s_addc_u32 s64, s10, 0
    s_mul_i32 s64, s64, 25088
    s_add_u32 s64, s64, 7168
    s_mul_i32 s65, s10, 9216
    s_add_u32 s65, s65, s22
    s_mov_b32 m0, s65
    s_nop 0
    buffer_load_dwordx4 v114, s[12:15], s64 offen sc1 lds
    buffer_load_dwordx4 v114, s[12:15], s64 offen offset:1024 sc1 lds
    buffer_load_dwordx4 v114, s[12:15], s64 offen offset:2048 sc1 lds
    buffer_load_dwordx4 v114, s[12:15], s64 offen offset:3072 sc1 lds
    s_add_u32 s64, s64, 4096
    s_add_u32 s65, s65, 4096
    s_mov_b32 m0, s65
    s_nop 0
    buffer_load_dwordx4 v114, s[12:15], s64 offen sc1 lds
    buffer_load_dwordx4 v114, s[12:15], s64 offen offset:1024 sc1 lds
    buffer_load_dwordx4 v114, s[12:15], s64 offen offset:2048 sc1 lds
    buffer_load_dwordx4 v114, s[12:15], s64 offen offset:3072 sc1 lds
    s_add_u32 s64, s64, 4096
    s_add_u32 s65, s65, 4096
    s_mov_b32 m0, s65
    s_nop 0
    buffer_load_dwordx4 v114, s[12:15], s64 offen sc1 lds
PL_20_3:
    s_cmp_lg_u32 s7, 0
    s_cbranch_scc1 PL_20
    s_add_u32 s60, s28, 32
    s_addc_u32 s61, s29, 0
    s_load_dwordx2 s[32:33], s[60:61], s56 glc
    s_load_dwordx2 s[36:37], s[60:61], s57 glc
    s_load_dwordx2 s[40:41], s[60:61], s58 glc
    s_load_dwordx2 s[44:45], s[60:61], s59 glc
    s_waitcnt vmcnt(0)
    v_mov_b32 v0, 154880
    v_mov_b32 v1, 1
    s_mov_b64 exec, 1
    ds_add_u32 v0, v1 offset:28
    s_mov_b64 exec, -1
    s_mov_b32 s62, s20
    s_mov_b32 s7, s6
    s_mov_b32 s63, 4000000
    s_branch PL_21_W
PL_21:
    s_load_dwordx2 s[32:33], s[60:61], s56 glc
    s_load_dwordx2 s[36:37], s[60:61], s57 glc
    s_load_dwordx2 s[40:41], s[60:61], s58 glc
    s_load_dwordx2 s[44:45], s[60:61], s59 glc
PL_21_W:
    s_sub_u32 s63, s63, 1
    s_cmp_eq_u32 s63, 0
    s_cselect_b32 s62, 0, s62
    s_waitcnt lgkmcnt(0)
    s_min_u32 s32, s32, s33
    s_bitcmp0_b32 s7, 0
    s_cbranch_scc1 PL_21_0
    s_cmp_lt_u32 s32, s62
    s_cbranch_scc1 PL_21_0
    s_bitset0_b32 s7, 0
PL_21_0:
    s_min_u32 s36, s36, s37
    s_bitcmp0_b32 s7, 1
    s_cbranch_scc1 PL_21_1
    s_cmp_lt_u32 s36, s62
    s_cbranch_scc1 PL_21_1
    s_bitset0_b32 s7, 1
PL_21_1:
    s_min_u32 s40, s40, s41
    s_bitcmp0_b32 s7, 2
    s_cbranch_scc1 PL_21_2
    s_cmp_lt_u32 s40, s62
    s_cbranch_scc1 PL_21_2
    s_bitset0_b32 s7, 2
PL_21_2:
    s_min_u32 s44, s44, s45
    s_bitcmp0_b32 s7, 3
    s_cbranch_scc1 PL_21_3
    s_cmp_lt_u32 s44, s62
    s_cbranch_scc1 PL_21_3
    s_bitset0_b32 s7, 3
PL_21_3:
    s_cmp_lg_u32 s7, 0
    s_cbranch_scc1 PL_21
    v_mov_b32 v0, 154880
    s_add_u32 s66, s20, 1
    s_mul_i32 s66, s66, 14
SP_22:
    ds_read_b32 v1, v0 offset:36
    s_waitcnt lgkmcnt(0)
    v_readfirstlane_b32 s67, v1
    s_cmp_ge_u32 s67, s66
    s_cbranch_scc1 SP_22_E
    s_sleep 1
    s_branch SP_22
SP_22_E:
    s_add_u32 s10, s4, 0
    s_cmp_ge_u32 s10, s5
    s_addc_u32 s64, s10, 0
    s_mul_i32 s64, s64, 25088
    s_add_u32 s64, s64, 16384
    s_mul_i32 s65, s10, 9216
    s_add_u32 s65, s65, s21
    s_mov_b32 m0, s65
    s_nop 0
    buffer_load_dwordx4 v114, s[12:15], s64 offen sc1 lds
    buffer_load_dwordx4 v114, s[12:15], s64 offen offset:1024 sc1 lds
    buffer_load_dwordx4 v114, s[12:15], s64 offen offset:2048 sc1 lds
    buffer_load_dwordx4 v114, s[12:15], s64 offen offset:3072 sc1 lds
    s_add_u32 s64, s64, 4096
    s_add_u32 s65, s65, 4096
    s_mov_b32 m0, s65
    s_nop 0
    buffer_load_dwordx4 v114, s[12:15], s64 offen sc1 lds
    buffer_load_dwordx4 v114, s[12:15], s64 offen offset:1024 sc1 lds
    buffer_load_dwordx4 v114, s[12:15], s64 offen offset:2048 sc1 lds
    buffer_load_dwordx4 v114, s[12:15], s64 offen offset:3072 sc1 lds
    s_add_u32 s64, s64, 4096
    s_add_u32 s65, s65, 4096
    s_mov_b32 m0, s65
    s_nop 0
    buffer_load_dwordx4 v114, s[12:15], s64 offen sc1 lds
    s_add_u32 s10, s4, 1
    s_cmp_ge_u32 s10, s5
    s_addc_u32 s64, s10, 0
    s_mul_i32 s64, s64, 25088
    s_add_u32 s64, s64, 16384
    s_mul_i32 s65, s10, 9216
    s_add_u32 s65, s65, s21
    s_mov_b32 m0, s65
    s_nop 0
    buffer_load_dwordx4 v114, s[12:15], s64 offen sc1 lds
    buffer_load_dwordx4 v114, s[12:15], s64 offen offset:1024 sc1 lds
    buffer_load_dwordx4 v114, s[12:15], s64 offen offset:2048 sc1 lds
    buffer_load_dwordx4 v114, s[12:15], s64 offen offset:3072 sc1 lds
    s_add_u32 s64, s64, 4096
    s_add_u32 s65, s65, 4096
    s_mov_b32 m0, s65
    s_nop 0
    buffer_load_dwordx4 v114, s[12:15], s64 offen sc1 lds
    buffer_load_dwordx4 v114, s[12:15], s64 offen offset:1024 sc1 lds
    buffer_load_dwordx4 v114, s[12:15], s64 offen offset:2048 sc1 lds
    buffer_load_dwordx4 v114, s[12:15], s64 offen offset:3072 sc1 lds
    s_add_u32 s64, s64, 4096
    s_add_u32 s65, s65, 4096
    s_mov_b32 m0, s65
    s_nop 0
    buffer_load_dwordx4 v114, s[12:15], s64 offen sc1 lds
    s_add_u32 s10, s4, 2
    s_cmp_ge_u32 s10, s5
    s_addc_u32 s64, s10, 0
    s_mul_i32 s64, s64, 25088
    s_add_u32 s64, s64, 16384
    s_mul_i32 s65, s10, 9216
    s_add_u32 s65, s65, s21
    s_mov_b32 m0, s65
    s_nop 0
    buffer_load_dwordx4 v114, s[12:15], s64 offen sc1 lds
    buffer_load_dwordx4 v114, s[12:15], s64 offen offset:1024 sc1 lds
    buffer_load_dwordx4 v114, s[12:15], s64 offen offset:2048 sc1 lds
    buffer_load_dwordx4 v114, s[12:15], s64 offen offset:3072 sc1 lds
    s_add_u32 s64, s64, 4096
    s_add_u32 s65, s65, 4096
    s_mov_b32 m0, s65
    s_nop 0
    buffer_load_dwordx4 v114, s[12:15], s64 offen sc1 lds
    buffer_load_dwordx4 v114, s[12:15], s64 offen offset:1024 sc1 lds
    buffer_load_dwordx4 v114, s[12:15], s64 offen offset:2048 sc1 lds
    buffer_load_dwordx4 v114, s[12:15], s64 offen offset:3072 sc1 lds
    s_add_u32 s64, s64, 4096
    s_add_u32 s65, s65, 4096
    s_mov_b32 m0, s65
    s_nop 0
    buffer_load_dwordx4 v114, s[12:15], s64 offen sc1 lds
    s_cmp_eq_u32 s3, 15
    s_cbranch_scc1 K3_H3
    s_add_u32 s10, s4, 3
    s_cmp_ge_u32 s10, s5
    s_addc_u32 s64, s10, 0
    s_mul_i32 s64, s64, 25088
    s_add_u32 s64, s64, 16384
    s_mul_i32 s65, s10, 9216
    s_add_u32 s65, s65, s21
    s_mov_b32 m0, s65
    s_nop 0
    buffer_load_dwordx4 v114, s[12:15], s64 offen sc1 lds
    buffer_load_dwordx4 v114, s[12:15], s64 offen offset:1024 sc1 lds
    buffer_load_dwordx4 v114, s[12:15], s64 offen offset:2048 sc1 lds
    buffer_load_dwordx4 v114, s[12:15], s64 offen offset:3072 sc1 lds
    s_add_u32 s64, s64, 4096
    s_add_u32 s65, s65, 4096
    s_mov_b32 m0, s65
    s_nop 0
    buffer_load_dwordx4 v114, s[12:15], s64 offen sc1 lds
    buffer_load_dwordx4 v114, s[12:15], s64 offen offset:1024 sc1 lds
    buffer_load_dwordx4 v114, s[12:15], s64 offen offset:2048 sc1 lds
    buffer_load_dwordx4 v114, s[12:15], s64 offen offset:3072 sc1 lds
    s_add_u32 s64, s64, 4096
    s_add_u32 s65, s65, 4096
    s_mov_b32 m0, s65
    s_nop 0
    buffer_load_dwordx4 v114, s[12:15], s64 offen sc1 lds
K3_H3:
    s_waitcnt vmcnt(0)
    v_mov_b32 v0, 154880
    v_mov_b32 v1, 1
    s_mov_b64 exec, 1
    ds_add_u32 v0, v1 offset:32
    s_mov_b64 exec, -1
    s_cmp_eq_u32 s20, 6
    s_cbranch_scc1 K3_WARM
    v_mov_b32 v0, 154880
    s_add_u32 s66, s20, 1
    s_mul_i32 s66, s66, 14
SP_23:
    ds_read_b32 v1, v0 offset:40
    s_waitcnt lgkmcnt(0)
    v_readfirstlane_b32 s67, v1
    s_cmp_ge_u32 s67, s66
    s_cbranch_scc1 SP_23_E
    s_sleep 1
    s_branch SP_23
SP_23_E:
    v_mov_b32 v0, 154880
    s_add_u32 s66, s20, 1
    s_mul_i32 s66, s66, 2
SP_24:
    ds_read_b32 v1, v0 offset:0
    s_waitcnt lgkmcnt(0)
    v_readfirstlane_b32 s67, v1
    s_cmp_ge_u32 s67, s66
    s_cbranch_scc1 SP_24_E
    s_sleep 1
    s_branch SP_24
SP_24_E:
    s_add_u32 s20, s20, 1
    s_mov_b32 s10, s21
    s_mov_b32 s21, s22
    s_mov_b32 s22, s10
    s_add_u32 s12, s12, 6422528
    s_addc_u32 s13, s13, 0
K3_HF0:
    s_add_u32 s60, s28, 0
    s_addc_u32 s61, s29, 0
    s_load_dwordx2 s[32:33], s[60:61], s56 glc
    s_load_dwordx2 s[36:37], s[60:61], s57 glc
    s_load_dwordx2 s[40:41], s[60:61], s58 glc
    s_load_dwordx2 s[44:45], s[60:61], s59 glc
    s_mov_b32 s62, s20
    s_mov_b32 s7, s6
    s_mov_b32 s63, 4000000
    s_branch PL_25_W
PL_25:
    s_load_dwordx2 s[32:33], s[60:61], s56 glc
    s_load_dwordx2 s[36:37], s[60:61], s57 glc
    s_load_dwordx2 s[40:41], s[60:61], s58 glc
    s_load_dwordx2 s[44:45], s[60:61], s59 glc
PL_25_W:
    s_sub_u32 s63, s63, 1
    s_cmp_eq_u32 s63, 0
    s_cselect_b32 s62, 0, s62
    s_waitcnt lgkmcnt(0)
    s_min_u32 s32, s32, s33
    s_bitcmp0_b32 s7, 0
    s_cbranch_scc1 PL_25_0
    s_cmp_lt_u32 s32, s62
    s_cbranch_scc1 PL_25_0
    s_bitset0_b32 s7, 0
    s_add_u32 s10, s4, 0
    s_cmp_ge_u32 s10, s5
    s_addc_u32 s64, s10, 0
    s_mul_i32 s64, s64, 25088
    s_add_u32 s64, s64, 0
    s_mul_i32 s65, s10, 9216
    s_add_u32 s65, s65, s21
    s_mov_b32 m0, s65
    s_nop 0
    buffer_load_dwordx4 v114, s[12:15], s64 offen sc1 lds
    buffer_load_dwordx4 v114, s[12:15], s64 offen offset:1024 sc1 lds
    buffer_load_dwordx4 v114, s[12:15], s64 offen offset:2048 sc1 lds
    buffer_load_dwordx4 v114, s[12:15], s64 offen offset:3072 sc1 lds
    s_add_u32 s64, s64, 4096
    s_add_u32 s65, s65, 4096
    s_mov_b32 m0, s65
    s_nop 0
    buffer_load_dwordx4 v114, s[12:15], s64 offen sc1 lds
    buffer_load_dwordx4 v114, s[12:15], s64 offen offset:1024 sc1 lds
    buffer_load_dwordx4 v114, s[12:15], s64 offen offset:2048 sc1 lds
PL_25_0:
    s_min_u32 s36, s36, s37
    s_bitcmp0_b32 s7, 1
    s_cbranch_scc1 PL_25_1
    s_cmp_lt_u32 s36, s62
    s_cbranch_scc1 PL_25_1
    s_bitset0_b32 s7, 1
    s_add_u32 s10, s4, 1
    s_cmp_ge_u32 s10, s5
    s_addc_u32 s64, s10, 0
    s_mul_i32 s64, s64, 25088
    s_add_u32 s64, s64, 0
    s_mul_i32 s65, s10, 9216
    s_add_u32 s65, s65, s21
    s_mov_b32 m0, s65
    s_nop 0
    buffer_load_dwordx4 v114, s[12:15], s64 offen sc1 lds
    buffer_load_dwordx4 v114, s[12:15], s64 offen offset:1024 sc1 lds
    buffer_load_dwordx4 v114, s[12:15], s64 offen offset:2048 sc1 lds
    buffer_load_dwordx4 v114, s[12:15], s64 offen offset:3072 sc1 lds
    s_add_u32 s64, s64, 4096
    s_add_u32 s65, s65, 4096
    s_mov_b32 m0, s65
    s_nop 0
    buffer_load_dwordx4 v114, s[12:15], s64 offen sc1 lds
    buffer_load_dwordx4 v114, s[12:15], s64 offen offset:1024 sc1 lds
    buffer_load_dwordx4 v114, s[12:15], s64 offen offset:2048 sc1 lds
PL_25_1:
    s_min_u32 s40, s40, s41
    s_bitcmp0_b32 s7, 2
    s_cbranch_scc1 PL_25_2
    s_cmp_lt_u32 s40, s62
    s_cbranch_scc1 PL_25_2
    s_bitset0_b32 s7, 2
    s_add_u32 s10, s4, 2
    s_cmp_ge_u32 s10, s5
    s_addc_u32 s64, s10, 0
    s_mul_i32 s64, s64, 25088
    s_add_u32 s64, s64, 0
    s_mul_i32 s65, s10, 9216
    s_add_u32 s65, s65, s21
    s_mov_b32 m0, s65
    s_nop 0
    buffer_load_dwordx4 v114, s[12:15], s64 offen sc1 lds
    buffer_load_dwordx4 v114, s[12:15], s64 offen offset:1024 sc1 lds
    buffer_load_dwordx4 v114, s[12:15], s64 offen offset:2048 sc1 lds
    buffer_load_dwordx4 v114, s[12:15], s64 offen offset:3072 sc1 lds
    s_add_u32 s64, s64, 4096
    s_add_u32 s65, s65, 4096
    s_mov_b32 m0, s65
    s_nop 0
    buffer_load_dwordx4 v114, s[12:15], s64 offen sc1 lds
    buffer_load_dwordx4 v114, s[12:15], s64 offen offset:1024 sc1 lds
    buffer_load_dwordx4 v114, s[12:15], s64 offen offset:2048 sc1 lds
PL_25_2:
    s_min_u32 s44, s44, s45
    s_bitcmp0_b32 s7, 3
    s_cbranch_scc1 PL_25_3
    s_cmp_lt_u32 s44, s62
    s_cbranch_scc1 PL_25_3
    s_bitset0_b32 s7, 3
    s_add_u32 s10, s4, 3
    s_cmp_ge_u32 s10, s5
    s_addc_u32 s64, s10, 0
    s_mul_i32 s64, s64, 25088
    s_add_u32 s64, s64, 0
    s_mul_i32 s65, s10, 9216
    s_add_u32 s65, s65, s21
    s_mov_b32 m0, s65
    s_nop 0
    buffer_load_dwordx4 v114, s[12:15], s64 offen sc1 lds
    buffer_load_dwordx4 v114, s[12:15], s64 offen offset:1024 sc1 lds
    buffer_load_dwordx4 v114, s[12:15], s64 offen offset:2048 sc1 lds
    buffer_load_dwordx4 v114, s[12:15], s64 offen offset:3072 sc1 lds
    s_add_u32 s64, s64, 4096
    s_add_u32 s65, s65, 4096
    s_mov_b32 m0, s65
    s_nop 0
    buffer_load_dwordx4 v114, s[12:15], s64 offen sc1 lds
    buffer_load_dwordx4 v114, s[12:15], s64 offen offset:1024 sc1 lds
    buffer_load_dwordx4 v114, s[12:15], s64 offen offset:2048 sc1 lds
PL_25_3:
    s_cmp_lg_u32 s7, 0
    s_cbranch_scc1 PL_25
    s_add_u32 s60, s28, 1024
    s_addc_u32 s61, s29, 0
    s_load_dwordx4 s[32:35], s[60:61], s56 glc
    s_load_dwordx4 s[36:39], s[60:61], s57 glc
    s_load_dwordx4 s[40:43], s[60:61], s58 glc
    s_load_dwordx4 s[44:47], s[60:61], s59 glc
    s_waitcnt vmcnt(0)
    v_mov_b32 v0, 154880
    v_mov_b32 v1, 1
    s_mov_b64 exec, 1
    ds_add_u32 v0, v1 offset:24
    s_mov_b64 exec, -1
    s_branch K3_HL
K3_WARM:
    s_load_dwordx2 s[44:45], s[0:1], 0
    v_lshrrev_b32 v20, 7, v114
    v_and_b32 v21, 127, v114
    s_mov_b32 s10, 200704
    v_mad_u32_u24 v20, v20, s10, v21
    s_mul_i32 s10, s2, 768
    s_sub_u32 s11, s3, 14
    s_mul_i32 s11, s11, 19267584
    s_add_u32 s10, s10, s11
    s_add_u32 s10, s10, 6422528
    s_mov_b32 s40, s8
    s_mov_b32 s41, s9
    s_mov_b32 s42, 0x3100000
    s_mov_b32 s43, 0x20000
    buffer_load_dwordx4 v[24:27], v20, s[40:43], s10 offen
    s_add_u32 s10, s10, 1605632
    buffer_load_dwordx4 v[24:27], v20, s[40:43], s10 offen
    s_add_u32 s10, s10, 1605632
    buffer_load_dwordx4 v[24:27], v20, s[40:43], s10 offen
    s_add_u32 s10, s10, 1605632
    buffer_load_dwordx4 v[24:27], v20, s[40:43], s10 offen
    s_add_u32 s10, s10, 1605632
    buffer_load_dwordx4 v[24:27], v20, s[40:43], s10 offen
    s_add_u32 s10, s10, 1605632
    buffer_load_dwordx4 v[24:27], v20, s[40:43], s10 offen
    s_add_u32 s10, s10, 1605632
    buffer_load_dwordx4 v[24:27], v20, s[40:43], s10 offen
    s_add_u32 s10, s10, 1605632
    buffer_load_dwordx4 v[24:27], v20, s[40:43], s10 offen
    s_add_u32 s10, s10, 1605632
    buffer_load_dwordx4 v[24:27], v20, s[40:43], s10 offen
    s_add_u32 s10, s10, 1605632
    buffer_load_dwordx4 v[24:27], v20, s[40:43], s10 offen
    s_add_u32 s10, s10, 1605632
    buffer_load_dwordx4 v[24:27], v20, s[40:43], s10 offen
    s_add_u32 s10, s10, 1605632
    buffer_load_dwordx4 v[24:27], v20, s[40:43], s10 offen
    s_waitcnt lgkmcnt(0)
    s_mov_b32 s46, 6400000
    s_mov_b32 s47, 0x20000
    s_mul_i32 s10, s2, 24576
    s_sub_u32 s11, s3, 14
    s_lshl_b32 s11, s11, 11
    s_add_u32 s10, s10, s11
    s_add_u32 s10, s10, 0
    buffer_load_dwordx4 v[24:27], v114, s[44:47], s10 offen offset:0
    buffer_load_dwordx4 v[24:27], v114, s[44:47], s10 offen offset:1024
    s_cmp_ge_u32 s2, 64
    s_cbranch_scc1 K3_END
    s_cmp_eq_u32 s3, 14
    s_cbranch_scc1 K3_END
    v_lshrrev_b32 v0, 4, v114
    s_getpc_b64 s[40:41]
CP_26:
    s_add_u32 s40, s40, attn_kernel-CP_26
    s_addc_u32 s41, s41, 0
    s_mov_b32 s42, CODE_END-attn_kernel
    s_mov_b32 s43, 0x20000
    v_and_b32 v20, 63, v0
    v_lshlrev_b32 v20, 4, v20
    s_lshl_b32 s44, s5, 10
    buffer_load_dwordx4 v[24:27], v20, s[40:43], s44 offen
    s_add_u32 s44, s44, 8192
    buffer_load_dwordx4 v[24:27], v20, s[40:43], s44 offen
    s_add_u32 s44, s44, 8192
    s_add_u32 s40, s8, 0x34f0000
    s_addc_u32 s41, s9, 0
    s_mov_b32 s42, 0x11400
    s_mov_b32 s43, 0x20000
    s_lshl_b32 s44, s5, 10
    buffer_load_dwordx4 v[24:27], v20, s[40:43], s44 offen
    s_add_u32 s44, s44, 8192
    buffer_load_dwordx4 v[24:27], v20, s[40:43], s44 offen
    s_add_u32 s44, s44, 8192
    buffer_load_dwordx4 v[24:27], v20, s[40:43], s44 offen
    s_add_u32 s44, s44, 8192
    buffer_load_dwordx4 v[24:27], v20, s[40:43], s44 offen
    s_add_u32 s44, s44, 8192
    buffer_load_dwordx4 v[24:27], v20, s[40:43], s44 offen
    s_add_u32 s44, s44, 8192
    buffer_load_dwordx4 v[24:27], v20, s[40:43], s44 offen
    s_add_u32 s44, s44, 8192
    buffer_load_dwordx4 v[24:27], v20, s[40:43], s44 offen
    s_add_u32 s44, s44, 8192
    buffer_load_dwordx4 v[24:27], v20, s[40:43], s44 offen
    s_add_u32 s44, s44, 8192
    buffer_load_dwordx4 v[24:27], v20, s[40:43], s44 offen
    s_add_u32 s44, s44, 8192
K3_END:
    s_endpgm
.text
.globl attn_kernel
.p2align 8
.type attn_kernel,@function
attn_kernel:

    s_cmp_ge_u32 s2, 256
    s_cbranch_scc1 K4_END
    s_load_dwordx2 s[8:9], s[0:1], 88
    s_load_dwordx2 s[40:41], s[0:1], 0
    s_load_dwordx2 s[42:43], s[0:1], 24
    s_load_dwordx2 s[10:11], s[0:1], 72
    v_lshrrev_b32 v1, 6, v0
    v_and_b32 v2, 63, v0
    v_lshrrev_b32 v3, 4, v2
    v_readfirstlane_b32 s3, v1
    v_and_b32 v4, 15, v2
    v_lshlrev_b32 v205, 4, v2
    v_lshrrev_b32 v5, 3, v2
    v_and_b32 v6, 7, v2
    s_and_b32 s4, s3, 3
    s_lshr_b32 s5, s3, 2
    s_mul_i32 s32, s2, 96
    s_lshl_b32 s7, s5, 4
    s_add_u32 s32, s32, s7
    s_lshl_b32 s7, s5, 15
    s_add_u32 s7, s7, 69632
    s_add_u32 s33, s4, 1
    v_subrev_u32 v6, s33, v6
    v_and_b32 v6, 7, v6
    v_lshlrev_b32 v6, 4, v6
    v_and_b32 v7, 3, v5
    v_lshrrev_b32 v8, 2, v5
    v_lshl_or_b32 v7, v7, 1, v8
    s_mov_b32 s33, 200704
    v_mad_u32_u24 v215, v7, s33, v6
    s_lshl_b32 s33, s4, 10
    v_lshl_add_u32 v216, v3, 8, s33
    v_lshl_add_u32 v216, v4, 4, v216
    v_lshrrev_b32 v7, 3, v4
    v_and_b32 v8, 7, v4
    v_lshrrev_b32 v5, 1, v3
    s_lshl_b32 s33, s4, 2
    v_xor_b32 v17, v5, v7
    v_lshl_add_u32 v9, v17, 1, v5
    v_add_lshl_u32 v9, v9, s33, 1
    v_mov_b32 v10, 0x40000000
    v_cmp_eq_u32 vcc, 0, v8
    s_waitcnt lgkmcnt(0)
    v_cndmask_b32 v218, v9, v10, vcc
    v_add_lshl_u32 v9, v7, s33, 8
    v_lshl_add_u32 v9, v3, 4, v9
    v_cndmask_b32 v219, v10, v9, vcc
    s_mov_b32 s12, s8
    s_mov_b32 s13, s9
    s_mov_b32 s14, 0x3100000
    s_mov_b32 s15, 0x20000
    s_mov_b32 s16, s40
    s_mov_b32 s17, s41
    s_mov_b32 s18, 0x61a800
    s_mov_b32 s19, 0x20000
    s_mov_b32 s20, s42
    s_mov_b32 s21, s43
    s_mov_b32 s22, 0xc350
    s_mov_b32 s23, 0x20000
    s_mov_b32 s24, s10
    s_mov_b32 s25, s11
    s_mov_b32 s26, 0x61a800
    s_mov_b32 s27, 0x20000
    s_add_u32 s28, s8, 0x34f0000
    s_addc_u32 s29, s9, 0
    s_mov_b32 s30, 0x11400
    s_mov_b32 s31, 0x20000
    s_load_dword s51, s[28:29], 69884
    s_cmp_eq_u32 s5, 0
    s_cbranch_scc0 K4_WB
    s_add_u32 s34, s4, 1
    s_mul_i32 s33, s34, 6422528
    s_lshl_b32 s37, s32, 3
    s_add_u32 s33, s33, s37
    s_lshl_b32 s34, s34, 12
    s_add_u32 s34, s34, s7
    v_xor_b32 v227, 64, v215
    s_mov_b32 m0, s34
    s_add_u32 s34, s34, 1024
    buffer_load_dwordx4 v215, s[12:15], s33 offen lds
    s_add_u32 s33, s33, 1605632
    s_mov_b32 m0, s34
    s_add_u32 s34, s34, 1024
    buffer_load_dwordx4 v215, s[12:15], s33 offen lds
    s_add_u32 s33, s33, 1605632
    s_mov_b32 m0, s34
    s_add_u32 s34, s34, 1024
    buffer_load_dwordx4 v215, s[12:15], s33 offen lds
    s_add_u32 s33, s33, 1605632
    s_mov_b32 m0, s34
    s_add_u32 s34, s34, 1024
    buffer_load_dwordx4 v215, s[12:15], s33 offen lds
    s_cmp_eq_u32 s4, 3
    s_cbranch_scc1 PF_27
    s_add_u32 s33, s33, 20873216
    s_add_u32 s34, s34, 12288
    s_mov_b32 m0, s34
    s_add_u32 s34, s34, 1024
    buffer_load_dwordx4 v227, s[12:15], s33 offen lds
    s_add_u32 s33, s33, 1605632
    s_mov_b32 m0, s34
    s_add_u32 s34, s34, 1024
    buffer_load_dwordx4 v227, s[12:15], s33 offen lds
    s_add_u32 s33, s33, 1605632
    s_mov_b32 m0, s34
    s_add_u32 s34, s34, 1024
    buffer_load_dwordx4 v227, s[12:15], s33 offen lds
    s_add_u32 s33, s33, 1605632
    s_mov_b32 m0, s34
    s_add_u32 s34, s34, 1024
    buffer_load_dwordx4 v227, s[12:15], s33 offen lds
PF_27:
    s_lshl_b32 s33, s32, 8
    s_lshl_b32 s34, s32, 1
    buffer_load_dwordx4 v[222:225], v216, s[16:19], s33 offen
    buffer_load_ushort v221, v218, s[20:23], s34 offen
    s_lshl_b32 s33, s3, 10
    s_mov_b32 m0, s33
    s_nop 0
    buffer_load_dwordx4 v205, s[28:31], s33 offen lds
    s_add_u32 s33, s33, 8192
    s_mov_b32 m0, s33
    s_nop 0
    buffer_load_dwordx4 v205, s[28:31], s33 offen lds
    s_add_u32 s33, s33, 8192
    s_mov_b32 m0, s33
    s_nop 0
    buffer_load_dwordx4 v205, s[28:31], s33 offen lds
    s_add_u32 s33, s33, 8192
    s_mov_b32 m0, s33
    s_nop 0
    buffer_load_dwordx4 v205, s[28:31], s33 offen lds
    s_add_u32 s33, s33, 8192
    s_mov_b32 m0, s33
    s_nop 0
    buffer_load_dwordx4 v205, s[28:31], s33 offen lds
    s_add_u32 s33, s33, 8192
    s_mov_b32 m0, s33
    s_nop 0
    buffer_load_dwordx4 v205, s[28:31], s33 offen lds
    s_add_u32 s33, s33, 8192
    s_mov_b32 m0, s33
    s_nop 0
    buffer_load_dwordx4 v205, s[28:31], s33 offen lds
    s_add_u32 s33, s33, 8192
    s_mov_b32 m0, s33
    s_nop 0
    buffer_load_dwordx4 v205, s[28:31], s33 offen lds
    s_add_u32 s33, s33, 8192
    s_cmp_ge_u32 s3, 4
    s_cbranch_scc1 WD_28
    s_mov_b32 m0, s33
    s_nop 0
    buffer_load_dwordx4 v205, s[28:31], s33 offen lds
    s_add_u32 s33, s33, 8192
WD_28:
    s_branch K4_WC
K4_WB:
    s_lshl_b32 s33, s3, 10
    s_mov_b32 m0, s33
    s_nop 0
    buffer_load_dwordx4 v205, s[28:31], s33 offen lds
    s_add_u32 s33, s33, 8192
    s_mov_b32 m0, s33
    s_nop 0
    buffer_load_dwordx4 v205, s[28:31], s33 offen lds
    s_add_u32 s33, s33, 8192
    s_mov_b32 m0, s33
    s_nop 0
    buffer_load_dwordx4 v205, s[28:31], s33 offen lds
    s_add_u32 s33, s33, 8192
    s_mov_b32 m0, s33
    s_nop 0
    buffer_load_dwordx4 v205, s[28:31], s33 offen lds
    s_add_u32 s33, s33, 8192
    s_mov_b32 m0, s33
    s_nop 0
    buffer_load_dwordx4 v205, s[28:31], s33 offen lds
    s_add_u32 s33, s33, 8192
    s_mov_b32 m0, s33
    s_nop 0
    buffer_load_dwordx4 v205, s[28:31], s33 offen lds
    s_add_u32 s33, s33, 8192
    s_mov_b32 m0, s33
    s_nop 0
    buffer_load_dwordx4 v205, s[28:31], s33 offen lds
    s_add_u32 s33, s33, 8192
    s_mov_b32 m0, s33
    s_nop 0
    buffer_load_dwordx4 v205, s[28:31], s33 offen lds
    s_add_u32 s33, s33, 8192
    s_cmp_ge_u32 s3, 4
    s_cbranch_scc1 WD_29
    s_mov_b32 m0, s33
    s_nop 0
    buffer_load_dwordx4 v205, s[28:31], s33 offen lds
    s_add_u32 s33, s33, 8192
WD_29:
K4_WC:
    v_add_u32 v206, 0x10000, v205
    s_mov_b32 s48, 0x3c000000
    s_mov_b32 s49, 0x3727c5ac
    s_mov_b32 s50, 0x3fb8aa3b
    v_cmp_eq_u32 vcc, v5, v7
    v_and_b32 v10, 1, v3
    s_lshl_b32 s33, s4, 1
    v_lshlrev_b32 v11, 7, v5
    v_lshl_add_u32 v211, v3, 4, v11
    v_xor_b32 v226, 32, v211
    v_cndmask_b32 v214, 0, -1, vcc
    v_cndmask_b32 v212, v226, v211, vcc
    v_lshrrev_b32 v14, 2, v4
    v_and_b32 v15, 3, v4
    v_lshlrev_b32 v11, 6, v14
    v_lshl_add_u32 v220, v4, 2, v11
    v_lshlrev_b32 v12, 7, v17
    v_xor_b32 v11, v11, v12
    v_lshl_add_u32 v213, v15, 4, v11
    v_lshl_add_u32 v213, v17, 3, v213
    s_lshl_b32 s52, s5, 3
    s_add_u32 s52, s52, 135168
    v_mov_b32 v11, s52
    v_mov_b32 v12, 0
    v_mov_b32 v13, 0
    ds_write_b64 v11, v[12:13]
    v_lshlrev_b32 v11, 12, v8
    v_lshl_add_u32 v11, v3, 7, v11
    v_lshl_add_u32 v11, v7, 3, v11
    v_add_u32 v11, s7, v11
    v_add_u32 v12, s33, v8
    v_add_u32 v13, 0, v12
    v_and_b32 v13, 7, v13
    v_lshl_add_u32 v207, v13, 4, v11
    v_add_u32 v13, 1, v12
    v_and_b32 v13, 7, v13
    v_lshl_add_u32 v208, v13, 4, v11
    v_lshl_add_u32 v14, v10, 2, v14
    v_lshlrev_b32 v11, 12, v14
    v_lshl_add_u32 v11, v15, 7, v11
    v_lshl_add_u32 v11, v5, 3, v11
    v_add_u32 v11, s7, v11
    v_add_u32 v12, s33, v14
    v_add_u32 v13, 0, v12
    v_and_b32 v13, 7, v13
    v_lshl_add_u32 v209, v13, 4, v11
    v_add_u32 v13, 1, v12
    v_and_b32 v13, 7, v13
    v_lshl_add_u32 v210, v13, 4, v11
    v_lshrrev_b32 v11, 2, v4
    v_lshlrev_b32 v11, 10, v11
    v_lshl_add_u32 v11, v15, 7, v11
    v_add_u32 v12, s33, v5
    v_lshl_add_u32 v11, v12, 4, v11
    v_lshl_add_u32 v11, v10, 3, v11
    v_add_u32 v217, s7, v11
    v_lshlrev_b32 v12, 2, v3
    v_sub_u32 v12, v4, v12
    v_mov_b32 v13, 0x3f80
    v_mov_b32 v14, 0x3f800000
    v_cmp_eq_u32 s[40:41], 0, v12
    v_cmp_eq_u32 s[42:43], 1, v12
    v_cmp_eq_u32 s[44:45], 2, v12
    v_cmp_eq_u32 vcc, 3, v12
    v_cndmask_b32 v15, 0, v13, s[40:41]
    v_cndmask_b32 v16, 0, v13, s[44:45]
    v_cndmask_b32 v15, v15, v14, s[42:43]
    v_cndmask_b32 v16, v16, v14, vcc
    v_mov_b32 v56, v15
    v_mov_b32 v57, v16
    v_mov_b32 v66, v15
    v_mov_b32 v67, v16
    v_mov_b32 v76, v15
    v_mov_b32 v77, v16
    v_mov_b32 v86, v15
    v_mov_b32 v87, v16
    v_mov_b32 v182, 0
    v_mov_b32 v183, 0
    v_mov_b32 v96, v15
    v_mov_b32 v97, v16
    v_mov_b32 v106, v15
    v_mov_b32 v107, v16
    v_mov_b32 v116, v15
    v_mov_b32 v117, v16
    v_mov_b32 v126, v15
    v_mov_b32 v127, v16
    v_mov_b32 v186, 0
    v_mov_b32 v187, 0
    s_mov_b32 s35, 0
    s_mov_b32 s44, 0xaaaaaaaa
    s_mov_b32 s45, 0xaaaaaaaa
    s_mov_b32 s46, 0xcccccccc
    s_mov_b32 s47, 0xcccccccc
    s_cmp_eq_u32 s5, 0
    s_cbranch_scc0 K4_WE
    s_waitcnt vmcnt(0)
K4_WE:
    s_waitcnt vmcnt(0) lgkmcnt(0)
    s_barrier
    s_cmp_eq_u32 s5, 0
    s_cbranch_scc1 K4_WF
    s_add_u32 s34, s4, 1
    s_mul_i32 s33, s34, 6422528
    s_lshl_b32 s37, s32, 3
    s_add_u32 s33, s33, s37
    s_lshl_b32 s34, s34, 12
    s_add_u32 s34, s34, s7
    v_xor_b32 v227, 64, v215
    s_mov_b32 m0, s34
    s_add_u32 s34, s34, 1024
    buffer_load_dwordx4 v215, s[12:15], s33 offen lds
    s_add_u32 s33, s33, 1605632
    s_mov_b32 m0, s34
    s_add_u32 s34, s34, 1024
    buffer_load_dwordx4 v215, s[12:15], s33 offen lds
    s_add_u32 s33, s33, 1605632
    s_mov_b32 m0, s34
    s_add_u32 s34, s34, 1024
    buffer_load_dwordx4 v215, s[12:15], s33 offen lds
    s_add_u32 s33, s33, 1605632
    s_mov_b32 m0, s34
    s_add_u32 s34, s34, 1024
    buffer_load_dwordx4 v215, s[12:15], s33 offen lds
    s_cmp_eq_u32 s4, 3
    s_cbranch_scc1 PF_30
    s_add_u32 s33, s33, 20873216
    s_add_u32 s34, s34, 12288
    s_mov_b32 m0, s34
    s_add_u32 s34, s34, 1024
    buffer_load_dwordx4 v227, s[12:15], s33 offen lds
    s_add_u32 s33, s33, 1605632
    s_mov_b32 m0, s34
    s_add_u32 s34, s34, 1024
    buffer_load_dwordx4 v227, s[12:15], s33 offen lds
    s_add_u32 s33, s33, 1605632
    s_mov_b32 m0, s34
    s_add_u32 s34, s34, 1024
    buffer_load_dwordx4 v227, s[12:15], s33 offen lds
    s_add_u32 s33, s33, 1605632
    s_mov_b32 m0, s34
    s_add_u32 s34, s34, 1024
    buffer_load_dwordx4 v227, s[12:15], s33 offen lds
PF_30:
    s_lshl_b32 s33, s32, 8
    s_lshl_b32 s34, s32, 1
    buffer_load_dwordx4 v[222:225], v216, s[16:19], s33 offen
    buffer_load_ushort v221, v218, s[20:23], s34 offen
K4_WF:
    s_waitcnt vmcnt(0)
    ds_write2st64_b64 v217, v[222:223], v[224:225] offset1:1
    s_waitcnt lgkmcnt(0)
    v_mov_b32 v203, s52
    v_mov_b32 v204, 1
    s_mov_b64 exec, 1
    ds_add_u32 v203, v204 offset:0
    s_mov_b64 exec, -1
K4_LOOP:
    v_mov_b32 v203, s52
    v_lshlrev_b32 v199, 16, v221
    s_add_u32 s35, s35, 1
    v_cmp_eq_f32 vcc, 0, v199
    s_lshl_b32 s38, s35, 2
    s_lshl_b32 s36, s32, 8
    v_cndmask_b32 v199, v199, 1.0, vcc
SP_31:
    ds_read_b32 v204, v203 offset:0
    s_waitcnt lgkmcnt(0)
    v_readfirstlane_b32 s33, v204
    s_cmp_ge_u32 s33, s38
    s_cbranch_scc1 SP_31_E
    s_sleep 1
    s_branch SP_31
SP_31_E:
    s_setprio 3
    s_cmp_eq_u32 s35, 1
    s_cbranch_scc1 K4_PS
    s_setprio 2
    s_cmp_eq_u32 s35, 2
    s_cbranch_scc1 K4_PS
    s_setprio 1
K4_PS:
    ds_read_b64 v[2:3], v207 offset:0
    ds_read_b64 v[4:5], v207 offset:512
    ds_read_b64 v[28:29], v208 offset:0
    ds_read_b64 v[30:31], v208 offset:512
    ds_read_b128 v[228:231], v206 offset:0
    ds_read_b64 v[8:9], v207 offset:1024
    ds_read_b64 v[10:11], v207 offset:1536
    ds_read_b64 v[34:35], v208 offset:1024
    ds_read_b64 v[36:37], v208 offset:1536
    ds_read_b128 v[232:235], v206 offset:1024
    ds_read_b64 v[14:15], v207 offset:2048
    ds_read_b64 v[16:17], v207 offset:2560
    ds_read_b64 v[40:41], v208 offset:2048
    ds_read_b64 v[42:43], v208 offset:2560
    s_waitcnt lgkmcnt(10)
    ds_read_b64 v[20:21], v207 offset:3072
    ds_read_b64 v[22:23], v207 offset:3584
    ds_read_b64 v[46:47], v208 offset:3072
    ds_read_b64 v[48:49], v208 offset:3584
    s_waitcnt lgkmcnt(10)
    ds_read_b128 v[236:239], v206 offset:2048
    ds_read_b128 v[240:243], v206 offset:3072
    ds_read_b128 v[244:247], v205 offset:0
    ds_read_b128 v[248:251], v205 offset:1024
    v_mul_f32 v200, v199, v199
    v_mul_f32 v200, s49, v200
    v_mfma_f32_16x16x32_bf16 v[164:167], v[2:5], v[2:5], 0
    v_mfma_f32_16x16x32_bf16 v[168:171], v[2:5], v[228:231], 0
    v_mfma_f32_16x16x32_bf16 v[176:179], v[28:31], v[228:231], 0
    s_waitcnt lgkmcnt(10)
    ds_read_b128 v[228:231], v205 offset:2048
    v_mfma_f32_16x16x32_bf16 v[172:175], v[28:31], v[28:31], 0
    v_mfma_f32_16x16x32_bf16 v[168:171], v[8:11], v[232:235], v[168:171]
    v_mfma_f32_16x16x32_bf16 v[176:179], v[34:37], v[232:235], v[176:179]
    ds_read_b128 v[232:235], v205 offset:3072
    v_mfma_f32_16x16x32_bf16 v[164:167], v[8:11], v[8:11], v[164:167]
    v_mfma_f32_16x16x32_bf16 v[172:175], v[34:37], v[34:37], v[172:175]
    v_mfma_f32_16x16x32_bf16 v[164:167], v[14:17], v[14:17], v[164:167]
    s_waitcnt lgkmcnt(10)
    v_mfma_f32_16x16x32_bf16 v[172:175], v[40:43], v[40:43], v[172:175]
    s_waitcnt lgkmcnt(8)
    v_mfma_f32_16x16x32_bf16 v[164:167], v[20:23], v[20:23], v[164:167]
    s_waitcnt lgkmcnt(6)
    v_mfma_f32_16x16x32_bf16 v[172:175], v[46:49], v[46:49], v[172:175]
    s_waitcnt lgkmcnt(5)
    v_mfma_f32_16x16x32_bf16 v[168:171], v[14:17], v[236:239], v[168:171]
    s_nop 3
    v_cndmask_b32 v164, v164, v165, s[44:45]
    v_cndmask_b32 v166, v166, v167, s[44:45]
    v_mfma_f32_16x16x32_bf16 v[176:179], v[40:43], v[236:239], v[176:179]
    ds_read_b128 v[236:239], v205 offset:4096
    v_cndmask_b32 v172, v172, v173, s[44:45]
    v_cndmask_b32 v174, v174, v175, s[44:45]
    s_waitcnt lgkmcnt(5)
    v_mfma_f32_16x16x32_bf16 v[168:171], v[20:23], v[240:243], v[168:171]
    v_cndmask_b32 v164, v164, v166, s[46:47]
    v_cndmask_b32 v172, v172, v174, s[46:47]
    ds_bpermute_b32 v188, v220, v164
    ds_bpermute_b32 v189, v220, v172
    v_mfma_f32_16x16x32_bf16 v[176:179], v[46:49], v[240:243], v[176:179]
    ds_read_b128 v[240:243], v205 offset:5120
    s_nop 1
    v_cvt_pk_bf16_f32 v180, v168, v169
    v_mov_b32_dpp v168, v169 quad_perm:[0,1,2,3] row_mask:0xf bank_mask:0x2
    s_waitcnt lgkmcnt(7)
    v_mfma_f32_16x16x32_bf16 v[164:167], v[244:247], v[2:5], 0
    v_mov_b32_dpp v168, v170 quad_perm:[0,1,2,3] row_mask:0xf bank_mask:0x4
    v_cvt_pk_bf16_f32 v181, v170, v171
    v_mfma_f32_16x16x32_bf16 v[172:175], v[244:247], v[28:31], 0
    ds_read_b128 v[244:247], v205 offset:6144
    v_cvt_pk_bf16_f32 v184, v176, v177
    v_mov_b32_dpp v176, v177 quad_perm:[0,1,2,3] row_mask:0xf bank_mask:0x2
    s_waitcnt lgkmcnt(7)
    v_mfma_f32_16x16x32_bf16 v[164:167], v[248:251], v[8:11], v[164:167]
    v_mov_b32_dpp v176, v178 quad_perm:[0,1,2,3] row_mask:0xf bank_mask:0x4
    v_mov_b32_dpp v168, v171 quad_perm:[0,1,2,3] row_mask:0xf bank_mask:0x8
    v_mfma_f32_16x16x32_bf16 v[172:175], v[248:251], v[34:37], v[172:175]
    ds_read_b128 v[248:251], v205 offset:7168
    ds_read_b64_tr_b16 v[52:53], v209 offset:0
    v_mov_b32_dpp v176, v179 quad_perm:[0,1,2,3] row_mask:0xf bank_mask:0x8
    v_cvt_pk_bf16_f32 v185, v178, v179
    s_waitcnt lgkmcnt(8)
    v_mfma_f32_16x16x32_bf16 v[164:167], v[228:231], v[14:17], v[164:167]
    v_mov_b32_dpp v177, v176 quad_perm:[0,1,0,1] row_mask:0xf bank_mask:0xf
    v_cndmask_b32 v168, v168, v177, s[46:47]
    v_mfma_f32_16x16x32_bf16 v[172:175], v[228:231], v[40:43], v[172:175]
    ds_read_b128 v[228:231], v205 offset:8192
    ds_bpermute_b32 v196, v213, v168
    ds_bpermute_b32 v197, v213, v168 offset:4
    s_waitcnt lgkmcnt(10)
    v_mfma_f32_16x16x32_bf16 v[164:167], v[232:235], v[20:23], v[164:167]
    s_waitcnt lgkmcnt(7)
    v_mov_b32_dpp v188, v189 row_ror:8 row_mask:0x3 bank_mask:0xc
    v_mfma_f32_16x16x32_bf16 v[172:175], v[232:235], v[46:49], v[172:175]
    ds_read_b128 v[232:235], v205 offset:9216
    ds_read_b64_tr_b16 v[92:93], v210 offset:0
    v_mov_b32_dpp v188, v189 row_ror:8 row_mask:0xc bank_mask:0x3
    v_mfma_f32_16x16x32_bf16 v[168:171], v[236:239], v[2:5], 0
    s_nop 0
    v_cvt_pk_bf16_f32 v132, v164, v165
    v_cvt_pk_bf16_f32 v133, v166, v167
    v_mfma_f32_16x16x32_bf16 v[176:179], v[236:239], v[28:31], 0
    ds_read_b128 v[236:239], v205 offset:10240
    v_cvt_pk_bf16_f32 v148, v172, v173
    v_cvt_pk_bf16_f32 v149, v174, v175
    s_waitcnt lgkmcnt(9)
    v_mfma_f32_16x16x32_bf16 v[168:171], v[240:243], v[8:11], v[168:171]
    v_mfma_f32_16x16x32_bf16 v[176:179], v[240:243], v[34:37], v[176:179]
    ds_read_b128 v[240:243], v205 offset:11264
    ds_read_b64_tr_b16 v[60:61], v209 offset:512
    s_waitcnt lgkmcnt(10)
    v_mfma_f32_16x16x32_bf16 v[168:171], v[244:247], v[14:17], v[168:171]
    v_mfma_f32_16x16x32_bf16 v[176:179], v[244:247], v[40:43], v[176:179]
    ds_read_b128 v[244:247], v205 offset:12288
    s_waitcnt lgkmcnt(7)
    v_mul_f32 v201, s48, v196
    v_mfma_f32_16x16x32_bf16 v[168:171], v[248:251], v[20:23], v[168:171]
    v_fma_f32 v202, -v201, v201, v200
    v_and_b32 v201, 0x80000000, v199
    v_mfma_f32_16x16x32_bf16 v[176:179], v[248:251], v[46:49], v[176:179]
    ds_read_b128 v[248:251], v205 offset:13312
    ds_read_b64_tr_b16 v[100:101], v210 offset:512
    v_fmac_f32 v202, s48, v188
    v_mfma_f32_16x16x32_bf16 v[164:167], v[228:231], v[2:5], 0
    s_nop 0
    v_cvt_pk_bf16_f32 v134, v168, v169
    v_cvt_pk_bf16_f32 v135, v170, v171
    v_mfma_f32_16x16x32_bf16 v[172:175], v[228:231], v[28:31], 0
    ds_read_b128 v[228:231], v205 offset:14336
    v_cvt_pk_bf16_f32 v150, v176, v177
    v_cvt_pk_bf16_f32 v151, v178, v179
    s_waitcnt lgkmcnt(8)
    v_mfma_f32_16x16x32_bf16 v[164:167], v[232:235], v[8:11], v[164:167]
    v_max_f32 v202, v202, v200
    v_rsq_f32 v202, v202
    v_mfma_f32_16x16x32_bf16 v[172:175], v[232:235], v[34:37], v[172:175]
    ds_read_b128 v[232:235], v205 offset:15360
    ds_read_b64_tr_b16 v[62:63], v209 offset:1024
    v_or_b32 v198, v202, v201
    s_waitcnt lgkmcnt(8)
    v_mfma_f32_16x16x32_bf16 v[164:167], v[236:239], v[14:17], v[164:167]
    ds_bpermute_b32 v192, v212, v198
    ds_bpermute_b32 v193, v212, v198 offset:4
    ds_bpermute_b32 v194, v212, v198 offset:8
    ds_bpermute_b32 v195, v212, v198 offset:12
    v_mfma_f32_16x16x32_bf16 v[172:175], v[236:239], v[40:43], v[172:175]
    ds_read_b128 v[236:239], v205 offset:16384
    s_waitcnt lgkmcnt(12)
    v_mfma_f32_16x16x32_bf16 v[164:167], v[240:243], v[20:23], v[164:167]
    v_mfma_f32_16x16x32_bf16 v[172:175], v[240:243], v[46:49], v[172:175]
    ds_read_b128 v[240:243], v205 offset:17408
    ds_read_b64_tr_b16 v[102:103], v210 offset:1024
    s_waitcnt lgkmcnt(12)
    v_mfma_f32_16x16x32_bf16 v[168:171], v[244:247], v[2:5], 0
    s_nop 2
    v_cvt_pk_bf16_f32 v136, v164, v165
    v_cvt_pk_bf16_f32 v137, v166, v167
    v_mfma_f32_16x16x32_bf16 v[176:179], v[244:247], v[28:31], 0
    ds_read_b128 v[244:247], v205 offset:18432
    v_cvt_pk_bf16_f32 v152, v172, v173
    v_cvt_pk_bf16_f32 v153, v174, v175
    s_waitcnt lgkmcnt(12)
    v_mfma_f32_16x16x32_bf16 v[168:171], v[248:251], v[8:11], v[168:171]
    v_mfma_f32_16x16x32_bf16 v[176:179], v[248:251], v[34:37], v[176:179]
    ds_read_b128 v[248:251], v205 offset:19456
    ds_read_b64_tr_b16 v[70:71], v209 offset:1536
    s_waitcnt lgkmcnt(12)
    v_mfma_f32_16x16x32_bf16 v[168:171], v[228:231], v[14:17], v[168:171]
    v_mfma_f32_16x16x32_bf16 v[176:179], v[228:231], v[40:43], v[176:179]
    ds_read_b128 v[228:231], v205 offset:20480
    s_waitcnt lgkmcnt(12)
    v_mfma_f32_16x16x32_bf16 v[168:171], v[232:235], v[20:23], v[168:171]
    v_mfma_f32_16x16x32_bf16 v[176:179], v[232:235], v[46:49], v[176:179]
    ds_read_b128 v[232:235], v205 offset:21504
    ds_read_b64_tr_b16 v[110:111], v210 offset:1536
    s_waitcnt lgkmcnt(8)
    v_mfma_f32_16x16x32_bf16 v[164:167], v[236:239], v[2:5], 0
    s_nop 2
    v_cvt_pk_bf16_f32 v138, v168, v169
    v_cvt_pk_bf16_f32 v139, v170, v171
    v_mfma_f32_16x16x32_bf16 v[172:175], v[236:239], v[28:31], 0
    ds_read_b128 v[236:239], v205 offset:22528
    v_cvt_pk_bf16_f32 v154, v176, v177
    v_cvt_pk_bf16_f32 v155, v178, v179
    s_waitcnt lgkmcnt(8)
    v_mfma_f32_16x16x32_bf16 v[164:167], v[240:243], v[8:11], v[164:167]
    v_mfma_f32_16x16x32_bf16 v[172:175], v[240:243], v[34:37], v[172:175]
    ds_read_b128 v[240:243], v205 offset:23552
    ds_read_b64_tr_b16 v[72:73], v209 offset:2048
    s_waitcnt lgkmcnt(8)
    v_mfma_f32_16x16x32_bf16 v[164:167], v[244:247], v[14:17], v[164:167]
    v_mfma_f32_16x16x32_bf16 v[172:175], v[244:247], v[40:43], v[172:175]
    ds_read_b128 v[244:247], v205 offset:24576
    s_waitcnt lgkmcnt(8)
    v_mfma_f32_16x16x32_bf16 v[164:167], v[248:251], v[20:23], v[164:167]
    v_mfma_f32_16x16x32_bf16 v[172:175], v[248:251], v[46:49], v[172:175]
    ds_read_b128 v[248:251], v205 offset:25600
    ds_read_b64_tr_b16 v[112:113], v210 offset:2048
    s_waitcnt lgkmcnt(8)
    v_mfma_f32_16x16x32_bf16 v[168:171], v[228:231], v[2:5], 0
    s_nop 2
    v_cvt_pk_bf16_f32 v140, v164, v165
    v_cvt_pk_bf16_f32 v141, v166, v167
    v_mfma_f32_16x16x32_bf16 v[176:179], v[228:231], v[28:31], 0
    ds_read_b128 v[228:231], v205 offset:26624
    v_cvt_pk_bf16_f32 v156, v172, v173
    v_cvt_pk_bf16_f32 v157, v174, v175
    s_waitcnt lgkmcnt(8)
    v_mfma_f32_16x16x32_bf16 v[168:171], v[232:235], v[8:11], v[168:171]
    v_mfma_f32_16x16x32_bf16 v[176:179], v[232:235], v[34:37], v[176:179]
    ds_read_b128 v[232:235], v205 offset:27648
    ds_read_b64_tr_b16 v[80:81], v209 offset:2560
    s_waitcnt lgkmcnt(8)
    v_mfma_f32_16x16x32_bf16 v[168:171], v[236:239], v[14:17], v[168:171]
    v_mfma_f32_16x16x32_bf16 v[176:179], v[236:239], v[40:43], v[176:179]
    ds_read_b128 v[236:239], v205 offset:28672
    s_waitcnt lgkmcnt(8)
    v_mfma_f32_16x16x32_bf16 v[168:171], v[240:243], v[20:23], v[168:171]
    v_mfma_f32_16x16x32_bf16 v[176:179], v[240:243], v[46:49], v[176:179]
    ds_read_b128 v[240:243], v205 offset:29696
    ds_read_b64_tr_b16 v[120:121], v210 offset:2560
    s_waitcnt lgkmcnt(8)
    v_mfma_f32_16x16x32_bf16 v[164:167], v[244:247], v[2:5], 0
    s_nop 2
    v_cvt_pk_bf16_f32 v142, v168, v169
    v_cvt_pk_bf16_f32 v143, v170, v171
    v_mfma_f32_16x16x32_bf16 v[172:175], v[244:247], v[28:31], 0
    ds_read_b128 v[244:247], v205 offset:30720
    v_cvt_pk_bf16_f32 v158, v176, v177
    v_cvt_pk_bf16_f32 v159, v178, v179
    s_waitcnt lgkmcnt(8)
    v_mfma_f32_16x16x32_bf16 v[164:167], v[248:251], v[8:11], v[164:167]
    v_mfma_f32_16x16x32_bf16 v[172:175], v[248:251], v[34:37], v[172:175]
    ds_read_b128 v[248:251], v205 offset:31744
    ds_read_b64_tr_b16 v[82:83], v209 offset:3072
    s_waitcnt lgkmcnt(8)
    v_mfma_f32_16x16x32_bf16 v[164:167], v[228:231], v[14:17], v[164:167]
    v_mfma_f32_16x16x32_bf16 v[172:175], v[228:231], v[40:43], v[172:175]
    ds_read_b128 v[228:231], v205 offset:32768
    s_waitcnt lgkmcnt(8)
    v_mfma_f32_16x16x32_bf16 v[164:167], v[232:235], v[20:23], v[164:167]
    v_mfma_f32_16x16x32_bf16 v[172:175], v[232:235], v[46:49], v[172:175]
    ds_read_b128 v[232:235], v205 offset:33792
    ds_read_b64_tr_b16 v[122:123], v210 offset:3072
    s_waitcnt lgkmcnt(8)
    v_mfma_f32_16x16x32_bf16 v[168:171], v[236:239], v[2:5], 0
    s_nop 2
    v_cvt_pk_bf16_f32 v144, v164, v165
    v_cvt_pk_bf16_f32 v145, v166, v167
    v_mfma_f32_16x16x32_bf16 v[176:179], v[236:239], v[28:31], 0
    ds_read_b128 v[236:239], v205 offset:34816
    v_cvt_pk_bf16_f32 v160, v172, v173
    v_cvt_pk_bf16_f32 v161, v174, v175
    s_waitcnt lgkmcnt(8)
    v_mfma_f32_16x16x32_bf16 v[168:171], v[240:243], v[8:11], v[168:171]
    v_mfma_f32_16x16x32_bf16 v[176:179], v[240:243], v[34:37], v[176:179]
    ds_read_b128 v[240:243], v205 offset:35840
    ds_read_b64_tr_b16 v[90:91], v209 offset:3584
    s_waitcnt lgkmcnt(8)
    v_mfma_f32_16x16x32_bf16 v[168:171], v[244:247], v[14:17], v[168:171]
    v_mfma_f32_16x16x32_bf16 v[176:179], v[244:247], v[40:43], v[176:179]
    ds_read_b128 v[244:247], v205 offset:36864
    s_waitcnt lgkmcnt(8)
    v_mfma_f32_16x16x32_bf16 v[168:171], v[248:251], v[20:23], v[168:171]
    v_mfma_f32_16x16x32_bf16 v[176:179], v[248:251], v[46:49], v[176:179]
    ds_read_b128 v[248:251], v205 offset:37888
    ds_read_b64_tr_b16 v[130:131], v210 offset:3584
    v_mfma_f32_16x16x32_bf16 v[164:167], v[2:5], v[132:135], 0
    s_nop 3
    v_cvt_pk_bf16_f32 v146, v168, v169
    v_cvt_pk_bf16_f32 v147, v170, v171
    v_mfma_f32_16x16x32_bf16 v[172:175], v[28:31], v[148:151], 0
    v_cvt_pk_bf16_f32 v162, v176, v177
    v_cvt_pk_bf16_f32 v163, v178, v179
    s_waitcnt lgkmcnt(8)
    v_mfma_f32_16x16x32_bf16 v[132:135], v[2:5], v[228:231], 0
    v_mul_f32 v168, v198, v192
    v_mul_f32 v169, v198, v193
    v_mfma_f32_16x16x32_bf16 v[148:151], v[28:31], v[228:231], 0
    ds_read_b128 v[228:231], v205 offset:38912
    v_mul_f32 v170, v198, v194
    v_mul_f32 v171, v198, v195
    s_waitcnt lgkmcnt(8)
    v_mfma_f32_16x16x32_bf16 v[132:135], v[8:11], v[232:235], v[132:135]
    v_mfma_f32_16x16x32_bf16 v[148:151], v[34:37], v[232:235], v[148:151]
    ds_read_b128 v[232:235], v205 offset:39936
    s_waitcnt lgkmcnt(7)
    v_mfma_f32_16x16x32_bf16 v[132:135], v[14:17], v[236:239], v[132:135]
    v_mfma_f32_16x16x32_bf16 v[148:151], v[40:43], v[236:239], v[148:151]
    ds_read_b128 v[236:239], v205 offset:40960
    s_waitcnt lgkmcnt(7)
    v_mfma_f32_16x16x32_bf16 v[132:135], v[20:23], v[240:243], v[132:135]
    s_waitcnt lgkmcnt(3)
    v_mov_b32 v203, s52
    v_mov_b32 v204, 1
    s_mov_b64 exec, 1
    ds_add_u32 v203, v204 offset:4
    s_mov_b64 exec, -1
    v_mfma_f32_16x16x32_bf16 v[148:151], v[46:49], v[240:243], v[148:151]
    ds_read_b128 v[240:243], v205 offset:41984
    s_nop 3
    v_cvt_pk_bf16_f32 v54, v132, v133
    v_mfma_f32_16x16x32_bf16 v[164:167], v[8:11], v[136:139], v[164:167]
    v_cvt_pk_bf16_f32 v55, v134, v135
    v_mfma_f32_16x16x32_bf16 v[172:175], v[34:37], v[152:155], v[172:175]
    v_cvt_pk_bf16_f32 v94, v148, v149
    v_cvt_pk_bf16_f32 v95, v150, v151
    v_mfma_f32_16x16x32_bf16 v[136:139], v[2:5], v[244:247], 0
    v_mfma_f32_16x16x32_bf16 v[152:155], v[28:31], v[244:247], 0
    ds_read_b128 v[244:247], v205 offset:43008
    v_mfma_f32_16x16x32_bf16 v[136:139], v[8:11], v[248:251], v[136:139]
    v_mfma_f32_16x16x32_bf16 v[152:155], v[34:37], v[248:251], v[152:155]
    ds_read_b128 v[248:251], v205 offset:44032
    s_waitcnt lgkmcnt(5)
    v_mfma_f32_16x16x32_bf16 v[136:139], v[14:17], v[228:231], v[136:139]
    v_mfma_f32_16x16x32_bf16 v[152:155], v[40:43], v[228:231], v[152:155]
    ds_read_b128 v[228:231], v205 offset:45056
    s_waitcnt lgkmcnt(5)
    v_mfma_f32_16x16x32_bf16 v[136:139], v[20:23], v[232:235], v[136:139]
    v_mfma_f32_16x16x32_bf16 v[152:155], v[46:49], v[232:235], v[152:155]
    ds_read_b128 v[232:235], v205 offset:46080
    v_mfma_f32_16x16x32_bf16 v[164:167], v[14:17], v[140:143], v[164:167]
    s_nop 4
    v_cvt_pk_bf16_f32 v58, v136, v137
    v_cvt_pk_bf16_f32 v59, v138, v139
    v_mfma_f32_16x16x32_bf16 v[172:175], v[40:43], v[156:159], v[172:175]
    v_cvt_pk_bf16_f32 v98, v152, v153
    v_cvt_pk_bf16_f32 v99, v154, v155
    s_waitcnt lgkmcnt(5)
    v_mfma_f32_16x16x32_bf16 v[140:143], v[2:5], v[236:239], 0
    v_mfma_f32_16x16x32_bf16 v[156:159], v[28:31], v[236:239], 0
    ds_read_b128 v[236:239], v205 offset:47104
    s_waitcnt lgkmcnt(5)
    v_mfma_f32_16x16x32_bf16 v[140:143], v[8:11], v[240:243], v[140:143]
    v_mfma_f32_16x16x32_bf16 v[156:159], v[34:37], v[240:243], v[156:159]
    ds_read_b128 v[240:243], v205 offset:48128
    s_waitcnt lgkmcnt(5)
    v_mfma_f32_16x16x32_bf16 v[140:143], v[14:17], v[244:247], v[140:143]
SP_32:
    ds_read_b32 v204, v203 offset:4
    s_waitcnt lgkmcnt(0)
    v_readfirstlane_b32 s33, v204
    s_cmp_ge_u32 s33, s38
    s_cbranch_scc1 SP_32_E
    s_sleep 1
    s_branch SP_32
SP_32_E:
    s_add_u32 s32, s32, 32
    s_cmp_lt_u32 s35, 3
    s_cbranch_scc1 K4_PFN
    s_lshl_b32 s32, s2, 1
    s_add_u32 s32, s32, 24576
    s_cmp_ge_u32 s2, 212
    s_cbranch_scc1 K4_NOPF
    s_cmp_lg_u32 s5, 0
    s_cbranch_scc1 K4_NOPF
K4_PFN:
    s_add_u32 s34, s4, 1
    s_mul_i32 s33, s34, 6422528
    s_lshl_b32 s37, s32, 3
    s_add_u32 s33, s33, s37
    s_lshl_b32 s34, s34, 12
    s_add_u32 s34, s34, s7
    v_xor_b32 v227, 64, v215
    s_mov_b32 m0, s34
    s_add_u32 s34, s34, 1024
    buffer_load_dwordx4 v215, s[12:15], s33 offen lds
    s_add_u32 s33, s33, 1605632
    s_mov_b32 m0, s34
    s_add_u32 s34, s34, 1024
    buffer_load_dwordx4 v215, s[12:15], s33 offen lds
    s_add_u32 s33, s33, 1605632
    s_mov_b32 m0, s34
    s_add_u32 s34, s34, 1024
    buffer_load_dwordx4 v215, s[12:15], s33 offen lds
    s_add_u32 s33, s33, 1605632
    s_mov_b32 m0, s34
    s_add_u32 s34, s34, 1024
    buffer_load_dwordx4 v215, s[12:15], s33 offen lds
    s_cmp_eq_u32 s4, 3
    s_cbranch_scc1 PF_33
    s_add_u32 s33, s33, 20873216
    s_add_u32 s34, s34, 12288
    s_mov_b32 m0, s34
    s_add_u32 s34, s34, 1024
    buffer_load_dwordx4 v227, s[12:15], s33 offen lds
    s_add_u32 s33, s33, 1605632
    s_mov_b32 m0, s34
    s_add_u32 s34, s34, 1024
    buffer_load_dwordx4 v227, s[12:15], s33 offen lds
    s_add_u32 s33, s33, 1605632
    s_mov_b32 m0, s34
    s_add_u32 s34, s34, 1024
    buffer_load_dwordx4 v227, s[12:15], s33 offen lds
    s_add_u32 s33, s33, 1605632
    s_mov_b32 m0, s34
    s_add_u32 s34, s34, 1024
    buffer_load_dwordx4 v227, s[12:15], s33 offen lds
PF_33:
    s_lshl_b32 s33, s32, 8
    s_lshl_b32 s34, s32, 1
    buffer_load_dwordx4 v[222:225], v216, s[16:19], s33 offen
    buffer_load_ushort v221, v218, s[20:23], s34 offen
K4_NOPF:
    v_mfma_f32_16x16x32_bf16 v[156:159], v[40:43], v[244:247], v[156:159]
    ds_read_b128 v[244:247], v205 offset:49152
    v_rcp_f32 v204, v199
    s_waitcnt lgkmcnt(5)
    v_mfma_f32_16x16x32_bf16 v[140:143], v[20:23], v[248:251], v[140:143]
    v_mfma_f32_16x16x32_bf16 v[156:159], v[46:49], v[248:251], v[156:159]
    ds_read_b128 v[248:251], v205 offset:50176
    v_mfma_f32_16x16x32_bf16 v[164:167], v[20:23], v[144:147], v[164:167]
    s_nop 4
    v_cvt_pk_bf16_f32 v64, v140, v141
    v_cvt_pk_bf16_f32 v65, v142, v143
    v_mfma_f32_16x16x32_bf16 v[172:175], v[46:49], v[160:163], v[172:175]
    v_cvt_pk_bf16_f32 v104, v156, v157
    v_cvt_pk_bf16_f32 v105, v158, v159
    s_waitcnt lgkmcnt(5)
    v_mfma_f32_16x16x32_bf16 v[144:147], v[2:5], v[228:231], 0
    v_mfma_f32_16x16x32_bf16 v[160:163], v[28:31], v[228:231], 0
    ds_read_b128 v[228:231], v205 offset:51200
    s_nop 1
    v_mov_b32_dpp v164, v172 row_ror:8 row_mask:0x3 bank_mask:0xc
    v_mov_b32_dpp v165, v173 row_ror:8 row_mask:0x3 bank_mask:0xc
    s_waitcnt lgkmcnt(5)
    v_mfma_f32_16x16x32_bf16 v[144:147], v[8:11], v[232:235], v[144:147]
    v_mov_b32_dpp v166, v174 row_ror:8 row_mask:0x3 bank_mask:0xc
    v_mov_b32_dpp v167, v175 row_ror:8 row_mask:0x3 bank_mask:0xc
    v_mfma_f32_16x16x32_bf16 v[160:163], v[34:37], v[232:235], v[160:163]
    ds_read_b128 v[232:235], v205 offset:52224
    v_mov_b32_dpp v164, v172 row_ror:8 row_mask:0xc bank_mask:0x3
    v_mov_b32_dpp v165, v173 row_ror:8 row_mask:0xc bank_mask:0x3
    s_waitcnt lgkmcnt(5)
    v_mfma_f32_16x16x32_bf16 v[144:147], v[14:17], v[236:239], v[144:147]
    v_mov_b32_dpp v166, v174 row_ror:8 row_mask:0xc bank_mask:0x3
    v_mov_b32_dpp v167, v175 row_ror:8 row_mask:0xc bank_mask:0x3
    v_mfma_f32_16x16x32_bf16 v[160:163], v[40:43], v[236:239], v[160:163]
    ds_read_b128 v[236:239], v205 offset:53248
    v_mul_f32 v164, v164, v168
    v_mul_f32 v165, v165, v169
    s_waitcnt lgkmcnt(5)
    v_mfma_f32_16x16x32_bf16 v[144:147], v[20:23], v[240:243], v[144:147]
    v_mul_f32 v166, v166, v170
    v_mul_f32 v167, v167, v171
    v_mfma_f32_16x16x32_bf16 v[160:163], v[46:49], v[240:243], v[160:163]
    ds_read_b128 v[240:243], v205 offset:54272
    v_max3_f32 v201, v164, v165, v166
    v_max_f32 v201, v201, v167
    s_waitcnt lgkmcnt(5)
    v_mfma_f32_16x16x32_bf16 v[132:135], v[2:5], v[244:247], 0
    ds_swizzle_b32 v202, v201 offset:0x401F
    v_mfma_f32_16x16x32_bf16 v[148:151], v[28:31], v[244:247], 0
    ds_read_b128 v[244:247], v205 offset:55296
    v_cvt_pk_bf16_f32 v68, v144, v145
    v_cvt_pk_bf16_f32 v69, v146, v147
    s_waitcnt lgkmcnt(6)
    v_mfma_f32_16x16x32_bf16 v[132:135], v[8:11], v[248:251], v[132:135]
    v_cvt_pk_bf16_f32 v108, v160, v161
    v_cvt_pk_bf16_f32 v109, v162, v163
    v_mfma_f32_16x16x32_bf16 v[148:151], v[34:37], v[248:251], v[148:151]
    ds_read_b128 v[248:251], v205 offset:56320
    s_waitcnt lgkmcnt(6)
    v_mfma_f32_16x16x32_bf16 v[132:135], v[14:17], v[228:231], v[132:135]
    v_mfma_f32_16x16x32_bf16 v[148:151], v[40:43], v[228:231], v[148:151]
    ds_read_b128 v[228:231], v205 offset:57344
    s_waitcnt lgkmcnt(6)
    v_mfma_f32_16x16x32_bf16 v[132:135], v[20:23], v[232:235], v[132:135]
    v_mfma_f32_16x16x32_bf16 v[148:151], v[46:49], v[232:235], v[148:151]
    ds_read_b128 v[232:235], v205 offset:58368
    s_waitcnt lgkmcnt(6)
    v_mfma_f32_16x16x32_bf16 v[136:139], v[2:5], v[236:239], 0
    s_nop 3
    v_cvt_pk_bf16_f32 v74, v132, v133
    v_cvt_pk_bf16_f32 v75, v134, v135
    v_mfma_f32_16x16x32_bf16 v[152:155], v[28:31], v[236:239], 0
    ds_read_b128 v[236:239], v205 offset:59392
    s_waitcnt lgkmcnt(5)
    v_max_f32 v201, v201, v202
    v_cvt_pk_bf16_f32 v114, v148, v149
    v_mfma_f32_16x16x32_bf16 v[136:139], v[8:11], v[240:243], v[136:139]
    v_sub_f32 v164, v164, v201
    v_sub_f32 v165, v165, v201
    v_mfma_f32_16x16x32_bf16 v[152:155], v[34:37], v[240:243], v[152:155]
    ds_read_b128 v[240:243], v205 offset:60416
    v_sub_f32 v166, v166, v201
    v_sub_f32 v167, v167, v201
    s_waitcnt lgkmcnt(5)
    v_mfma_f32_16x16x32_bf16 v[136:139], v[14:17], v[244:247], v[136:139]
    v_exp_f32 v164, v164
    v_mfma_f32_16x16x32_bf16 v[152:155], v[40:43], v[244:247], v[152:155]
    ds_read_b128 v[244:247], v205 offset:61440
    v_exp_f32 v165, v165
    s_waitcnt lgkmcnt(5)
    v_mfma_f32_16x16x32_bf16 v[136:139], v[20:23], v[248:251], v[136:139]
    v_exp_f32 v166, v166
    v_mfma_f32_16x16x32_bf16 v[152:155], v[46:49], v[248:251], v[152:155]
    ds_read_b128 v[248:251], v205 offset:62464
    v_exp_f32 v167, v167
    s_waitcnt lgkmcnt(5)
    v_mfma_f32_16x16x32_bf16 v[140:143], v[2:5], v[228:231], 0
    v_add_f32 v201, v164, v165
    v_add_f32 v202, v166, v167
    v_mfma_f32_16x16x32_bf16 v[156:159], v[28:31], v[228:231], 0
    ds_read_b128 v[228:231], v205 offset:63488
    v_add_f32 v201, v201, v202
    v_cvt_pk_bf16_f32 v115, v150, v151
    ds_swizzle_b32 v202, v201 offset:0x401F
    s_waitcnt lgkmcnt(6)
    v_mfma_f32_16x16x32_bf16 v[140:143], v[8:11], v[232:235], v[140:143]
    v_cvt_pk_bf16_f32 v78, v136, v137
    v_cvt_pk_bf16_f32 v79, v138, v139
    v_mfma_f32_16x16x32_bf16 v[156:159], v[34:37], v[232:235], v[156:159]
    ds_read_b128 v[232:235], v205 offset:64512
    v_cvt_pk_bf16_f32 v118, v152, v153
    v_cvt_pk_bf16_f32 v119, v154, v155
    s_waitcnt lgkmcnt(6)
    v_mfma_f32_16x16x32_bf16 v[140:143], v[14:17], v[236:239], v[140:143]
    v_mfma_f32_16x16x32_bf16 v[156:159], v[40:43], v[236:239], v[156:159]
    s_waitcnt lgkmcnt(4)
    v_mfma_f32_16x16x32_bf16 v[144:147], v[2:5], v[244:247], 0
    v_mfma_f32_16x16x32_bf16 v[160:163], v[28:31], v[244:247], 0
    s_waitcnt lgkmcnt(3)
    v_mfma_f32_16x16x32_bf16 v[144:147], v[8:11], v[248:251], v[144:147]
    v_mfma_f32_16x16x32_bf16 v[160:163], v[34:37], v[248:251], v[160:163]
    s_waitcnt lgkmcnt(2)
    v_mfma_f32_16x16x32_bf16 v[144:147], v[14:17], v[228:231], v[144:147]
    s_waitcnt lgkmcnt(1)
    v_add_f32 v201, v201, v202
    v_rcp_f32 v201, v201
    v_mfma_f32_16x16x32_bf16 v[160:163], v[40:43], v[228:231], v[160:163]
    v_mul_f32 v201, v201, v199
    v_mul_f32 v168, v201, v192
    v_mfma_f32_16x16x32_bf16 v[140:143], v[20:23], v[240:243], v[140:143]
    v_mul_f32 v169, v201, v193
    v_mul_f32 v170, v201, v194
    v_mfma_f32_16x16x32_bf16 v[156:159], v[46:49], v[240:243], v[156:159]
    v_mul_f32 v171, v201, v195
    v_mul_f32 v164, v164, v168
    s_waitcnt lgkmcnt(0)
    v_mfma_f32_16x16x32_bf16 v[144:147], v[20:23], v[232:235], v[144:147]
    v_mul_f32 v165, v165, v169
    v_mul_f32 v166, v166, v170
    v_mfma_f32_16x16x32_bf16 v[160:163], v[46:49], v[232:235], v[160:163]
    v_mul_f32 v167, v167, v171
    v_cvt_pk_bf16_f32 v168, v164, v165
    v_cvt_pk_bf16_f32 v169, v166, v167
    v_and_b32 v0, v168, v214
    v_and_b32 v1, v169, v214
    v_and_b32_dpp v26, v168, v214 row_ror:8 row_mask:0xf bank_mask:0xf
    v_and_b32_dpp v27, v169, v214 row_ror:8 row_mask:0xf bank_mask:0xf
    v_mfma_f32_16x16x32_bf16 v[132:135], v[54:57], v[0:3], 0
    v_mov_b32 v6, v0
    v_mov_b32 v7, v1
    v_mfma_f32_16x16x32_bf16 v[148:151], v[94:97], v[26:29], 0
    v_mov_b32 v32, v26
    v_mov_b32 v33, v27
    v_mfma_f32_16x16x32_bf16 v[136:139], v[56:59], v[4:7], 0
    v_mov_b32 v12, v0
    v_mov_b32 v13, v1
    v_mfma_f32_16x16x32_bf16 v[152:155], v[96:99], v[30:33], 0
    v_mov_b32 v38, v26
    v_mov_b32 v39, v27
    v_mfma_f32_16x16x32_bf16 v[168:171], v[180:183], v[0:3], 0
    v_cvt_pk_bf16_f32 v84, v140, v141
    v_cvt_pk_bf16_f32 v85, v142, v143
    v_mfma_f32_16x16x32_bf16 v[140:143], v[64:67], v[6:9], 0
    v_cvt_pk_bf16_f32 v124, v156, v157
    v_cvt_pk_bf16_f32 v125, v158, v159
    v_mfma_f32_16x16x32_bf16 v[156:159], v[104:107], v[32:35], 0
    v_cvt_pk_bf16_f32 v88, v144, v145
    v_cvt_pk_bf16_f32 v89, v146, v147
    v_mfma_f32_16x16x32_bf16 v[144:147], v[66:69], v[10:13], 0
    v_cvt_pk_bf16_f32 v128, v160, v161
    v_cvt_pk_bf16_f32 v129, v162, v163
    v_mfma_f32_16x16x32_bf16 v[160:163], v[106:109], v[36:39], 0
    v_mov_b32 v18, v0
    v_mov_b32 v19, v1
    v_mfma_f32_16x16x32_bf16 v[176:179], v[184:187], v[26:29], 0
    v_mov_b32 v44, v26
    v_mov_b32 v45, v27
    v_cvt_pk_bf16_f32 v2, v132, v133
    v_cvt_pk_bf16_f32 v3, v134, v135
    v_mfma_f32_16x16x32_bf16 v[132:135], v[74:77], v[12:15], 0
    v_cvt_pk_bf16_f32 v28, v148, v149
    v_cvt_pk_bf16_f32 v29, v150, v151
    v_mfma_f32_16x16x32_bf16 v[148:151], v[114:117], v[38:41], 0
    v_cvt_pk_bf16_f32 v4, v136, v137
    v_cvt_pk_bf16_f32 v5, v138, v139
    v_mfma_f32_16x16x32_bf16 v[136:139], v[76:79], v[16:19], 0
    v_cvt_pk_bf16_f32 v30, v152, v153
    v_cvt_pk_bf16_f32 v31, v154, v155
    v_mfma_f32_16x16x32_bf16 v[152:155], v[116:119], v[42:45], 0
    v_mov_b32 v24, v0
    s_waitcnt vmcnt(0)
    ds_write2st64_b64 v217, v[222:223], v[224:225] offset1:1
    s_waitcnt lgkmcnt(0)
    v_mov_b32 v227, s52
    v_mov_b32 v0, 1
    s_mov_b64 exec, 1
    ds_add_u32 v227, v0 offset:0
    s_mov_b64 exec, -1
    v_mfma_f32_16x16x32_bf16 v[192:195], v[2:5], v[2:5], 0
    v_mov_b32 v25, v1
    v_mov_b32 v50, v26
    v_mfma_f32_16x16x32_bf16 v[172:175], v[28:31], v[28:31], 0
    v_mov_b32 v51, v27
    v_cvt_pk_bf16_f32 v8, v140, v141
    v_cvt_pk_bf16_f32 v9, v142, v143
    v_mfma_f32_16x16x32_bf16 v[140:143], v[84:87], v[18:21], 0
    v_cvt_pk_bf16_f32 v34, v156, v157
    v_cvt_pk_bf16_f32 v35, v158, v159
    v_mfma_f32_16x16x32_bf16 v[156:159], v[124:127], v[44:47], 0
    v_cvt_pk_bf16_f32 v10, v144, v145
    v_cvt_pk_bf16_f32 v11, v146, v147
    v_mfma_f32_16x16x32_bf16 v[144:147], v[86:89], v[22:25], 0
    v_cvt_pk_bf16_f32 v36, v160, v161
    v_cvt_pk_bf16_f32 v37, v162, v163
    v_mfma_f32_16x16x32_bf16 v[160:163], v[126:129], v[48:51], 0
    v_cvt_pk_bf16_f32 v14, v132, v133
    v_cvt_pk_bf16_f32 v15, v134, v135
    v_mfma_f32_16x16x32_bf16 v[192:195], v[8:11], v[8:11], v[192:195]
    v_cvt_pk_bf16_f32 v40, v148, v149
    v_cvt_pk_bf16_f32 v41, v150, v151
    v_mfma_f32_16x16x32_bf16 v[172:175], v[34:37], v[34:37], v[172:175]
    v_cvt_pk_bf16_f32 v16, v136, v137
    v_cvt_pk_bf16_f32 v17, v138, v139
    v_cvt_pk_bf16_f32 v42, v152, v153
    v_cvt_pk_bf16_f32 v43, v154, v155
    v_mfma_f32_16x16x32_bf16 v[192:195], v[14:17], v[14:17], v[192:195]
    v_cvt_pk_bf16_f32 v20, v140, v141
    v_cvt_pk_bf16_f32 v21, v142, v143
    v_mfma_f32_16x16x32_bf16 v[172:175], v[40:43], v[40:43], v[172:175]
    v_cvt_pk_bf16_f32 v46, v156, v157
    v_cvt_pk_bf16_f32 v47, v158, v159
    v_cvt_pk_bf16_f32 v22, v144, v145
    v_cvt_pk_bf16_f32 v23, v146, v147
    v_cvt_pk_bf16_f32 v48, v160, v161
    v_cvt_pk_bf16_f32 v49, v162, v163
    v_mfma_f32_16x16x32_bf16 v[192:195], v[20:23], v[20:23], v[192:195]
    v_add_f32 v201, v170, v196
    v_add_f32 v202, v171, v197
    v_mfma_f32_16x16x32_bf16 v[172:175], v[46:49], v[46:49], v[172:175]
    v_add_f32_dpp v201, v178, v196 row_ror:8 row_mask:0x3 bank_mask:0xc
    v_add_f32_dpp v202, v179, v197 row_ror:8 row_mask:0x3 bank_mask:0xc
    v_add_f32_dpp v201, v178, v196 row_ror:8 row_mask:0xc bank_mask:0x3
    s_nop 1
    v_cndmask_b32 v192, v192, v193, s[44:45]
    v_cndmask_b32 v194, v194, v195, s[44:45]
    v_mul_f32 v201, s48, v201
    v_cndmask_b32 v192, v192, v194, s[46:47]
    v_cndmask_b32 v172, v172, v173, s[44:45]
    ds_bpermute_b32 v188, v220, v192
    v_cndmask_b32 v174, v174, v175, s[44:45]
    v_fma_f32 v203, -v201, v201, v200
    v_cndmask_b32 v172, v172, v174, s[46:47]
    v_add_f32_dpp v202, v179, v197 row_ror:8 row_mask:0xc bank_mask:0x3
    ds_bpermute_b32 v189, v220, v172
    v_fma_f32 v202, -v201, s51, v202
    v_and_b32 v201, 0x80000000, v199
    v_mul_f32 v202, s50, v202
    v_xor_b32 v202, v202, v201
    s_waitcnt lgkmcnt(0)
    v_mov_b32_dpp v188, v189 row_ror:8 row_mask:0x3 bank_mask:0xc
    v_mov_b32_dpp v188, v189 row_ror:8 row_mask:0xc bank_mask:0x3
    v_fmac_f32 v203, s48, v188
    v_max_f32 v203, v203, v200
    v_rsq_f32 v203, v203
    s_nop 0
    v_mul_f32 v202, v202, v203
    s_nop 1
    v_max_f32_dpp v203, v202, v202 quad_perm:[1,0,3,2] row_mask:0xf bank_mask:0xf
    s_nop 1
    v_max_f32_dpp v203, v203, v203 quad_perm:[2,3,0,1] row_mask:0xf bank_mask:0xf
    s_nop 1
    v_max_f32_dpp v203, v203, v203 row_half_mirror row_mask:0xf bank_mask:0xf
    v_sub_f32 v202, v202, v203
    v_exp_f32 v202, v202
    s_nop 1
    v_add_f32_dpp v203, v202, v202 quad_perm:[1,0,3,2] row_mask:0xf bank_mask:0xf
    v_mul_f32 v202, v202, v204
    s_nop 0
    v_add_f32_dpp v203, v203, v203 quad_perm:[2,3,0,1] row_mask:0xf bank_mask:0xf
    s_nop 1
    v_add_f32_dpp v203, v203, v203 row_half_mirror row_mask:0xf bank_mask:0xf
    v_rcp_f32 v203, v203
    s_nop 0
    v_mul_f32 v202, v202, v203
    v_mul_f32 v164, v164, v202
    v_mul_f32 v165, v165, v202
    v_mov_b32_dpp v203, v202 quad_perm:[1,0,3,2] row_mask:0xf bank_mask:0xf
    v_mul_f32 v166, v166, v202
    v_cvt_pk_bf16_f32 v203, v202, v203
    v_mul_f32 v167, v167, v202
    ds_bpermute_b32 v144, v211, v203
    ds_bpermute_b32 v145, v211, v203 offset:8
    ds_bpermute_b32 v160, v226, v203
    ds_bpermute_b32 v161, v226, v203 offset:8
    v_add_f32_dpp v164, v164, v164 quad_perm:[1,0,3,2] row_mask:0xf bank_mask:0xf
    v_add_f32_dpp v165, v165, v165 quad_perm:[1,0,3,2] row_mask:0xf bank_mask:0xf
    v_add_f32_dpp v166, v166, v166 quad_perm:[1,0,3,2] row_mask:0xf bank_mask:0xf
    v_add_f32_dpp v167, v167, v167 quad_perm:[1,0,3,2] row_mask:0xf bank_mask:0xf
    v_add_f32_dpp v164, v164, v164 quad_perm:[2,3,0,1] row_mask:0xf bank_mask:0xf
    v_add_f32_dpp v165, v165, v165 quad_perm:[2,3,0,1] row_mask:0xf bank_mask:0xf
    v_add_f32_dpp v166, v166, v166 quad_perm:[2,3,0,1] row_mask:0xf bank_mask:0xf
    v_add_f32_dpp v167, v167, v167 quad_perm:[2,3,0,1] row_mask:0xf bank_mask:0xf
    v_add_f32_dpp v164, v164, v164 row_half_mirror row_mask:0xf bank_mask:0xf
    v_add_f32_dpp v165, v165, v165 row_half_mirror row_mask:0xf bank_mask:0xf
    v_add_f32_dpp v166, v166, v166 row_half_mirror row_mask:0xf bank_mask:0xf
    v_add_f32_dpp v167, v167, v167 row_half_mirror row_mask:0xf bank_mask:0xf
    v_cvt_pk_bf16_f32 v164, v164, v165
    v_cvt_pk_bf16_f32 v165, v166, v167
    v_and_b32 v142, v164, v214
    v_and_b32 v143, v165, v214
    v_and_b32_dpp v158, v164, v214 row_ror:8 row_mask:0xf bank_mask:0xf
    v_and_b32_dpp v159, v165, v214 row_ror:8 row_mask:0xf bank_mask:0xf
    s_waitcnt lgkmcnt(3)
    v_and_b32 v140, v144, v214
    v_and_b32 v144, v144, v214
    s_waitcnt lgkmcnt(2)
    v_and_b32 v141, v145, v214
    v_and_b32 v145, v145, v214
    s_waitcnt lgkmcnt(1)
    v_and_b32 v156, v160, v214
    v_mfma_f32_16x16x32_bf16 v[132:135], v[52:55], v[140:143], 0
    s_waitcnt lgkmcnt(0)
    v_and_b32 v157, v161, v214
    v_and_b32 v160, v160, v214
    v_mfma_f32_16x16x32_bf16 v[136:139], v[58:61], v[142:145], 0
    v_and_b32 v161, v161, v214
    v_mfma_f32_16x16x32_bf16 v[148:151], v[92:95], v[156:159], 0
    s_nop 1
    v_cvt_pk_bf16_f32 v2, v132, v133
    v_cvt_pk_bf16_f32 v3, v134, v135
    v_mfma_f32_16x16x32_bf16 v[152:155], v[98:101], v[158:161], 0
    s_nop 0
    v_cvt_pk_bf16_f32 v4, v136, v137
    v_cvt_pk_bf16_f32 v5, v138, v139
    v_mfma_f32_16x16x32_bf16 v[164:167], v[62:65], v[140:143], 0
    buffer_store_dwordx4 v[2:5], v219, s[24:27], s36 offen offset:0 sc1
    v_cvt_pk_bf16_f32 v28, v148, v149
    v_cvt_pk_bf16_f32 v29, v150, v151
    v_mfma_f32_16x16x32_bf16 v[172:175], v[102:105], v[156:159], 0
    v_cvt_pk_bf16_f32 v30, v152, v153
    v_cvt_pk_bf16_f32 v31, v154, v155
    v_mfma_f32_16x16x32_bf16 v[168:171], v[68:71], v[142:145], 0
    buffer_store_dwordx4 v[28:31], v219, s[24:27], s36 offen offset:512 sc1
    v_cvt_pk_bf16_f32 v8, v164, v165
    v_cvt_pk_bf16_f32 v9, v166, v167
    v_mfma_f32_16x16x32_bf16 v[176:179], v[108:111], v[158:161], 0
    s_nop 0
    v_cvt_pk_bf16_f32 v34, v172, v173
    v_cvt_pk_bf16_f32 v35, v174, v175
    v_mfma_f32_16x16x32_bf16 v[132:135], v[72:75], v[140:143], 0
    v_cvt_pk_bf16_f32 v10, v168, v169
    v_cvt_pk_bf16_f32 v11, v170, v171
    v_mfma_f32_16x16x32_bf16 v[148:151], v[112:115], v[156:159], 0
    buffer_store_dwordx4 v[8:11], v219, s[24:27], s36 offen offset:64 sc1
    v_cvt_pk_bf16_f32 v36, v176, v177
    v_cvt_pk_bf16_f32 v37, v178, v179
    v_mfma_f32_16x16x32_bf16 v[136:139], v[78:81], v[142:145], 0
    buffer_store_dwordx4 v[34:37], v219, s[24:27], s36 offen offset:576 sc1
    v_cvt_pk_bf16_f32 v14, v132, v133
    v_cvt_pk_bf16_f32 v15, v134, v135
    v_mfma_f32_16x16x32_bf16 v[152:155], v[118:121], v[158:161], 0
    v_cvt_pk_bf16_f32 v40, v148, v149
    v_cvt_pk_bf16_f32 v41, v150, v151
    v_mfma_f32_16x16x32_bf16 v[164:167], v[82:85], v[140:143], 0
    s_nop 0
    v_cvt_pk_bf16_f32 v16, v136, v137
    v_cvt_pk_bf16_f32 v17, v138, v139
    v_mfma_f32_16x16x32_bf16 v[172:175], v[122:125], v[156:159], 0
    buffer_store_dwordx4 v[14:17], v219, s[24:27], s36 offen offset:128 sc1
    v_cvt_pk_bf16_f32 v42, v152, v153
    v_cvt_pk_bf16_f32 v43, v154, v155
    v_mfma_f32_16x16x32_bf16 v[168:171], v[88:91], v[142:145], 0
    buffer_store_dwordx4 v[40:43], v219, s[24:27], s36 offen offset:640 sc1
    v_cvt_pk_bf16_f32 v20, v164, v165
    v_cvt_pk_bf16_f32 v21, v166, v167
    v_mfma_f32_16x16x32_bf16 v[176:179], v[128:131], v[158:161], 0
    v_cvt_pk_bf16_f32 v46, v172, v173
    v_cvt_pk_bf16_f32 v47, v174, v175
    s_nop 1
    v_cvt_pk_bf16_f32 v22, v168, v169
    v_cvt_pk_bf16_f32 v23, v170, v171
    buffer_store_dwordx4 v[20:23], v219, s[24:27], s36 offen offset:192 sc1
    s_nop 0
    v_cvt_pk_bf16_f32 v48, v176, v177
    v_cvt_pk_bf16_f32 v49, v178, v179
    buffer_store_dwordx4 v[46:49], v219, s[24:27], s36 offen offset:704 sc1
    s_cmp_lt_u32 s35, 3
    s_cbranch_scc1 K4_LOOP
    s_cmp_ge_u32 s2, 212
    s_cbranch_scc1 K4_END
    s_cmp_lg_u32 s5, 0
    s_cbranch_scc1 K4_END
    s_setprio 2
    v_mov_b32 v203, s52
    v_lshlrev_b32 v199, 16, v221
    s_add_u32 s35, s35, 1
    v_cmp_eq_f32 vcc, 0, v199
    s_lshl_b32 s38, s35, 2
    s_lshl_b32 s36, s32, 8
    v_cndmask_b32 v199, v199, 1.0, vcc
SP_34:
    ds_read_b32 v204, v203 offset:0
    s_waitcnt lgkmcnt(0)
    v_readfirstlane_b32 s33, v204
    s_cmp_ge_u32 s33, s38
    s_cbranch_scc1 SP_34_E
    s_sleep 1
    s_branch SP_34
SP_34_E:
    s_cmp_lg_u32 s3, 0
    s_cbranch_scc1 K4_END
    ds_read_b64 v[2:3], v207 offset:0
    ds_read_b64 v[4:5], v207 offset:512
    ds_read_b128 v[228:231], v206 offset:0
    ds_read_b64 v[8:9], v207 offset:1024
    ds_read_b64 v[10:11], v207 offset:1536
    ds_read_b128 v[232:235], v206 offset:1024
    ds_read_b64 v[14:15], v207 offset:2048
    ds_read_b64 v[16:17], v207 offset:2560
    ds_read_b64 v[20:21], v207 offset:3072
    ds_read_b64 v[22:23], v207 offset:3584
    ds_read_b128 v[236:239], v206 offset:2048
    ds_read_b128 v[240:243], v206 offset:3072
    ds_read_b128 v[244:247], v205 offset:0
    ds_read_b128 v[248:251], v205 offset:1024
    v_mul_f32 v200, v199, v199
    v_rcp_f32 v204, v199
    v_mul_f32 v200, s49, v200
    s_waitcnt lgkmcnt(12)
    v_mfma_f32_16x16x32_bf16 v[164:167], v[2:5], v[2:5], 0
    s_waitcnt lgkmcnt(11)
    v_mfma_f32_16x16x32_bf16 v[168:171], v[2:5], v[228:231], 0
    ds_read_b128 v[228:231], v205 offset:2048
    s_waitcnt lgkmcnt(9)
    v_mfma_f32_16x16x32_bf16 v[168:171], v[8:11], v[232:235], v[168:171]
    ds_read_b128 v[232:235], v205 offset:3072
    v_mfma_f32_16x16x32_bf16 v[164:167], v[8:11], v[8:11], v[164:167]
    s_waitcnt lgkmcnt(8)
    v_mfma_f32_16x16x32_bf16 v[164:167], v[14:17], v[14:17], v[164:167]
    s_waitcnt lgkmcnt(6)
    v_mfma_f32_16x16x32_bf16 v[164:167], v[20:23], v[20:23], v[164:167]
    s_waitcnt lgkmcnt(5)
    v_mfma_f32_16x16x32_bf16 v[168:171], v[14:17], v[236:239], v[168:171]
    ds_read_b128 v[236:239], v205 offset:4096
    s_waitcnt lgkmcnt(5)
    v_mfma_f32_16x16x32_bf16 v[168:171], v[20:23], v[240:243], v[168:171]
    ds_read_b128 v[240:243], v205 offset:5120
    s_nop 1
    v_cndmask_b32 v164, v164, v165, s[44:45]
    v_cndmask_b32 v166, v166, v167, s[44:45]
    v_cndmask_b32 v164, v164, v166, s[46:47]
    ds_bpermute_b32 v188, v220, v164
    s_waitcnt lgkmcnt(6)
    v_mfma_f32_16x16x32_bf16 v[164:167], v[244:247], v[2:5], 0
    ds_read_b128 v[244:247], v205 offset:6144
    v_cvt_pk_bf16_f32 v180, v168, v169
    v_mov_b32_dpp v168, v169 quad_perm:[0,1,2,3] row_mask:0xf bank_mask:0x2
    s_waitcnt lgkmcnt(6)
    v_mfma_f32_16x16x32_bf16 v[164:167], v[248:251], v[8:11], v[164:167]
    ds_read_b128 v[248:251], v205 offset:7168
    ds_read_b64_tr_b16 v[52:53], v209 offset:0
    v_mov_b32_dpp v168, v170 quad_perm:[0,1,2,3] row_mask:0xf bank_mask:0x4
    v_cvt_pk_bf16_f32 v181, v170, v171
    s_waitcnt lgkmcnt(7)
    v_mfma_f32_16x16x32_bf16 v[164:167], v[228:231], v[14:17], v[164:167]
    ds_read_b128 v[228:231], v205 offset:8192
    v_mov_b32_dpp v168, v171 quad_perm:[0,1,2,3] row_mask:0xf bank_mask:0x8
    ds_bpermute_b32 v196, v213, v168
    ds_bpermute_b32 v197, v213, v168 offset:4
    s_waitcnt lgkmcnt(9)
    v_mfma_f32_16x16x32_bf16 v[164:167], v[232:235], v[20:23], v[164:167]
    ds_read_b128 v[232:235], v205 offset:9216
    ds_read_b64_tr_b16 v[60:61], v209 offset:512
    s_waitcnt lgkmcnt(10)
    v_mfma_f32_16x16x32_bf16 v[168:171], v[236:239], v[2:5], 0
    ds_read_b128 v[236:239], v205 offset:10240
    s_nop 2
    v_cvt_pk_bf16_f32 v132, v164, v165
    v_cvt_pk_bf16_f32 v133, v166, v167
    s_waitcnt lgkmcnt(10)
    v_mfma_f32_16x16x32_bf16 v[168:171], v[240:243], v[8:11], v[168:171]
    ds_read_b128 v[240:243], v205 offset:11264
    ds_read_b64_tr_b16 v[62:63], v209 offset:1024
    s_waitcnt lgkmcnt(10)
    v_mfma_f32_16x16x32_bf16 v[168:171], v[244:247], v[14:17], v[168:171]
    ds_read_b128 v[244:247], v205 offset:12288
    s_waitcnt lgkmcnt(10)
    v_mfma_f32_16x16x32_bf16 v[168:171], v[248:251], v[20:23], v[168:171]
    ds_read_b128 v[248:251], v205 offset:13312
    ds_read_b64_tr_b16 v[70:71], v209 offset:1536
    s_waitcnt lgkmcnt(10)
    v_mfma_f32_16x16x32_bf16 v[164:167], v[228:231], v[2:5], 0
    ds_read_b128 v[228:231], v205 offset:14336
    s_waitcnt lgkmcnt(10)
    v_mul_f32 v201, s48, v196
    v_fma_f32 v202, -v201, v201, v200
    v_and_b32 v201, 0x80000000, v199
    v_cvt_pk_bf16_f32 v134, v168, v169
    v_cvt_pk_bf16_f32 v135, v170, v171
    s_waitcnt lgkmcnt(8)
    v_mfma_f32_16x16x32_bf16 v[164:167], v[232:235], v[8:11], v[164:167]
    ds_read_b128 v[232:235], v205 offset:15360
    ds_read_b64_tr_b16 v[72:73], v209 offset:2048
    v_fmac_f32 v202, s48, v188
    v_max_f32 v202, v202, v200
    v_rsq_f32 v202, v202
    s_waitcnt lgkmcnt(8)
    v_mfma_f32_16x16x32_bf16 v[164:167], v[236:239], v[14:17], v[164:167]
    ds_read_b128 v[236:239], v205 offset:16384
    v_or_b32 v198, v202, v201
    ds_bpermute_b32 v192, v212, v198
    ds_bpermute_b32 v193, v212, v198 offset:4
    ds_bpermute_b32 v194, v212, v198 offset:8
    ds_bpermute_b32 v195, v212, v198 offset:12
    s_waitcnt lgkmcnt(12)
    v_mfma_f32_16x16x32_bf16 v[164:167], v[240:243], v[20:23], v[164:167]
    ds_read_b128 v[240:243], v205 offset:17408
    ds_read_b64_tr_b16 v[80:81], v209 offset:2560
    s_waitcnt lgkmcnt(12)
    v_mfma_f32_16x16x32_bf16 v[168:171], v[244:247], v[2:5], 0
    ds_read_b128 v[244:247], v205 offset:18432
    s_waitcnt lgkmcnt(12)
    v_mfma_f32_16x16x32_bf16 v[168:171], v[248:251], v[8:11], v[168:171]
    ds_read_b128 v[248:251], v205 offset:19456
    ds_read_b64_tr_b16 v[82:83], v209 offset:3072
    v_cvt_pk_bf16_f32 v136, v164, v165
    v_cvt_pk_bf16_f32 v137, v166, v167
    s_waitcnt lgkmcnt(12)
    v_mfma_f32_16x16x32_bf16 v[168:171], v[228:231], v[14:17], v[168:171]
    ds_read_b128 v[228:231], v205 offset:20480
    s_waitcnt lgkmcnt(12)
    v_mfma_f32_16x16x32_bf16 v[168:171], v[232:235], v[20:23], v[168:171]
    ds_read_b128 v[232:235], v205 offset:21504
    ds_read_b64_tr_b16 v[90:91], v209 offset:3584
    s_waitcnt lgkmcnt(12)
    v_mfma_f32_16x16x32_bf16 v[164:167], v[236:239], v[2:5], 0
    ds_read_b128 v[236:239], v205 offset:22528
    s_nop 2
    v_cvt_pk_bf16_f32 v138, v168, v169
    v_cvt_pk_bf16_f32 v139, v170, v171
    s_waitcnt lgkmcnt(8)
    v_mfma_f32_16x16x32_bf16 v[164:167], v[240:243], v[8:11], v[164:167]
    ds_read_b128 v[240:243], v205 offset:23552
    s_waitcnt lgkmcnt(7)
    v_mfma_f32_16x16x32_bf16 v[164:167], v[244:247], v[14:17], v[164:167]
    ds_read_b128 v[244:247], v205 offset:24576
    s_waitcnt lgkmcnt(7)
    v_mfma_f32_16x16x32_bf16 v[164:167], v[248:251], v[20:23], v[164:167]
    ds_read_b128 v[248:251], v205 offset:25600
    s_waitcnt lgkmcnt(6)
    v_mfma_f32_16x16x32_bf16 v[168:171], v[228:231], v[2:5], 0
    ds_read_b128 v[228:231], v205 offset:26624
    s_waitcnt lgkmcnt(6)
    v_mfma_f32_16x16x32_bf16 v[168:171], v[232:235], v[8:11], v[168:171]
    ds_read_b128 v[232:235], v205 offset:27648
    s_nop 0
    v_cvt_pk_bf16_f32 v140, v164, v165
    v_cvt_pk_bf16_f32 v141, v166, v167
    s_waitcnt lgkmcnt(5)
    v_mfma_f32_16x16x32_bf16 v[168:171], v[236:239], v[14:17], v[168:171]
    ds_read_b128 v[236:239], v205 offset:28672
    s_waitcnt lgkmcnt(5)
    v_mfma_f32_16x16x32_bf16 v[168:171], v[240:243], v[20:23], v[168:171]
    ds_read_b128 v[240:243], v205 offset:29696
    s_waitcnt lgkmcnt(5)
    v_mfma_f32_16x16x32_bf16 v[164:167], v[244:247], v[2:5], 0
    ds_read_b128 v[244:247], v205 offset:30720
    s_waitcnt lgkmcnt(5)
    v_mfma_f32_16x16x32_bf16 v[164:167], v[248:251], v[8:11], v[164:167]
    ds_read_b128 v[248:251], v205 offset:31744
    s_nop 0
    v_cvt_pk_bf16_f32 v142, v168, v169
    v_cvt_pk_bf16_f32 v143, v170, v171
    s_waitcnt lgkmcnt(5)
    v_mfma_f32_16x16x32_bf16 v[164:167], v[228:231], v[14:17], v[164:167]
    ds_read_b128 v[228:231], v205 offset:32768
    s_waitcnt lgkmcnt(5)
    v_mfma_f32_16x16x32_bf16 v[164:167], v[232:235], v[20:23], v[164:167]
    ds_read_b128 v[232:235], v205 offset:33792
    s_waitcnt lgkmcnt(5)
    v_mfma_f32_16x16x32_bf16 v[168:171], v[236:239], v[2:5], 0
    ds_read_b128 v[236:239], v205 offset:34816
    s_nop 3
    v_cvt_pk_bf16_f32 v144, v164, v165
    v_cvt_pk_bf16_f32 v145, v166, v167
    v_mfma_f32_16x16x32_bf16 v[164:167], v[2:5], v[132:135], 0
    v_mfma_f32_16x16x32_bf16 v[164:167], v[8:11], v[136:139], v[164:167]
    s_waitcnt lgkmcnt(5)
    v_mfma_f32_16x16x32_bf16 v[168:171], v[240:243], v[8:11], v[168:171]
    ds_read_b128 v[240:243], v205 offset:35840
    s_waitcnt lgkmcnt(5)
    v_mfma_f32_16x16x32_bf16 v[168:171], v[244:247], v[14:17], v[168:171]
    ds_read_b128 v[244:247], v205 offset:36864
    s_waitcnt lgkmcnt(5)
    v_mfma_f32_16x16x32_bf16 v[168:171], v[248:251], v[20:23], v[168:171]
    ds_read_b128 v[248:251], v205 offset:37888
    s_waitcnt lgkmcnt(5)
    v_mfma_f32_16x16x32_bf16 v[132:135], v[2:5], v[228:231], 0
    ds_read_b128 v[228:231], v205 offset:38912
    v_mfma_f32_16x16x32_bf16 v[164:167], v[14:17], v[140:143], v[164:167]
    s_nop 2
    v_cvt_pk_bf16_f32 v146, v168, v169
    v_cvt_pk_bf16_f32 v147, v170, v171
    s_waitcnt lgkmcnt(5)
    v_mfma_f32_16x16x32_bf16 v[132:135], v[8:11], v[232:235], v[132:135]
    ds_read_b128 v[232:235], v205 offset:39936
    v_mul_f32 v168, v198, v192
    v_mul_f32 v169, v198, v193
    v_mfma_f32_16x16x32_bf16 v[164:167], v[20:23], v[144:147], v[164:167]
    v_mul_f32 v170, v198, v194
    v_mul_f32 v171, v198, v195
    s_waitcnt lgkmcnt(5)
    v_mfma_f32_16x16x32_bf16 v[132:135], v[14:17], v[236:239], v[132:135]
    ds_read_b128 v[236:239], v205 offset:40960
    s_nop 2
    v_mul_f32 v164, v164, v168
    v_mul_f32 v165, v165, v169
    v_mul_f32 v166, v166, v170
    s_waitcnt lgkmcnt(5)
    v_mfma_f32_16x16x32_bf16 v[132:135], v[20:23], v[240:243], v[132:135]
    ds_read_b128 v[240:243], v205 offset:41984
    v_mul_f32 v167, v167, v171
    v_max3_f32 v201, v164, v165, v166
    s_waitcnt lgkmcnt(5)
    v_mfma_f32_16x16x32_bf16 v[136:139], v[2:5], v[244:247], 0
    ds_read_b128 v[244:247], v205 offset:43008
    v_max_f32 v201, v201, v167
    ds_swizzle_b32 v202, v201 offset:0x401F
    s_waitcnt lgkmcnt(6)
    v_mfma_f32_16x16x32_bf16 v[136:139], v[8:11], v[248:251], v[136:139]
    ds_read_b128 v[248:251], v205 offset:44032
    v_cvt_pk_bf16_f32 v54, v132, v133
    v_cvt_pk_bf16_f32 v55, v134, v135
    s_waitcnt lgkmcnt(6)
    v_mfma_f32_16x16x32_bf16 v[136:139], v[14:17], v[228:231], v[136:139]
    ds_read_b128 v[228:231], v205 offset:45056
    s_waitcnt lgkmcnt(6)
    v_mfma_f32_16x16x32_bf16 v[136:139], v[20:23], v[232:235], v[136:139]
    ds_read_b128 v[232:235], v205 offset:46080
    s_waitcnt lgkmcnt(6)
    v_mfma_f32_16x16x32_bf16 v[140:143], v[2:5], v[236:239], 0
    ds_read_b128 v[236:239], v205 offset:47104
    s_nop 3
    v_cvt_pk_bf16_f32 v58, v136, v137
    v_cvt_pk_bf16_f32 v59, v138, v139
    s_waitcnt lgkmcnt(6)
    v_mfma_f32_16x16x32_bf16 v[140:143], v[8:11], v[240:243], v[140:143]
    ds_read_b128 v[240:243], v205 offset:48128
    s_waitcnt lgkmcnt(6)
    v_mfma_f32_16x16x32_bf16 v[140:143], v[14:17], v[244:247], v[140:143]
    ds_read_b128 v[244:247], v205 offset:49152
    s_waitcnt lgkmcnt(6)
    v_max_f32 v201, v201, v202
    v_sub_f32 v164, v164, v201
    v_sub_f32 v165, v165, v201
    s_waitcnt lgkmcnt(5)
    v_mfma_f32_16x16x32_bf16 v[140:143], v[20:23], v[248:251], v[140:143]
    ds_read_b128 v[248:251], v205 offset:50176
    v_sub_f32 v166, v166, v201
    v_sub_f32 v167, v167, v201
    s_waitcnt lgkmcnt(5)
    v_mfma_f32_16x16x32_bf16 v[144:147], v[2:5], v[228:231], 0
    ds_read_b128 v[228:231], v205 offset:51200
    v_exp_f32 v164, v164
    v_exp_f32 v165, v165
    s_waitcnt lgkmcnt(5)
    v_mfma_f32_16x16x32_bf16 v[144:147], v[8:11], v[232:235], v[144:147]
    ds_read_b128 v[232:235], v205 offset:52224
    v_exp_f32 v166, v166
    v_exp_f32 v167, v167
    v_add_f32 v201, v164, v165
    v_add_f32 v202, v166, v167
    s_waitcnt lgkmcnt(5)
    v_mfma_f32_16x16x32_bf16 v[144:147], v[14:17], v[236:239], v[144:147]
    ds_read_b128 v[236:239], v205 offset:53248
    v_add_f32 v201, v201, v202
    v_cvt_pk_bf16_f32 v64, v140, v141
    ds_swizzle_b32 v202, v201 offset:0x401F
    v_cvt_pk_bf16_f32 v65, v142, v143
    s_waitcnt lgkmcnt(6)
    v_mfma_f32_16x16x32_bf16 v[144:147], v[20:23], v[240:243], v[144:147]
    ds_read_b128 v[240:243], v205 offset:54272
    s_waitcnt lgkmcnt(6)
    v_mfma_f32_16x16x32_bf16 v[132:135], v[2:5], v[244:247], 0
    ds_read_b128 v[244:247], v205 offset:55296
    s_waitcnt lgkmcnt(6)
    v_mfma_f32_16x16x32_bf16 v[132:135], v[8:11], v[248:251], v[132:135]
    ds_read_b128 v[248:251], v205 offset:56320
    s_nop 0
    v_cvt_pk_bf16_f32 v68, v144, v145
    v_cvt_pk_bf16_f32 v69, v146, v147
    s_waitcnt lgkmcnt(6)
    v_mfma_f32_16x16x32_bf16 v[132:135], v[14:17], v[228:231], v[132:135]
    ds_read_b128 v[228:231], v205 offset:57344
    s_waitcnt lgkmcnt(6)
    v_mfma_f32_16x16x32_bf16 v[132:135], v[20:23], v[232:235], v[132:135]
    ds_read_b128 v[232:235], v205 offset:58368
    s_waitcnt lgkmcnt(6)
    v_mfma_f32_16x16x32_bf16 v[136:139], v[2:5], v[236:239], 0
    ds_read_b128 v[236:239], v205 offset:59392
    s_waitcnt lgkmcnt(6)
    v_add_f32 v201, v201, v202
    s_nop 1
    v_cvt_pk_bf16_f32 v74, v132, v133
    v_rcp_f32 v201, v201
    v_cvt_pk_bf16_f32 v75, v134, v135
    v_mul_f32 v201, v201, v199
    s_waitcnt lgkmcnt(5)
    v_mfma_f32_16x16x32_bf16 v[136:139], v[8:11], v[240:243], v[136:139]
    ds_read_b128 v[240:243], v205 offset:60416
    v_mul_f32 v168, v201, v192
    v_mul_f32 v169, v201, v193
    s_waitcnt lgkmcnt(5)
    v_mfma_f32_16x16x32_bf16 v[136:139], v[14:17], v[244:247], v[136:139]
    ds_read_b128 v[244:247], v205 offset:61440
    v_mul_f32 v170, v201, v194
    v_mul_f32 v171, v201, v195
    v_mul_f32 v164, v164, v168
    v_mul_f32 v165, v165, v169
    s_waitcnt lgkmcnt(5)
    v_mfma_f32_16x16x32_bf16 v[136:139], v[20:23], v[248:251], v[136:139]
    ds_read_b128 v[248:251], v205 offset:62464
    v_mul_f32 v166, v166, v170
    v_mul_f32 v167, v167, v171
    s_waitcnt lgkmcnt(5)
    v_mfma_f32_16x16x32_bf16 v[140:143], v[2:5], v[228:231], 0
    ds_read_b128 v[228:231], v205 offset:63488
    v_cvt_pk_bf16_f32 v168, v164, v165
    v_cvt_pk_bf16_f32 v169, v166, v167
    v_and_b32 v0, v168, v214
    v_and_b32 v1, v169, v214
    s_waitcnt lgkmcnt(5)
    v_mfma_f32_16x16x32_bf16 v[140:143], v[8:11], v[232:235], v[140:143]
    ds_read_b128 v[232:235], v205 offset:64512
    v_mov_b32 v6, v0
    v_mov_b32 v7, v1
    v_mfma_f32_16x16x32_bf16 v[132:135], v[54:57], v[0:3], 0
    v_cvt_pk_bf16_f32 v78, v136, v137
    v_cvt_pk_bf16_f32 v79, v138, v139
    s_waitcnt lgkmcnt(5)
    v_mfma_f32_16x16x32_bf16 v[140:143], v[14:17], v[236:239], v[140:143]
    v_mov_b32 v12, v0
    v_mov_b32 v13, v1
    v_mfma_f32_16x16x32_bf16 v[136:139], v[56:59], v[4:7], 0
    v_mov_b32 v18, v0
    v_mov_b32 v19, v1
    s_waitcnt lgkmcnt(4)
    v_mfma_f32_16x16x32_bf16 v[140:143], v[20:23], v[240:243], v[140:143]
    v_mov_b32 v24, v0
    v_mov_b32 v25, v1
    s_waitcnt lgkmcnt(3)
    v_mfma_f32_16x16x32_bf16 v[144:147], v[2:5], v[244:247], 0
    v_cvt_pk_bf16_f32 v4, v136, v137
    v_cvt_pk_bf16_f32 v5, v138, v139
    v_mfma_f32_16x16x32_bf16 v[168:171], v[180:183], v[0:3], 0
    s_nop 0
    v_cvt_pk_bf16_f32 v84, v140, v141
    v_cvt_pk_bf16_f32 v85, v142, v143
    s_waitcnt lgkmcnt(2)
    v_mfma_f32_16x16x32_bf16 v[144:147], v[8:11], v[248:251], v[144:147]
    v_cvt_pk_bf16_f32 v2, v132, v133
    v_cvt_pk_bf16_f32 v3, v134, v135
    s_waitcnt lgkmcnt(1)
    v_mfma_f32_16x16x32_bf16 v[144:147], v[14:17], v[228:231], v[144:147]
    v_add_f32 v201, v170, v196
    v_add_f32 v202, v171, v197
    v_mfma_f32_16x16x32_bf16 v[140:143], v[64:67], v[6:9], 0
    v_mul_f32 v201, s48, v201
    v_fma_f32 v203, -v201, v201, v200
    s_waitcnt lgkmcnt(0)
    v_mfma_f32_16x16x32_bf16 v[144:147], v[20:23], v[232:235], v[144:147]
    v_fma_f32 v202, -v201, s51, v202
    v_and_b32 v201, 0x80000000, v199
    v_mfma_f32_16x16x32_bf16 v[132:135], v[74:77], v[12:15], 0
    s_nop 0
    v_cvt_pk_bf16_f32 v8, v140, v141
    v_cvt_pk_bf16_f32 v9, v142, v143
    v_mfma_f32_16x16x32_bf16 v[136:139], v[76:79], v[16:19], 0
    s_nop 0
    v_cvt_pk_bf16_f32 v88, v144, v145
    v_cvt_pk_bf16_f32 v89, v146, v147
    v_mfma_f32_16x16x32_bf16 v[144:147], v[66:69], v[10:13], 0
    v_cvt_pk_bf16_f32 v14, v132, v133
    v_cvt_pk_bf16_f32 v15, v134, v135
    v_mfma_f32_16x16x32_bf16 v[140:143], v[84:87], v[18:21], 0
    s_nop 0
    v_cvt_pk_bf16_f32 v16, v136, v137
    v_cvt_pk_bf16_f32 v17, v138, v139
    v_mfma_f32_16x16x32_bf16 v[192:195], v[2:5], v[2:5], 0
    s_nop 0
    v_cvt_pk_bf16_f32 v10, v144, v145
    v_cvt_pk_bf16_f32 v11, v146, v147
    v_mfma_f32_16x16x32_bf16 v[144:147], v[86:89], v[22:25], 0
    v_cvt_pk_bf16_f32 v20, v140, v141
    v_cvt_pk_bf16_f32 v21, v142, v143
    v_mfma_f32_16x16x32_bf16 v[192:195], v[8:11], v[8:11], v[192:195]
    v_mul_f32 v202, s50, v202
    v_xor_b32 v202, v202, v201
    v_mfma_f32_16x16x32_bf16 v[192:195], v[14:17], v[14:17], v[192:195]
    s_nop 1
    v_cvt_pk_bf16_f32 v22, v144, v145
    v_cvt_pk_bf16_f32 v23, v146, v147
    s_nop 1
    v_mfma_f32_16x16x32_bf16 v[192:195], v[20:23], v[20:23], v[192:195]
    s_nop 7
    v_cndmask_b32 v192, v192, v193, s[44:45]
    v_cndmask_b32 v194, v194, v195, s[44:45]
    v_cndmask_b32 v192, v192, v194, s[46:47]
    ds_bpermute_b32 v188, v220, v192
    s_waitcnt lgkmcnt(0)
    v_fmac_f32 v203, s48, v188
    v_max_f32 v203, v203, v200
    v_rsq_f32 v203, v203
    s_nop 0
    v_mul_f32 v202, v202, v203
    s_nop 1
    v_max_f32_dpp v203, v202, v202 quad_perm:[1,0,3,2] row_mask:0xf bank_mask:0xf
    s_nop 1
    v_max_f32_dpp v203, v203, v203 quad_perm:[2,3,0,1] row_mask:0xf bank_mask:0xf
    s_nop 1
    v_max_f32_dpp v203, v203, v203 row_half_mirror row_mask:0xf bank_mask:0xf
    v_sub_f32 v202, v202, v203
    v_exp_f32 v202, v202
    s_nop 1
    v_add_f32_dpp v203, v202, v202 quad_perm:[1,0,3,2] row_mask:0xf bank_mask:0xf
    v_mul_f32 v202, v202, v204
    s_nop 0
    v_add_f32_dpp v203, v203, v203 quad_perm:[2,3,0,1] row_mask:0xf bank_mask:0xf
    s_nop 1
    v_add_f32_dpp v203, v203, v203 row_half_mirror row_mask:0xf bank_mask:0xf
    v_rcp_f32 v203, v203
    s_nop 0
    v_mul_f32 v202, v202, v203
    v_mul_f32 v164, v164, v202
    v_mul_f32 v165, v165, v202
    v_mov_b32_dpp v203, v202 quad_perm:[1,0,3,2] row_mask:0xf bank_mask:0xf
    v_mul_f32 v166, v166, v202
    v_cvt_pk_bf16_f32 v203, v202, v203
    v_mul_f32 v167, v167, v202
    ds_bpermute_b32 v144, v211, v203
    ds_bpermute_b32 v145, v211, v203 offset:8
    v_add_f32_dpp v164, v164, v164 quad_perm:[1,0,3,2] row_mask:0xf bank_mask:0xf
    v_add_f32_dpp v165, v165, v165 quad_perm:[1,0,3,2] row_mask:0xf bank_mask:0xf
    v_add_f32_dpp v166, v166, v166 quad_perm:[1,0,3,2] row_mask:0xf bank_mask:0xf
    v_add_f32_dpp v167, v167, v167 quad_perm:[1,0,3,2] row_mask:0xf bank_mask:0xf
    v_add_f32_dpp v164, v164, v164 quad_perm:[2,3,0,1] row_mask:0xf bank_mask:0xf
    v_add_f32_dpp v165, v165, v165 quad_perm:[2,3,0,1] row_mask:0xf bank_mask:0xf
    v_add_f32_dpp v166, v166, v166 quad_perm:[2,3,0,1] row_mask:0xf bank_mask:0xf
    v_add_f32_dpp v167, v167, v167 quad_perm:[2,3,0,1] row_mask:0xf bank_mask:0xf
    v_add_f32_dpp v164, v164, v164 row_half_mirror row_mask:0xf bank_mask:0xf
    v_add_f32_dpp v165, v165, v165 row_half_mirror row_mask:0xf bank_mask:0xf
    v_add_f32_dpp v166, v166, v166 row_half_mirror row_mask:0xf bank_mask:0xf
    v_add_f32_dpp v167, v167, v167 row_half_mirror row_mask:0xf bank_mask:0xf
    v_cvt_pk_bf16_f32 v164, v164, v165
    v_cvt_pk_bf16_f32 v165, v166, v167
    v_and_b32 v142, v164, v214
    v_and_b32 v143, v165, v214
    s_waitcnt lgkmcnt(1)
    v_and_b32 v140, v144, v214
    v_and_b32 v144, v144, v214
    s_waitcnt lgkmcnt(0)
    v_and_b32 v141, v145, v214
    v_and_b32 v145, v145, v214
    s_nop 0
    v_mfma_f32_16x16x32_bf16 v[132:135], v[52:55], v[140:143], 0
    v_mfma_f32_16x16x32_bf16 v[136:139], v[58:61], v[142:145], 0
    v_mfma_f32_16x16x32_bf16 v[164:167], v[62:65], v[140:143], 0
    s_nop 5
    v_cvt_pk_bf16_f32 v2, v132, v133
    v_cvt_pk_bf16_f32 v3, v134, v135
    v_mfma_f32_16x16x32_bf16 v[168:171], v[68:71], v[142:145], 0
    v_cvt_pk_bf16_f32 v4, v136, v137
    v_cvt_pk_bf16_f32 v5, v138, v139
    v_mfma_f32_16x16x32_bf16 v[132:135], v[72:75], v[140:143], 0
    buffer_store_dwordx4 v[2:5], v219, s[24:27], s36 offen offset:0 sc1
    v_cvt_pk_bf16_f32 v8, v164, v165
    v_cvt_pk_bf16_f32 v9, v166, v167
    v_mfma_f32_16x16x32_bf16 v[136:139], v[78:81], v[142:145], 0
    s_nop 0
    v_cvt_pk_bf16_f32 v10, v168, v169
    v_cvt_pk_bf16_f32 v11, v170, v171
    v_mfma_f32_16x16x32_bf16 v[164:167], v[82:85], v[140:143], 0
    buffer_store_dwordx4 v[8:11], v219, s[24:27], s36 offen offset:64 sc1
    v_cvt_pk_bf16_f32 v14, v132, v133
    v_cvt_pk_bf16_f32 v15, v134, v135
    v_mfma_f32_16x16x32_bf16 v[168:171], v[88:91], v[142:145], 0
    v_cvt_pk_bf16_f32 v16, v136, v137
    v_cvt_pk_bf16_f32 v17, v138, v139
    buffer_store_dwordx4 v[14:17], v219, s[24:27], s36 offen offset:128 sc1
    s_nop 0
    v_cvt_pk_bf16_f32 v20, v164, v165
    v_cvt_pk_bf16_f32 v21, v166, v167
    s_nop 1
    v_cvt_pk_bf16_f32 v22, v168, v169
    v_cvt_pk_bf16_f32 v23, v170, v171
    buffer_store_dwordx4 v[20:23], v219, s[24:27], s36 offen offset:192 sc1
K4_END:
    s_endpgm
CODE_END:
.section .rodata,"a"
.p2align 6
.amdhsa_kernel prep_kernel
  .amdhsa_next_free_vgpr 128
  .amdhsa_next_free_sgpr 64
  .amdhsa_accum_offset 128
  .amdhsa_group_segment_fixed_size 0
  .amdhsa_kernarg_size 96
  .amdhsa_user_sgpr_count 2
  .amdhsa_user_sgpr_kernarg_segment_ptr 1
  .amdhsa_system_sgpr_workgroup_id_x 1
  .amdhsa_float_denorm_mode_32 3
.end_amdhsa_kernel
.section .rodata,"a"
.p2align 6
.amdhsa_kernel build_kernel
  .amdhsa_next_free_vgpr 64
  .amdhsa_next_free_sgpr 80
  .amdhsa_accum_offset 64
  .amdhsa_group_segment_fixed_size 0
  .amdhsa_kernarg_size 96
  .amdhsa_user_sgpr_count 2
  .amdhsa_user_sgpr_kernarg_segment_ptr 1
  .amdhsa_system_sgpr_workgroup_id_x 1
  .amdhsa_float_denorm_mode_32 3
.end_amdhsa_kernel
.section .rodata,"a"
.p2align 6
.amdhsa_kernel hops_kernel
  .amdhsa_next_free_vgpr 128
  .amdhsa_next_free_sgpr 80
  .amdhsa_accum_offset 128
  .amdhsa_group_segment_fixed_size 0
  .amdhsa_kernarg_size 96
  .amdhsa_user_sgpr_count 2
  .amdhsa_user_sgpr_kernarg_segment_ptr 1
  .amdhsa_system_sgpr_workgroup_id_x 1
  .amdhsa_float_denorm_mode_32 3
.end_amdhsa_kernel
.section .rodata,"a"
.p2align 6
.amdhsa_kernel attn_kernel
  .amdhsa_next_free_vgpr 252
  .amdhsa_next_free_sgpr 64
  .amdhsa_accum_offset 252
  .amdhsa_group_segment_fixed_size 0
  .amdhsa_kernarg_size 96
  .amdhsa_user_sgpr_count 2
  .amdhsa_user_sgpr_kernarg_segment_ptr 1
  .amdhsa_system_sgpr_workgroup_id_x 1
  .amdhsa_float_denorm_mode_32 3
.end_amdhsa_kernel
```
